```python
import torch

def _softmax(x, axis=-1):
    return torch.softmax(x, dim=axis)
def _gelu(x):
    return torch.nn.functional.gelu(x, approximate="tanh")
def _silu(x):
    return torch.nn.functional.silu(x)
def _sigmoid(x):
    return torch.sigmoid(x)
def _layernorm(x, axis=-1, eps=1e-5):
    m = x.mean(dim=axis, keepdim=True)
    v = x.var(dim=axis, keepdim=True, unbiased=False)
    return (x - m) / torch.sqrt(v + eps)
def _scatter_add(tgt, idx, src, axis=0):
    return tgt.clone().index_add_(axis, idx, src)
def _segment_sum(src, seg, n):
    out = torch.zeros((n,) + src.shape[1:], dtype=src.dtype)
    return out.index_add_(0, seg, src)
def _pad(x, pw):
    flat = tuple(v for pair in reversed(pw) for v in pair)
    return torch.nn.functional.pad(x, flat)

kernel_name = 'sequential_preLN__mha_block__geglu_ffn__prompt'

def setup_inputs():

    _w = (lambda a: (lambda t: t.to(torch.bfloat16) if t.is_floating_point() else t)(torch.as_tensor(a)))
    def _A_setup():
        B, S, D, H = 1, 2048, 640, 32
        return {
            "x": _w((lambda *s: torch.randn(*s, dtype=torch.bfloat16) * 0.05)(B, S, D)),
            "wqkv": _w((lambda *s: torch.randn(*s, dtype=torch.bfloat16) * 0.05)(D, 3 * D)),
            "wo": _w((lambda *s: torch.randn(*s, dtype=torch.bfloat16) * 0.05)(D, D)),
        }
    _A_in = _A_setup()

    def _B_setup():
        B, S, D, F = 1, 2048, 640, 1536
        return {
            "x": _w((lambda *s: torch.randn(*s, dtype=torch.bfloat16) * 0.05)(B, S, D)),
            "w_gate": _w((lambda *s: torch.randn(*s, dtype=torch.bfloat16) * 0.05)(D, F)),
            "w_up": _w((lambda *s: torch.randn(*s, dtype=torch.bfloat16) * 0.05)(D, F)),
            "w_down": _w((lambda *s: torch.randn(*s, dtype=torch.bfloat16) * 0.05)(F, D)),
        }
    _B_in = _B_setup()

    return {
        "A_x": _A_in["x"],
        "A_wqkv": _A_in["wqkv"],
        "A_wo": _A_in["wo"],
        "B_x": _B_in["x"],
        "B_w_gate": _B_in["w_gate"],
        "B_w_up": _B_in["w_up"],
        "B_w_down": _B_in["w_down"],
    }

def reference(A_x, A_wqkv, A_wo, B_x, B_w_gate, B_w_up, B_w_down):
    def _A_ref(x, wqkv, wo):
        B, S, D = x.shape
        H = 32
        Dh = D // H
        qkv = (lambda x, *d: x.permute(*d))((x @ wqkv).reshape(B, S, 3, H, Dh), 2, 0, 3, 1, 4)
        q, k, v = qkv[0], qkv[1], qkv[2]
        scores = torch.einsum("bhqd,bhkd->bhqk", q, k) * (Dh ** -0.5)
        p = _softmax(scores, axis=-1)
        o = torch.einsum("bhqk,bhkd->bhqd", p, v)
        return (lambda x, *d: x.permute(*d))(o, 0, 2, 1, 3).reshape(B, S, D) @ wo

    def _B_ref(x, w_gate, w_up, w_down):
        return (_gelu(x @ w_gate) * (x @ w_up)) @ w_down

    x = A_x
    h = x + _A_ref(_layernorm(x, axis=-1), A_wqkv, A_wo)
    h2 = h + _B_ref(_layernorm(h, axis=-1), B_w_gate, B_w_up, B_w_down)
    return h2
```

```asm
; @launch grid=(256,1,1) block=(512,1,1) lds=163840
.amdgcn_target "amdgcn-amd-amdhsa--gfx950"
.text
.globl sequential_preLN__mha_block__geglu_ffn__prompt_kernel
.p2align 8
.type sequential_preLN__mha_block__geglu_ffn__prompt_kernel,@function
sequential_preLN__mha_block__geglu_ffn__prompt_kernel:
  s_cmp_ge_u32 s2, 256
  s_cbranch_scc1 L_mega_end
  s_load_dwordx16 s[4:19], s[0:1], 0
  s_load_dwordx4 s[20:23], s[0:1], 64
  v_and_b32 v1, 63, v0
  v_lshrrev_b32 v3, 6, v0
  v_lshlrev_b32 v2, 4, v1
  v_readfirstlane_b32 s3, v3
  s_waitcnt lgkmcnt(0)
  s_mov_b32 s24, s22
  s_mov_b32 s25, s23
  s_mov_b32 s26, 26992640
  s_mov_b32 s27, 0x20000
  s_mov_b32 s28, s20
  s_mov_b32 s29, s21
  s_mov_b32 s30, 256
  s_mov_b32 s31, 0x20000
  s_cmp_lg_u32 s3, 7
  s_cbranch_scc1 L_cpf_1
  s_getpc_b64 s[32:33]
L_cpf_base:
  s_mov_b32 s34, L_mega_end-L_cpf_base
  v_lshlrev_b32 v3, 7, v1
  v_min_u32 v4, s34, v3
  global_load_dword v240, v4, s[32:33]
  v_add_u32 v3, 8192, v3
  v_min_u32 v4, s34, v3
  global_load_dword v241, v4, s[32:33]
  v_add_u32 v3, 8192, v3
  v_min_u32 v4, s34, v3
  global_load_dword v242, v4, s[32:33]
  v_add_u32 v3, 8192, v3
  v_min_u32 v4, s34, v3
  global_load_dword v243, v4, s[32:33]
  v_add_u32 v3, 8192, v3
  v_min_u32 v4, s34, v3
  global_load_dword v244, v4, s[32:33]
  v_add_u32 v3, 8192, v3
  v_min_u32 v4, s34, v3
  global_load_dword v245, v4, s[32:33]
  v_add_u32 v3, 8192, v3
  v_min_u32 v4, s34, v3
  global_load_dword v246, v4, s[32:33]
  v_add_u32 v3, 8192, v3
L_cpf_1:
  s_and_b32 s34, s2, 7
  s_lshr_b32 s35, s2, 3
  s_lshr_b32 s32, s34, 1
  s_lshl_b32 s32, s32, 1
  s_cmp_ge_u32 s35, 15
  s_cselect_b32 s33, 15, 0
  s_cselect_b32 s75, 1, 0
  s_sub_u32 s33, s35, s33
  s_add_u32 s32, s32, s75
  s_and_b32 s75, s34, 1
  s_mul_i32 s75, s75, 15
  s_add_u32 s33, s33, s75
  s_cmp_ge_u32 s35, 30
  s_cselect_b32 s76, 1, 0
  s_lshl_b32 s77, s34, 1
  s_add_u32 s77, s77, s35
  s_sub_u32 s77, s77, 30
  s_cmp_lt_u32 s3, 4
  s_cbranch_scc1 L_qcomp_3
  s_cmp_eq_u32 s76, 1
  s_cbranch_scc1 L_spare_2
  s_and_b32 s34, s3, 1
  s_cmp_ge_u32 s3, 6
  s_cbranch_scc1 L_qldw_5
  v_lshrrev_b32 v3, 3, v1
  s_lshl_b32 s35, s34, 3
  s_lshl_b32 s75, s32, 7
  s_add_u32 s35, s35, s75
  v_add_u32 v3, s35, v3
  s_movk_i32 s35, 1280
  v_mul_lo_u32 v3, v3, s35
  v_lshrrev_b32 v4, 4, v1
  s_lshl_b32 s35, s34, 2
  v_add_u32 v4, s35, v4
  v_and_b32 v5, 7, v1
  v_xor_b32 v4, v4, v5
  v_lshl_add_u32 v10, v4, 4, v3
  s_lshl_b32 s75, s34, 10
  s_add_u32 s75, s75, 81920
  s_mov_b32 s40, s4
  s_mov_b32 s41, s5
  s_mov_b32 s42, 2621440
  s_mov_b32 s43, 0x20000
  s_mov_b32 s64, 0
  s_mov_b32 s65, 20480
  s_mov_b32 s66, 40960
  s_mov_b32 s67, 61440
  s_mov_b32 s68, 81920
  s_mov_b32 s69, 102400
  s_mov_b32 s70, 122880
  s_mov_b32 s71, 143360
  s_mov_b32 s58, s75
  s_add_u32 s72, s75, 81920
  s_add_u32 m0, s58, 0
  s_nop 0
  buffer_load_dwordx4 v10, s[40:43], s64 offen lds
  s_add_u32 s64, s64, 128
  s_add_u32 m0, s58, 2048
  s_nop 0
  buffer_load_dwordx4 v10, s[40:43], s65 offen lds
  s_add_u32 s65, s65, 128
  s_add_u32 m0, s58, 4096
  s_nop 0
  buffer_load_dwordx4 v10, s[40:43], s66 offen lds
  s_add_u32 s66, s66, 128
  s_add_u32 m0, s58, 6144
  s_nop 0
  buffer_load_dwordx4 v10, s[40:43], s67 offen lds
  s_add_u32 s67, s67, 128
  s_add_u32 m0, s58, 8192
  s_nop 0
  buffer_load_dwordx4 v10, s[40:43], s68 offen lds
  s_add_u32 s68, s68, 128
  s_add_u32 m0, s58, 10240
  s_nop 0
  buffer_load_dwordx4 v10, s[40:43], s69 offen lds
  s_add_u32 s69, s69, 128
  s_add_u32 m0, s58, 12288
  s_nop 0
  buffer_load_dwordx4 v10, s[40:43], s70 offen lds
  s_add_u32 s70, s70, 128
  s_add_u32 m0, s58, 14336
  s_nop 0
  buffer_load_dwordx4 v10, s[40:43], s71 offen lds
  s_add_u32 s71, s71, 128
  s_add_u32 s58, s58, 16384
  s_cmp_ge_u32 s58, s72
  s_cselect_b32 s73, 81920, 0
  s_sub_u32 s58, s58, s73
  s_add_u32 m0, s58, 0
  s_nop 0
  buffer_load_dwordx4 v10, s[40:43], s64 offen lds
  s_add_u32 s64, s64, 128
  s_add_u32 m0, s58, 2048
  s_nop 0
  buffer_load_dwordx4 v10, s[40:43], s65 offen lds
  s_add_u32 s65, s65, 128
  s_add_u32 m0, s58, 4096
  s_nop 0
  buffer_load_dwordx4 v10, s[40:43], s66 offen lds
  s_add_u32 s66, s66, 128
  s_add_u32 m0, s58, 6144
  s_nop 0
  buffer_load_dwordx4 v10, s[40:43], s67 offen lds
  s_add_u32 s67, s67, 128
  s_add_u32 m0, s58, 8192
  s_nop 0
  buffer_load_dwordx4 v10, s[40:43], s68 offen lds
  s_add_u32 s68, s68, 128
  s_add_u32 m0, s58, 10240
  s_nop 0
  buffer_load_dwordx4 v10, s[40:43], s69 offen lds
  s_add_u32 s69, s69, 128
  s_add_u32 m0, s58, 12288
  s_nop 0
  buffer_load_dwordx4 v10, s[40:43], s70 offen lds
  s_add_u32 s70, s70, 128
  s_add_u32 m0, s58, 14336
  s_nop 0
  buffer_load_dwordx4 v10, s[40:43], s71 offen lds
  s_add_u32 s71, s71, 128
  s_add_u32 s58, s58, 16384
  s_cmp_ge_u32 s58, s72
  s_cselect_b32 s73, 81920, 0
  s_sub_u32 s58, s58, s73
  s_add_u32 m0, s58, 0
  s_nop 0
  buffer_load_dwordx4 v10, s[40:43], s64 offen lds
  s_add_u32 s64, s64, 128
  s_add_u32 m0, s58, 2048
  s_nop 0
  buffer_load_dwordx4 v10, s[40:43], s65 offen lds
  s_add_u32 s65, s65, 128
  s_add_u32 m0, s58, 4096
  s_nop 0
  buffer_load_dwordx4 v10, s[40:43], s66 offen lds
  s_add_u32 s66, s66, 128
  s_add_u32 m0, s58, 6144
  s_nop 0
  buffer_load_dwordx4 v10, s[40:43], s67 offen lds
  s_add_u32 s67, s67, 128
  s_add_u32 m0, s58, 8192
  s_nop 0
  buffer_load_dwordx4 v10, s[40:43], s68 offen lds
  s_add_u32 s68, s68, 128
  s_add_u32 m0, s58, 10240
  s_nop 0
  buffer_load_dwordx4 v10, s[40:43], s69 offen lds
  s_add_u32 s69, s69, 128
  s_add_u32 m0, s58, 12288
  s_nop 0
  buffer_load_dwordx4 v10, s[40:43], s70 offen lds
  s_add_u32 s70, s70, 128
  s_add_u32 m0, s58, 14336
  s_nop 0
  buffer_load_dwordx4 v10, s[40:43], s71 offen lds
  s_add_u32 s71, s71, 128
  s_add_u32 s58, s58, 16384
  s_cmp_ge_u32 s58, s72
  s_cselect_b32 s73, 81920, 0
  s_sub_u32 s58, s58, s73
  s_waitcnt vmcnt(16)
  s_barrier
  s_add_u32 m0, s58, 0
  s_nop 0
  buffer_load_dwordx4 v10, s[40:43], s64 offen lds
  s_add_u32 s64, s64, 128
  s_add_u32 m0, s58, 2048
  s_nop 0
  buffer_load_dwordx4 v10, s[40:43], s65 offen lds
  s_add_u32 s65, s65, 128
  s_add_u32 m0, s58, 4096
  s_nop 0
  buffer_load_dwordx4 v10, s[40:43], s66 offen lds
  s_add_u32 s66, s66, 128
  s_add_u32 m0, s58, 6144
  s_nop 0
  buffer_load_dwordx4 v10, s[40:43], s67 offen lds
  s_add_u32 s67, s67, 128
  s_add_u32 m0, s58, 8192
  s_nop 0
  buffer_load_dwordx4 v10, s[40:43], s68 offen lds
  s_add_u32 s68, s68, 128
  s_add_u32 m0, s58, 10240
  s_nop 0
  buffer_load_dwordx4 v10, s[40:43], s69 offen lds
  s_add_u32 s69, s69, 128
  s_add_u32 m0, s58, 12288
  s_nop 0
  buffer_load_dwordx4 v10, s[40:43], s70 offen lds
  s_add_u32 s70, s70, 128
  s_add_u32 m0, s58, 14336
  s_nop 0
  buffer_load_dwordx4 v10, s[40:43], s71 offen lds
  s_add_u32 s71, s71, 128
  s_add_u32 s58, s58, 16384
  s_cmp_ge_u32 s58, s72
  s_cselect_b32 s73, 81920, 0
  s_sub_u32 s58, s58, s73
  s_add_u32 m0, s58, 0
  s_nop 0
  buffer_load_dwordx4 v10, s[40:43], s64 offen lds
  s_add_u32 s64, s64, 128
  s_add_u32 m0, s58, 2048
  s_nop 0
  buffer_load_dwordx4 v10, s[40:43], s65 offen lds
  s_add_u32 s65, s65, 128
  s_add_u32 m0, s58, 4096
  s_nop 0
  buffer_load_dwordx4 v10, s[40:43], s66 offen lds
  s_add_u32 s66, s66, 128
  s_add_u32 m0, s58, 6144
  s_nop 0
  buffer_load_dwordx4 v10, s[40:43], s67 offen lds
  s_add_u32 s67, s67, 128
  s_add_u32 m0, s58, 8192
  s_nop 0
  buffer_load_dwordx4 v10, s[40:43], s68 offen lds
  s_add_u32 s68, s68, 128
  s_add_u32 m0, s58, 10240
  s_nop 0
  buffer_load_dwordx4 v10, s[40:43], s69 offen lds
  s_add_u32 s69, s69, 128
  s_add_u32 m0, s58, 12288
  s_nop 0
  buffer_load_dwordx4 v10, s[40:43], s70 offen lds
  s_add_u32 s70, s70, 128
  s_add_u32 m0, s58, 14336
  s_nop 0
  buffer_load_dwordx4 v10, s[40:43], s71 offen lds
  s_add_u32 s71, s71, 128
  s_add_u32 s58, s58, 16384
  s_cmp_ge_u32 s58, s72
  s_cselect_b32 s73, 81920, 0
  s_sub_u32 s58, s58, s73
  s_waitcnt vmcnt(24)
  s_barrier
  s_waitcnt vmcnt(16)
  s_barrier
  s_add_u32 m0, s58, 0
  s_nop 0
  buffer_load_dwordx4 v10, s[40:43], s64 offen lds
  s_add_u32 s64, s64, 128
  s_add_u32 m0, s58, 2048
  s_nop 0
  buffer_load_dwordx4 v10, s[40:43], s65 offen lds
  s_add_u32 s65, s65, 128
  s_add_u32 m0, s58, 4096
  s_nop 0
  buffer_load_dwordx4 v10, s[40:43], s66 offen lds
  s_add_u32 s66, s66, 128
  s_add_u32 m0, s58, 6144
  s_nop 0
  buffer_load_dwordx4 v10, s[40:43], s67 offen lds
  s_add_u32 s67, s67, 128
  s_add_u32 m0, s58, 8192
  s_nop 0
  buffer_load_dwordx4 v10, s[40:43], s68 offen lds
  s_add_u32 s68, s68, 128
  s_add_u32 m0, s58, 10240
  s_nop 0
  buffer_load_dwordx4 v10, s[40:43], s69 offen lds
  s_add_u32 s69, s69, 128
  s_add_u32 m0, s58, 12288
  s_nop 0
  buffer_load_dwordx4 v10, s[40:43], s70 offen lds
  s_add_u32 s70, s70, 128
  s_add_u32 m0, s58, 14336
  s_nop 0
  buffer_load_dwordx4 v10, s[40:43], s71 offen lds
  s_add_u32 s71, s71, 128
  s_add_u32 s58, s58, 16384
  s_cmp_ge_u32 s58, s72
  s_cselect_b32 s73, 81920, 0
  s_sub_u32 s58, s58, s73
  s_waitcnt vmcnt(16)
  s_barrier
  s_add_u32 m0, s58, 0
  s_nop 0
  buffer_load_dwordx4 v10, s[40:43], s64 offen lds
  s_add_u32 s64, s64, 128
  s_add_u32 m0, s58, 2048
  s_nop 0
  buffer_load_dwordx4 v10, s[40:43], s65 offen lds
  s_add_u32 s65, s65, 128
  s_add_u32 m0, s58, 4096
  s_nop 0
  buffer_load_dwordx4 v10, s[40:43], s66 offen lds
  s_add_u32 s66, s66, 128
  s_add_u32 m0, s58, 6144
  s_nop 0
  buffer_load_dwordx4 v10, s[40:43], s67 offen lds
  s_add_u32 s67, s67, 128
  s_add_u32 m0, s58, 8192
  s_nop 0
  buffer_load_dwordx4 v10, s[40:43], s68 offen lds
  s_add_u32 s68, s68, 128
  s_add_u32 m0, s58, 10240
  s_nop 0
  buffer_load_dwordx4 v10, s[40:43], s69 offen lds
  s_add_u32 s69, s69, 128
  s_add_u32 m0, s58, 12288
  s_nop 0
  buffer_load_dwordx4 v10, s[40:43], s70 offen lds
  s_add_u32 s70, s70, 128
  s_add_u32 m0, s58, 14336
  s_nop 0
  buffer_load_dwordx4 v10, s[40:43], s71 offen lds
  s_add_u32 s71, s71, 128
  s_add_u32 s58, s58, 16384
  s_cmp_ge_u32 s58, s72
  s_cselect_b32 s73, 81920, 0
  s_sub_u32 s58, s58, s73
  s_waitcnt vmcnt(16)
  s_barrier
  s_add_u32 m0, s58, 0
  s_nop 0
  buffer_load_dwordx4 v10, s[40:43], s64 offen lds
  s_add_u32 s64, s64, 128
  s_add_u32 m0, s58, 2048
  s_nop 0
  buffer_load_dwordx4 v10, s[40:43], s65 offen lds
  s_add_u32 s65, s65, 128
  s_add_u32 m0, s58, 4096
  s_nop 0
  buffer_load_dwordx4 v10, s[40:43], s66 offen lds
  s_add_u32 s66, s66, 128
  s_add_u32 m0, s58, 6144
  s_nop 0
  buffer_load_dwordx4 v10, s[40:43], s67 offen lds
  s_add_u32 s67, s67, 128
  s_add_u32 m0, s58, 8192
  s_nop 0
  buffer_load_dwordx4 v10, s[40:43], s68 offen lds
  s_add_u32 s68, s68, 128
  s_add_u32 m0, s58, 10240
  s_nop 0
  buffer_load_dwordx4 v10, s[40:43], s69 offen lds
  s_add_u32 s69, s69, 128
  s_add_u32 m0, s58, 12288
  s_nop 0
  buffer_load_dwordx4 v10, s[40:43], s70 offen lds
  s_add_u32 s70, s70, 128
  s_add_u32 m0, s58, 14336
  s_nop 0
  buffer_load_dwordx4 v10, s[40:43], s71 offen lds
  s_add_u32 s71, s71, 128
  s_add_u32 s58, s58, 16384
  s_cmp_ge_u32 s58, s72
  s_cselect_b32 s73, 81920, 0
  s_sub_u32 s58, s58, s73
  s_waitcnt vmcnt(16)
  s_barrier
  s_add_u32 m0, s58, 0
  s_nop 0
  buffer_load_dwordx4 v10, s[40:43], s64 offen lds
  s_add_u32 s64, s64, 128
  s_add_u32 m0, s58, 2048
  s_nop 0
  buffer_load_dwordx4 v10, s[40:43], s65 offen lds
  s_add_u32 s65, s65, 128
  s_add_u32 m0, s58, 4096
  s_nop 0
  buffer_load_dwordx4 v10, s[40:43], s66 offen lds
  s_add_u32 s66, s66, 128
  s_add_u32 m0, s58, 6144
  s_nop 0
  buffer_load_dwordx4 v10, s[40:43], s67 offen lds
  s_add_u32 s67, s67, 128
  s_add_u32 m0, s58, 8192
  s_nop 0
  buffer_load_dwordx4 v10, s[40:43], s68 offen lds
  s_add_u32 s68, s68, 128
  s_add_u32 m0, s58, 10240
  s_nop 0
  buffer_load_dwordx4 v10, s[40:43], s69 offen lds
  s_add_u32 s69, s69, 128
  s_add_u32 m0, s58, 12288
  s_nop 0
  buffer_load_dwordx4 v10, s[40:43], s70 offen lds
  s_add_u32 s70, s70, 128
  s_add_u32 m0, s58, 14336
  s_nop 0
  buffer_load_dwordx4 v10, s[40:43], s71 offen lds
  s_add_u32 s71, s71, 128
  s_add_u32 s58, s58, 16384
  s_cmp_ge_u32 s58, s72
  s_cselect_b32 s73, 81920, 0
  s_sub_u32 s58, s58, s73
  s_waitcnt vmcnt(16)
  s_barrier
  s_add_u32 m0, s58, 0
  s_nop 0
  buffer_load_dwordx4 v10, s[40:43], s64 offen lds
  s_add_u32 s64, s64, 128
  s_add_u32 m0, s58, 2048
  s_nop 0
  buffer_load_dwordx4 v10, s[40:43], s65 offen lds
  s_add_u32 s65, s65, 128
  s_add_u32 m0, s58, 4096
  s_nop 0
  buffer_load_dwordx4 v10, s[40:43], s66 offen lds
  s_add_u32 s66, s66, 128
  s_add_u32 m0, s58, 6144
  s_nop 0
  buffer_load_dwordx4 v10, s[40:43], s67 offen lds
  s_add_u32 s67, s67, 128
  s_add_u32 m0, s58, 8192
  s_nop 0
  buffer_load_dwordx4 v10, s[40:43], s68 offen lds
  s_add_u32 s68, s68, 128
  s_add_u32 m0, s58, 10240
  s_nop 0
  buffer_load_dwordx4 v10, s[40:43], s69 offen lds
  s_add_u32 s69, s69, 128
  s_add_u32 m0, s58, 12288
  s_nop 0
  buffer_load_dwordx4 v10, s[40:43], s70 offen lds
  s_add_u32 s70, s70, 128
  s_add_u32 m0, s58, 14336
  s_nop 0
  buffer_load_dwordx4 v10, s[40:43], s71 offen lds
  s_add_u32 s71, s71, 128
  s_add_u32 s58, s58, 16384
  s_cmp_ge_u32 s58, s72
  s_cselect_b32 s73, 81920, 0
  s_sub_u32 s58, s58, s73
  s_waitcnt vmcnt(16)
  s_barrier
  s_add_u32 s64, s64, 1309440
  s_add_u32 s65, s65, 1309440
  s_add_u32 s66, s66, 1309440
  s_add_u32 s67, s67, 1309440
  s_add_u32 s68, s68, 1309440
  s_add_u32 s69, s69, 1309440
  s_add_u32 s70, s70, 1309440
  s_add_u32 s71, s71, 1309440
  s_add_u32 m0, s58, 0
  s_nop 0
  buffer_load_dwordx4 v10, s[40:43], s64 offen lds
  s_add_u32 s64, s64, 128
  s_add_u32 m0, s58, 2048
  s_nop 0
  buffer_load_dwordx4 v10, s[40:43], s65 offen lds
  s_add_u32 s65, s65, 128
  s_add_u32 m0, s58, 4096
  s_nop 0
  buffer_load_dwordx4 v10, s[40:43], s66 offen lds
  s_add_u32 s66, s66, 128
  s_add_u32 m0, s58, 6144
  s_nop 0
  buffer_load_dwordx4 v10, s[40:43], s67 offen lds
  s_add_u32 s67, s67, 128
  s_add_u32 m0, s58, 8192
  s_nop 0
  buffer_load_dwordx4 v10, s[40:43], s68 offen lds
  s_add_u32 s68, s68, 128
  s_add_u32 m0, s58, 10240
  s_nop 0
  buffer_load_dwordx4 v10, s[40:43], s69 offen lds
  s_add_u32 s69, s69, 128
  s_add_u32 m0, s58, 12288
  s_nop 0
  buffer_load_dwordx4 v10, s[40:43], s70 offen lds
  s_add_u32 s70, s70, 128
  s_add_u32 m0, s58, 14336
  s_nop 0
  buffer_load_dwordx4 v10, s[40:43], s71 offen lds
  s_add_u32 s71, s71, 128
  s_add_u32 s58, s58, 16384
  s_cmp_ge_u32 s58, s72
  s_cselect_b32 s73, 81920, 0
  s_sub_u32 s58, s58, s73
  s_waitcnt vmcnt(16)
  s_barrier
  s_add_u32 m0, s58, 0
  s_nop 0
  buffer_load_dwordx4 v10, s[40:43], s64 offen lds
  s_add_u32 s64, s64, 128
  s_add_u32 m0, s58, 2048
  s_nop 0
  buffer_load_dwordx4 v10, s[40:43], s65 offen lds
  s_add_u32 s65, s65, 128
  s_add_u32 m0, s58, 4096
  s_nop 0
  buffer_load_dwordx4 v10, s[40:43], s66 offen lds
  s_add_u32 s66, s66, 128
  s_add_u32 m0, s58, 6144
  s_nop 0
  buffer_load_dwordx4 v10, s[40:43], s67 offen lds
  s_add_u32 s67, s67, 128
  s_add_u32 m0, s58, 8192
  s_nop 0
  buffer_load_dwordx4 v10, s[40:43], s68 offen lds
  s_add_u32 s68, s68, 128
  s_add_u32 m0, s58, 10240
  s_nop 0
  buffer_load_dwordx4 v10, s[40:43], s69 offen lds
  s_add_u32 s69, s69, 128
  s_add_u32 m0, s58, 12288
  s_nop 0
  buffer_load_dwordx4 v10, s[40:43], s70 offen lds
  s_add_u32 s70, s70, 128
  s_add_u32 m0, s58, 14336
  s_nop 0
  buffer_load_dwordx4 v10, s[40:43], s71 offen lds
  s_add_u32 s71, s71, 128
  s_add_u32 s58, s58, 16384
  s_cmp_ge_u32 s58, s72
  s_cselect_b32 s73, 81920, 0
  s_sub_u32 s58, s58, s73
  s_waitcnt vmcnt(16)
  s_barrier
  s_add_u32 m0, s58, 0
  s_nop 0
  buffer_load_dwordx4 v10, s[40:43], s64 offen lds
  s_add_u32 s64, s64, 128
  s_add_u32 m0, s58, 2048
  s_nop 0
  buffer_load_dwordx4 v10, s[40:43], s65 offen lds
  s_add_u32 s65, s65, 128
  s_add_u32 m0, s58, 4096
  s_nop 0
  buffer_load_dwordx4 v10, s[40:43], s66 offen lds
  s_add_u32 s66, s66, 128
  s_add_u32 m0, s58, 6144
  s_nop 0
  buffer_load_dwordx4 v10, s[40:43], s67 offen lds
  s_add_u32 s67, s67, 128
  s_add_u32 m0, s58, 8192
  s_nop 0
  buffer_load_dwordx4 v10, s[40:43], s68 offen lds
  s_add_u32 s68, s68, 128
  s_add_u32 m0, s58, 10240
  s_nop 0
  buffer_load_dwordx4 v10, s[40:43], s69 offen lds
  s_add_u32 s69, s69, 128
  s_add_u32 m0, s58, 12288
  s_nop 0
  buffer_load_dwordx4 v10, s[40:43], s70 offen lds
  s_add_u32 s70, s70, 128
  s_add_u32 m0, s58, 14336
  s_nop 0
  buffer_load_dwordx4 v10, s[40:43], s71 offen lds
  s_add_u32 s71, s71, 128
  s_add_u32 s58, s58, 16384
  s_cmp_ge_u32 s58, s72
  s_cselect_b32 s73, 81920, 0
  s_sub_u32 s58, s58, s73
  s_waitcnt vmcnt(16)
  s_barrier
  s_add_u32 m0, s58, 0
  s_nop 0
  buffer_load_dwordx4 v10, s[40:43], s64 offen lds
  s_add_u32 s64, s64, 128
  s_add_u32 m0, s58, 2048
  s_nop 0
  buffer_load_dwordx4 v10, s[40:43], s65 offen lds
  s_add_u32 s65, s65, 128
  s_add_u32 m0, s58, 4096
  s_nop 0
  buffer_load_dwordx4 v10, s[40:43], s66 offen lds
  s_add_u32 s66, s66, 128
  s_add_u32 m0, s58, 6144
  s_nop 0
  buffer_load_dwordx4 v10, s[40:43], s67 offen lds
  s_add_u32 s67, s67, 128
  s_add_u32 m0, s58, 8192
  s_nop 0
  buffer_load_dwordx4 v10, s[40:43], s68 offen lds
  s_add_u32 s68, s68, 128
  s_add_u32 m0, s58, 10240
  s_nop 0
  buffer_load_dwordx4 v10, s[40:43], s69 offen lds
  s_add_u32 s69, s69, 128
  s_add_u32 m0, s58, 12288
  s_nop 0
  buffer_load_dwordx4 v10, s[40:43], s70 offen lds
  s_add_u32 s70, s70, 128
  s_add_u32 m0, s58, 14336
  s_nop 0
  buffer_load_dwordx4 v10, s[40:43], s71 offen lds
  s_add_u32 s71, s71, 128
  s_add_u32 s58, s58, 16384
  s_cmp_ge_u32 s58, s72
  s_cselect_b32 s73, 81920, 0
  s_sub_u32 s58, s58, s73
  s_waitcnt vmcnt(16)
  s_barrier
  s_add_u32 m0, s58, 0
  s_nop 0
  buffer_load_dwordx4 v10, s[40:43], s64 offen lds
  s_add_u32 s64, s64, 128
  s_add_u32 m0, s58, 2048
  s_nop 0
  buffer_load_dwordx4 v10, s[40:43], s65 offen lds
  s_add_u32 s65, s65, 128
  s_add_u32 m0, s58, 4096
  s_nop 0
  buffer_load_dwordx4 v10, s[40:43], s66 offen lds
  s_add_u32 s66, s66, 128
  s_add_u32 m0, s58, 6144
  s_nop 0
  buffer_load_dwordx4 v10, s[40:43], s67 offen lds
  s_add_u32 s67, s67, 128
  s_add_u32 m0, s58, 8192
  s_nop 0
  buffer_load_dwordx4 v10, s[40:43], s68 offen lds
  s_add_u32 s68, s68, 128
  s_add_u32 m0, s58, 10240
  s_nop 0
  buffer_load_dwordx4 v10, s[40:43], s69 offen lds
  s_add_u32 s69, s69, 128
  s_add_u32 m0, s58, 12288
  s_nop 0
  buffer_load_dwordx4 v10, s[40:43], s70 offen lds
  s_add_u32 s70, s70, 128
  s_add_u32 m0, s58, 14336
  s_nop 0
  buffer_load_dwordx4 v10, s[40:43], s71 offen lds
  s_add_u32 s71, s71, 128
  s_add_u32 s58, s58, 16384
  s_cmp_ge_u32 s58, s72
  s_cselect_b32 s73, 81920, 0
  s_sub_u32 s58, s58, s73
  s_waitcnt vmcnt(16)
  s_barrier
  s_add_u32 m0, s58, 0
  s_nop 0
  buffer_load_dwordx4 v10, s[40:43], s64 offen lds
  s_add_u32 s64, s64, 128
  s_add_u32 m0, s58, 2048
  s_nop 0
  buffer_load_dwordx4 v10, s[40:43], s65 offen lds
  s_add_u32 s65, s65, 128
  s_add_u32 m0, s58, 4096
  s_nop 0
  buffer_load_dwordx4 v10, s[40:43], s66 offen lds
  s_add_u32 s66, s66, 128
  s_add_u32 m0, s58, 6144
  s_nop 0
  buffer_load_dwordx4 v10, s[40:43], s67 offen lds
  s_add_u32 s67, s67, 128
  s_add_u32 m0, s58, 8192
  s_nop 0
  buffer_load_dwordx4 v10, s[40:43], s68 offen lds
  s_add_u32 s68, s68, 128
  s_add_u32 m0, s58, 10240
  s_nop 0
  buffer_load_dwordx4 v10, s[40:43], s69 offen lds
  s_add_u32 s69, s69, 128
  s_add_u32 m0, s58, 12288
  s_nop 0
  buffer_load_dwordx4 v10, s[40:43], s70 offen lds
  s_add_u32 s70, s70, 128
  s_add_u32 m0, s58, 14336
  s_nop 0
  buffer_load_dwordx4 v10, s[40:43], s71 offen lds
  s_add_u32 s71, s71, 128
  s_add_u32 s58, s58, 16384
  s_cmp_ge_u32 s58, s72
  s_cselect_b32 s73, 81920, 0
  s_sub_u32 s58, s58, s73
  s_waitcnt vmcnt(16)
  s_barrier
  s_add_u32 m0, s58, 0
  s_nop 0
  buffer_load_dwordx4 v10, s[40:43], s64 offen lds
  s_add_u32 s64, s64, 128
  s_add_u32 m0, s58, 2048
  s_nop 0
  buffer_load_dwordx4 v10, s[40:43], s65 offen lds
  s_add_u32 s65, s65, 128
  s_add_u32 m0, s58, 4096
  s_nop 0
  buffer_load_dwordx4 v10, s[40:43], s66 offen lds
  s_add_u32 s66, s66, 128
  s_add_u32 m0, s58, 6144
  s_nop 0
  buffer_load_dwordx4 v10, s[40:43], s67 offen lds
  s_add_u32 s67, s67, 128
  s_add_u32 m0, s58, 8192
  s_nop 0
  buffer_load_dwordx4 v10, s[40:43], s68 offen lds
  s_add_u32 s68, s68, 128
  s_add_u32 m0, s58, 10240
  s_nop 0
  buffer_load_dwordx4 v10, s[40:43], s69 offen lds
  s_add_u32 s69, s69, 128
  s_add_u32 m0, s58, 12288
  s_nop 0
  buffer_load_dwordx4 v10, s[40:43], s70 offen lds
  s_add_u32 s70, s70, 128
  s_add_u32 m0, s58, 14336
  s_nop 0
  buffer_load_dwordx4 v10, s[40:43], s71 offen lds
  s_add_u32 s71, s71, 128
  s_add_u32 s58, s58, 16384
  s_cmp_ge_u32 s58, s72
  s_cselect_b32 s73, 81920, 0
  s_sub_u32 s58, s58, s73
  s_waitcnt vmcnt(16)
  s_barrier
  s_add_u32 m0, s58, 0
  s_nop 0
  buffer_load_dwordx4 v10, s[40:43], s64 offen lds
  s_add_u32 s64, s64, 128
  s_add_u32 m0, s58, 2048
  s_nop 0
  buffer_load_dwordx4 v10, s[40:43], s65 offen lds
  s_add_u32 s65, s65, 128
  s_add_u32 m0, s58, 4096
  s_nop 0
  buffer_load_dwordx4 v10, s[40:43], s66 offen lds
  s_add_u32 s66, s66, 128
  s_add_u32 m0, s58, 6144
  s_nop 0
  buffer_load_dwordx4 v10, s[40:43], s67 offen lds
  s_add_u32 s67, s67, 128
  s_add_u32 m0, s58, 8192
  s_nop 0
  buffer_load_dwordx4 v10, s[40:43], s68 offen lds
  s_add_u32 s68, s68, 128
  s_add_u32 m0, s58, 10240
  s_nop 0
  buffer_load_dwordx4 v10, s[40:43], s69 offen lds
  s_add_u32 s69, s69, 128
  s_add_u32 m0, s58, 12288
  s_nop 0
  buffer_load_dwordx4 v10, s[40:43], s70 offen lds
  s_add_u32 s70, s70, 128
  s_add_u32 m0, s58, 14336
  s_nop 0
  buffer_load_dwordx4 v10, s[40:43], s71 offen lds
  s_add_u32 s71, s71, 128
  s_add_u32 s58, s58, 16384
  s_cmp_ge_u32 s58, s72
  s_cselect_b32 s73, 81920, 0
  s_sub_u32 s58, s58, s73
  s_waitcnt vmcnt(16)
  s_barrier
  s_add_u32 m0, s58, 0
  s_nop 0
  buffer_load_dwordx4 v10, s[40:43], s64 offen lds
  s_add_u32 s64, s64, 128
  s_add_u32 m0, s58, 2048
  s_nop 0
  buffer_load_dwordx4 v10, s[40:43], s65 offen lds
  s_add_u32 s65, s65, 128
  s_add_u32 m0, s58, 4096
  s_nop 0
  buffer_load_dwordx4 v10, s[40:43], s66 offen lds
  s_add_u32 s66, s66, 128
  s_add_u32 m0, s58, 6144
  s_nop 0
  buffer_load_dwordx4 v10, s[40:43], s67 offen lds
  s_add_u32 s67, s67, 128
  s_add_u32 m0, s58, 8192
  s_nop 0
  buffer_load_dwordx4 v10, s[40:43], s68 offen lds
  s_add_u32 s68, s68, 128
  s_add_u32 m0, s58, 10240
  s_nop 0
  buffer_load_dwordx4 v10, s[40:43], s69 offen lds
  s_add_u32 s69, s69, 128
  s_add_u32 m0, s58, 12288
  s_nop 0
  buffer_load_dwordx4 v10, s[40:43], s70 offen lds
  s_add_u32 s70, s70, 128
  s_add_u32 m0, s58, 14336
  s_nop 0
  buffer_load_dwordx4 v10, s[40:43], s71 offen lds
  s_add_u32 s71, s71, 128
  s_add_u32 s58, s58, 16384
  s_cmp_ge_u32 s58, s72
  s_cselect_b32 s73, 81920, 0
  s_sub_u32 s58, s58, s73
  s_waitcnt vmcnt(16)
  s_barrier
  s_add_u32 m0, s58, 0
  s_nop 0
  buffer_load_dwordx4 v10, s[40:43], s64 offen lds
  s_add_u32 s64, s64, 128
  s_add_u32 m0, s58, 2048
  s_nop 0
  buffer_load_dwordx4 v10, s[40:43], s65 offen lds
  s_add_u32 s65, s65, 128
  s_add_u32 m0, s58, 4096
  s_nop 0
  buffer_load_dwordx4 v10, s[40:43], s66 offen lds
  s_add_u32 s66, s66, 128
  s_add_u32 m0, s58, 6144
  s_nop 0
  buffer_load_dwordx4 v10, s[40:43], s67 offen lds
  s_add_u32 s67, s67, 128
  s_add_u32 m0, s58, 8192
  s_nop 0
  buffer_load_dwordx4 v10, s[40:43], s68 offen lds
  s_add_u32 s68, s68, 128
  s_add_u32 m0, s58, 10240
  s_nop 0
  buffer_load_dwordx4 v10, s[40:43], s69 offen lds
  s_add_u32 s69, s69, 128
  s_add_u32 m0, s58, 12288
  s_nop 0
  buffer_load_dwordx4 v10, s[40:43], s70 offen lds
  s_add_u32 s70, s70, 128
  s_add_u32 m0, s58, 14336
  s_nop 0
  buffer_load_dwordx4 v10, s[40:43], s71 offen lds
  s_add_u32 s71, s71, 128
  s_add_u32 s58, s58, 16384
  s_cmp_ge_u32 s58, s72
  s_cselect_b32 s73, 81920, 0
  s_sub_u32 s58, s58, s73
  s_waitcnt vmcnt(16)
  s_barrier
  s_waitcnt vmcnt(8)
  s_barrier
  s_waitcnt vmcnt(0)
  s_barrier
  s_barrier
  s_branch L_p1_done
L_qldw_5:
  v_lshrrev_b32 v3, 3, v1
  v_bfe_u32 v4, v3, 1, 1
  v_lshlrev_b32 v4, 2, v4
  v_and_b32 v5, 7, v1
  v_xor_b32 v4, v4, v5
  s_lshl_b32 s35, s34, 3
  v_add_u32 v3, s35, v3
  s_movk_i32 s35, 3840
  v_mul_lo_u32 v3, v3, s35
  v_lshl_add_u32 v3, v4, 4, v3
  s_lshl_b32 s35, s33, 7
  v_add_u32 v10, s35, v3
  s_lshl_b32 s75, s34, 10
  s_mov_b32 s64, 0
  s_mov_b32 s44, s6
  s_mov_b32 s45, s7
  s_mov_b32 s46, 2457600
  s_mov_b32 s47, 0x20000
  s_add_u32 m0, s75, 0
  s_add_u32 s65, s64, 0
  buffer_load_dwordx4 v10, s[44:47], s65 offen lds
  s_add_u32 m0, s75, 2048
  s_add_u32 s65, s64, 61440
  buffer_load_dwordx4 v10, s[44:47], s65 offen lds
  s_add_u32 m0, s75, 4096
  s_add_u32 s65, s64, 122880
  buffer_load_dwordx4 v10, s[44:47], s65 offen lds
  s_add_u32 m0, s75, 6144
  s_add_u32 s65, s64, 184320
  buffer_load_dwordx4 v10, s[44:47], s65 offen lds
  s_add_u32 s64, s64, 245760
  s_add_u32 s75, s75, 8192
  s_add_u32 m0, s75, 0
  s_add_u32 s65, s64, 0
  buffer_load_dwordx4 v10, s[44:47], s65 offen lds
  s_add_u32 m0, s75, 2048
  s_add_u32 s65, s64, 61440
  buffer_load_dwordx4 v10, s[44:47], s65 offen lds
  s_add_u32 m0, s75, 4096
  s_add_u32 s65, s64, 122880
  buffer_load_dwordx4 v10, s[44:47], s65 offen lds
  s_add_u32 m0, s75, 6144
  s_add_u32 s65, s64, 184320
  buffer_load_dwordx4 v10, s[44:47], s65 offen lds
  s_add_u32 s64, s64, 245760
  s_add_u32 s75, s75, 8192
  s_add_u32 m0, s75, 0
  s_add_u32 s65, s64, 0
  buffer_load_dwordx4 v10, s[44:47], s65 offen lds
  s_add_u32 m0, s75, 2048
  s_add_u32 s65, s64, 61440
  buffer_load_dwordx4 v10, s[44:47], s65 offen lds
  s_add_u32 m0, s75, 4096
  s_add_u32 s65, s64, 122880
  buffer_load_dwordx4 v10, s[44:47], s65 offen lds
  s_add_u32 m0, s75, 6144
  s_add_u32 s65, s64, 184320
  buffer_load_dwordx4 v10, s[44:47], s65 offen lds
  s_add_u32 s64, s64, 245760
  s_add_u32 s75, s75, 8192
  s_add_u32 m0, s75, 0
  s_add_u32 s65, s64, 0
  buffer_load_dwordx4 v10, s[44:47], s65 offen lds
  s_add_u32 m0, s75, 2048
  s_add_u32 s65, s64, 61440
  buffer_load_dwordx4 v10, s[44:47], s65 offen lds
  s_add_u32 m0, s75, 4096
  s_add_u32 s65, s64, 122880
  buffer_load_dwordx4 v10, s[44:47], s65 offen lds
  s_add_u32 m0, s75, 6144
  s_add_u32 s65, s64, 184320
  buffer_load_dwordx4 v10, s[44:47], s65 offen lds
  s_add_u32 s64, s64, 245760
  s_add_u32 s75, s75, 8192
  s_waitcnt vmcnt(12)
  s_barrier
  s_add_u32 m0, s75, 0
  s_add_u32 s65, s64, 0
  buffer_load_dwordx4 v10, s[44:47], s65 offen lds
  s_add_u32 m0, s75, 2048
  s_add_u32 s65, s64, 61440
  buffer_load_dwordx4 v10, s[44:47], s65 offen lds
  s_add_u32 m0, s75, 4096
  s_add_u32 s65, s64, 122880
  buffer_load_dwordx4 v10, s[44:47], s65 offen lds
  s_add_u32 m0, s75, 6144
  s_add_u32 s65, s64, 184320
  buffer_load_dwordx4 v10, s[44:47], s65 offen lds
  s_add_u32 s64, s64, 245760
  s_add_u32 s75, s75, 8192
  s_add_u32 m0, s75, 0
  s_add_u32 s65, s64, 0
  buffer_load_dwordx4 v10, s[44:47], s65 offen lds
  s_add_u32 m0, s75, 2048
  s_add_u32 s65, s64, 61440
  buffer_load_dwordx4 v10, s[44:47], s65 offen lds
  s_add_u32 m0, s75, 4096
  s_add_u32 s65, s64, 122880
  buffer_load_dwordx4 v10, s[44:47], s65 offen lds
  s_add_u32 m0, s75, 6144
  s_add_u32 s65, s64, 184320
  buffer_load_dwordx4 v10, s[44:47], s65 offen lds
  s_add_u32 s64, s64, 245760
  s_add_u32 s75, s75, 8192
  s_waitcnt vmcnt(16)
  s_barrier
  s_add_u32 m0, s75, 0
  s_add_u32 s65, s64, 0
  buffer_load_dwordx4 v10, s[44:47], s65 offen lds
  s_add_u32 m0, s75, 2048
  s_add_u32 s65, s64, 61440
  buffer_load_dwordx4 v10, s[44:47], s65 offen lds
  s_add_u32 m0, s75, 4096
  s_add_u32 s65, s64, 122880
  buffer_load_dwordx4 v10, s[44:47], s65 offen lds
  s_add_u32 m0, s75, 6144
  s_add_u32 s65, s64, 184320
  buffer_load_dwordx4 v10, s[44:47], s65 offen lds
  s_add_u32 s64, s64, 245760
  s_add_u32 s75, s75, 8192
  s_add_u32 m0, s75, 0
  s_add_u32 s65, s64, 0
  buffer_load_dwordx4 v10, s[44:47], s65 offen lds
  s_add_u32 m0, s75, 2048
  s_add_u32 s65, s64, 61440
  buffer_load_dwordx4 v10, s[44:47], s65 offen lds
  s_add_u32 m0, s75, 4096
  s_add_u32 s65, s64, 122880
  buffer_load_dwordx4 v10, s[44:47], s65 offen lds
  s_add_u32 m0, s75, 6144
  s_add_u32 s65, s64, 184320
  buffer_load_dwordx4 v10, s[44:47], s65 offen lds
  s_add_u32 s64, s64, 245760
  s_add_u32 s75, s75, 8192
  s_waitcnt vmcnt(20)
  s_barrier
  s_add_u32 m0, s75, 0
  s_add_u32 s65, s64, 0
  buffer_load_dwordx4 v10, s[44:47], s65 offen lds
  s_add_u32 m0, s75, 2048
  s_add_u32 s65, s64, 61440
  buffer_load_dwordx4 v10, s[44:47], s65 offen lds
  s_add_u32 m0, s75, 4096
  s_add_u32 s65, s64, 122880
  buffer_load_dwordx4 v10, s[44:47], s65 offen lds
  s_add_u32 m0, s75, 6144
  s_add_u32 s65, s64, 184320
  buffer_load_dwordx4 v10, s[44:47], s65 offen lds
  s_add_u32 s64, s64, 245760
  s_add_u32 s75, s75, 8192
  s_add_u32 m0, s75, 0
  s_add_u32 s65, s64, 0
  buffer_load_dwordx4 v10, s[44:47], s65 offen lds
  s_add_u32 m0, s75, 2048
  s_add_u32 s65, s64, 61440
  buffer_load_dwordx4 v10, s[44:47], s65 offen lds
  s_add_u32 m0, s75, 4096
  s_add_u32 s65, s64, 122880
  buffer_load_dwordx4 v10, s[44:47], s65 offen lds
  s_add_u32 m0, s75, 6144
  s_add_u32 s65, s64, 184320
  buffer_load_dwordx4 v10, s[44:47], s65 offen lds
  s_add_u32 s64, s64, 245760
  s_add_u32 s75, s75, 8192
  s_waitcnt vmcnt(24)
  s_barrier
  s_waitcnt vmcnt(20)
  s_barrier
  s_waitcnt vmcnt(16)
  s_barrier
  s_waitcnt vmcnt(12)
  s_barrier
  s_waitcnt vmcnt(8)
  s_barrier
  s_waitcnt vmcnt(4)
  s_barrier
  s_waitcnt vmcnt(0)
  s_barrier
  s_mov_b32 s72, 0
L_ob_6:
  s_barrier
  s_add_u32 s72, s72, 1
  s_cmp_lt_u32 s72, 11
  s_cbranch_scc1 L_ob_6
  s_branch L_p1_done
L_qcomp_3:
  s_mov_b32 s40, s4
  s_mov_b32 s41, s5
  s_mov_b32 s42, 2621440
  s_mov_b32 s43, 0x20000
  s_mov_b32 s44, s6
  s_mov_b32 s45, s7
  s_mov_b32 s46, 2457600
  s_mov_b32 s47, 0x20000
  s_cmp_lg_u32 s2, 0
  s_cbranch_scc1 L_nozero_7
  s_cmp_lg_u32 s3, 1
  s_cbranch_scc1 L_nozero_7
  v_lshlrev_b32 v3, 8, v1
  v_mov_b32 v4, 0
  s_mov_b32 s34, 26681344
  buffer_store_dword v4, v3, s[24:27], s34 offen sc1
  s_mov_b32 s34, 26697728
  buffer_store_dword v4, v3, s[24:27], s34 offen sc1
  s_mov_b32 s34, 26714112
  buffer_store_dword v4, v3, s[24:27], s34 offen sc1
L_nozero_7:
  s_cmp_lg_u32 s3, 0
  s_cbranch_scc1 L_p0s_8
  s_cmp_ge_u32 s2, 240
  s_cbranch_scc1 L_p0e_9
  s_mov_b32 s35, 143165577
  s_mul_hi_u32 s84, s2, s35
  s_mul_i32 s35, s84, 30
  s_sub_u32 s85, s2, s35
  v_lshrrev_b32 v3, 3, v1
  s_movk_i32 s35, 3840
  v_mul_lo_u32 v3, v3, s35
  v_and_b32 v4, 7, v1
  v_lshl_add_u32 v3, v4, 4, v3
  s_mul_i32 s35, s84, 307200
  s_lshl_b32 s34, s85, 7
  s_add_u32 s35, s35, s34
  buffer_load_dwordx4 v[208:211], v3, s[44:47], s35 offen
  s_add_u32 s35, s35, 30720
  buffer_load_dwordx4 v[212:215], v3, s[44:47], s35 offen
  s_add_u32 s35, s35, 30720
  buffer_load_dwordx4 v[216:219], v3, s[44:47], s35 offen
  s_add_u32 s35, s35, 30720
  buffer_load_dwordx4 v[220:223], v3, s[44:47], s35 offen
  s_add_u32 s35, s35, 30720
  buffer_load_dwordx4 v[224:227], v3, s[44:47], s35 offen
  s_add_u32 s35, s35, 30720
  buffer_load_dwordx4 v[228:231], v3, s[44:47], s35 offen
  s_add_u32 s35, s35, 30720
  buffer_load_dwordx4 v[232:235], v3, s[44:47], s35 offen
  s_add_u32 s35, s35, 30720
  buffer_load_dwordx4 v[236:239], v3, s[44:47], s35 offen
  s_add_u32 s35, s35, 30720
  buffer_load_dwordx4 v[240:243], v3, s[44:47], s35 offen
  s_add_u32 s35, s35, 30720
  buffer_load_dwordx4 v[244:247], v3, s[44:47], s35 offen
  s_branch L_p0e_9
L_p0s_8:
  v_lshlrev_b32 v3, 2, v1
  s_mul_i32 s34, s3, 3
  s_add_u32 s34, s34, 0
  s_sub_u32 s34, s34, 3
  s_min_u32 s34, s34, 7
  s_lshl_b32 s35, s2, 3
  s_add_u32 s84, s34, s35
  s_mul_i32 s35, s84, 1280
  buffer_load_dword v208, v3, s[40:43], s35 offen offset:0
  buffer_load_dword v209, v3, s[40:43], s35 offen offset:256
  buffer_load_dword v210, v3, s[40:43], s35 offen offset:512
  buffer_load_dword v211, v3, s[40:43], s35 offen offset:768
  buffer_load_dword v212, v3, s[40:43], s35 offen offset:1024
  s_mul_i32 s34, s3, 3
  s_add_u32 s34, s34, 1
  s_sub_u32 s34, s34, 3
  s_min_u32 s34, s34, 7
  s_lshl_b32 s35, s2, 3
  s_add_u32 s85, s34, s35
  s_mul_i32 s35, s85, 1280
  buffer_load_dword v213, v3, s[40:43], s35 offen offset:0
  buffer_load_dword v214, v3, s[40:43], s35 offen offset:256
  buffer_load_dword v215, v3, s[40:43], s35 offen offset:512
  buffer_load_dword v216, v3, s[40:43], s35 offen offset:768
  buffer_load_dword v217, v3, s[40:43], s35 offen offset:1024
  s_mul_i32 s34, s3, 3
  s_add_u32 s34, s34, 2
  s_sub_u32 s34, s34, 3
  s_min_u32 s34, s34, 7
  s_lshl_b32 s35, s2, 3
  s_add_u32 s86, s34, s35
  s_mul_i32 s35, s86, 1280
  buffer_load_dword v218, v3, s[40:43], s35 offen offset:0
  buffer_load_dword v219, v3, s[40:43], s35 offen offset:256
  buffer_load_dword v220, v3, s[40:43], s35 offen offset:512
  buffer_load_dword v221, v3, s[40:43], s35 offen offset:768
  buffer_load_dword v222, v3, s[40:43], s35 offen offset:1024
L_p0e_9:
  s_cmp_lg_u32 s76, 1
  s_cbranch_scc1 L_nsp_10
  s_waitcnt vmcnt(0)
  s_cmp_lg_u32 s3, 0
  s_cbranch_scc1 L_p0s_11
  s_cmp_ge_u32 s2, 240
  s_cbranch_scc1 L_p0e_12
  v_mov_b32 v248, 0
  v_mov_b32 v249, 0
  v_mov_b32 v250, 0
  v_mov_b32 v251, 0
  v_mov_b32 v252, 0
  v_mov_b32 v253, 0
  v_mov_b32 v254, 0
  v_mov_b32 v255, 0
  v_lshlrev_b32 v16, 16, v208
  v_and_b32 v17, 0xffff0000, v208
  v_add_f32 v248, v248, v16
  v_add_f32 v249, v249, v17
  v_lshlrev_b32 v16, 16, v209
  v_and_b32 v17, 0xffff0000, v209
  v_add_f32 v250, v250, v16
  v_add_f32 v251, v251, v17
  v_lshlrev_b32 v16, 16, v210
  v_and_b32 v17, 0xffff0000, v210
  v_add_f32 v252, v252, v16
  v_add_f32 v253, v253, v17
  v_lshlrev_b32 v16, 16, v211
  v_and_b32 v17, 0xffff0000, v211
  v_add_f32 v254, v254, v16
  v_add_f32 v255, v255, v17
  v_lshlrev_b32 v16, 16, v212
  v_and_b32 v17, 0xffff0000, v212
  v_add_f32 v248, v248, v16
  v_add_f32 v249, v249, v17
  v_lshlrev_b32 v16, 16, v213
  v_and_b32 v17, 0xffff0000, v213
  v_add_f32 v250, v250, v16
  v_add_f32 v251, v251, v17
  v_lshlrev_b32 v16, 16, v214
  v_and_b32 v17, 0xffff0000, v214
  v_add_f32 v252, v252, v16
  v_add_f32 v253, v253, v17
  v_lshlrev_b32 v16, 16, v215
  v_and_b32 v17, 0xffff0000, v215
  v_add_f32 v254, v254, v16
  v_add_f32 v255, v255, v17
  v_lshlrev_b32 v16, 16, v216
  v_and_b32 v17, 0xffff0000, v216
  v_add_f32 v248, v248, v16
  v_add_f32 v249, v249, v17
  v_lshlrev_b32 v16, 16, v217
  v_and_b32 v17, 0xffff0000, v217
  v_add_f32 v250, v250, v16
  v_add_f32 v251, v251, v17
  v_lshlrev_b32 v16, 16, v218
  v_and_b32 v17, 0xffff0000, v218
  v_add_f32 v252, v252, v16
  v_add_f32 v253, v253, v17
  v_lshlrev_b32 v16, 16, v219
  v_and_b32 v17, 0xffff0000, v219
  v_add_f32 v254, v254, v16
  v_add_f32 v255, v255, v17
  v_lshlrev_b32 v16, 16, v220
  v_and_b32 v17, 0xffff0000, v220
  v_add_f32 v248, v248, v16
  v_add_f32 v249, v249, v17
  v_lshlrev_b32 v16, 16, v221
  v_and_b32 v17, 0xffff0000, v221
  v_add_f32 v250, v250, v16
  v_add_f32 v251, v251, v17
  v_lshlrev_b32 v16, 16, v222
  v_and_b32 v17, 0xffff0000, v222
  v_add_f32 v252, v252, v16
  v_add_f32 v253, v253, v17
  v_lshlrev_b32 v16, 16, v223
  v_and_b32 v17, 0xffff0000, v223
  v_add_f32 v254, v254, v16
  v_add_f32 v255, v255, v17
  v_lshlrev_b32 v16, 16, v224
  v_and_b32 v17, 0xffff0000, v224
  v_add_f32 v248, v248, v16
  v_add_f32 v249, v249, v17
  v_lshlrev_b32 v16, 16, v225
  v_and_b32 v17, 0xffff0000, v225
  v_add_f32 v250, v250, v16
  v_add_f32 v251, v251, v17
  v_lshlrev_b32 v16, 16, v226
  v_and_b32 v17, 0xffff0000, v226
  v_add_f32 v252, v252, v16
  v_add_f32 v253, v253, v17
  v_lshlrev_b32 v16, 16, v227
  v_and_b32 v17, 0xffff0000, v227
  v_add_f32 v254, v254, v16
  v_add_f32 v255, v255, v17
  v_lshlrev_b32 v16, 16, v228
  v_and_b32 v17, 0xffff0000, v228
  v_add_f32 v248, v248, v16
  v_add_f32 v249, v249, v17
  v_lshlrev_b32 v16, 16, v229
  v_and_b32 v17, 0xffff0000, v229
  v_add_f32 v250, v250, v16
  v_add_f32 v251, v251, v17
  v_lshlrev_b32 v16, 16, v230
  v_and_b32 v17, 0xffff0000, v230
  v_add_f32 v252, v252, v16
  v_add_f32 v253, v253, v17
  v_lshlrev_b32 v16, 16, v231
  v_and_b32 v17, 0xffff0000, v231
  v_add_f32 v254, v254, v16
  v_add_f32 v255, v255, v17
  v_lshlrev_b32 v16, 16, v232
  v_and_b32 v17, 0xffff0000, v232
  v_add_f32 v248, v248, v16
  v_add_f32 v249, v249, v17
  v_lshlrev_b32 v16, 16, v233
  v_and_b32 v17, 0xffff0000, v233
  v_add_f32 v250, v250, v16
  v_add_f32 v251, v251, v17
  v_lshlrev_b32 v16, 16, v234
  v_and_b32 v17, 0xffff0000, v234
  v_add_f32 v252, v252, v16
  v_add_f32 v253, v253, v17
  v_lshlrev_b32 v16, 16, v235
  v_and_b32 v17, 0xffff0000, v235
  v_add_f32 v254, v254, v16
  v_add_f32 v255, v255, v17
  v_lshlrev_b32 v16, 16, v236
  v_and_b32 v17, 0xffff0000, v236
  v_add_f32 v248, v248, v16
  v_add_f32 v249, v249, v17
  v_lshlrev_b32 v16, 16, v237
  v_and_b32 v17, 0xffff0000, v237
  v_add_f32 v250, v250, v16
  v_add_f32 v251, v251, v17
  v_lshlrev_b32 v16, 16, v238
  v_and_b32 v17, 0xffff0000, v238
  v_add_f32 v252, v252, v16
  v_add_f32 v253, v253, v17
  v_lshlrev_b32 v16, 16, v239
  v_and_b32 v17, 0xffff0000, v239
  v_add_f32 v254, v254, v16
  v_add_f32 v255, v255, v17
  v_lshlrev_b32 v16, 16, v240
  v_and_b32 v17, 0xffff0000, v240
  v_add_f32 v248, v248, v16
  v_add_f32 v249, v249, v17
  v_lshlrev_b32 v16, 16, v241
  v_and_b32 v17, 0xffff0000, v241
  v_add_f32 v250, v250, v16
  v_add_f32 v251, v251, v17
  v_lshlrev_b32 v16, 16, v242
  v_and_b32 v17, 0xffff0000, v242
  v_add_f32 v252, v252, v16
  v_add_f32 v253, v253, v17
  v_lshlrev_b32 v16, 16, v243
  v_and_b32 v17, 0xffff0000, v243
  v_add_f32 v254, v254, v16
  v_add_f32 v255, v255, v17
  v_lshlrev_b32 v16, 16, v244
  v_and_b32 v17, 0xffff0000, v244
  v_add_f32 v248, v248, v16
  v_add_f32 v249, v249, v17
  v_lshlrev_b32 v16, 16, v245
  v_and_b32 v17, 0xffff0000, v245
  v_add_f32 v250, v250, v16
  v_add_f32 v251, v251, v17
  v_lshlrev_b32 v16, 16, v246
  v_and_b32 v17, 0xffff0000, v246
  v_add_f32 v252, v252, v16
  v_add_f32 v253, v253, v17
  v_lshlrev_b32 v16, 16, v247
  v_and_b32 v17, 0xffff0000, v247
  v_add_f32 v254, v254, v16
  v_add_f32 v255, v255, v17
  v_add_f32_dpp v248, v248, v248 row_ror:8 row_mask:0xf bank_mask:0xf
  v_add_f32_dpp v249, v249, v249 row_ror:8 row_mask:0xf bank_mask:0xf
  v_add_f32_dpp v250, v250, v250 row_ror:8 row_mask:0xf bank_mask:0xf
  v_add_f32_dpp v251, v251, v251 row_ror:8 row_mask:0xf bank_mask:0xf
  v_add_f32_dpp v252, v252, v252 row_ror:8 row_mask:0xf bank_mask:0xf
  v_add_f32_dpp v253, v253, v253 row_ror:8 row_mask:0xf bank_mask:0xf
  v_add_f32_dpp v254, v254, v254 row_ror:8 row_mask:0xf bank_mask:0xf
  v_add_f32_dpp v255, v255, v255 row_ror:8 row_mask:0xf bank_mask:0xf
  v_mov_b32 v16, v248
  s_nop 1
  v_permlane16_swap_b32 v248, v16
  v_add_f32 v248, v248, v16
  v_mov_b32 v16, v249
  s_nop 1
  v_permlane16_swap_b32 v249, v16
  v_add_f32 v249, v249, v16
  v_mov_b32 v16, v250
  s_nop 1
  v_permlane16_swap_b32 v250, v16
  v_add_f32 v250, v250, v16
  v_mov_b32 v16, v251
  s_nop 1
  v_permlane16_swap_b32 v251, v16
  v_add_f32 v251, v251, v16
  v_mov_b32 v16, v252
  s_nop 1
  v_permlane16_swap_b32 v252, v16
  v_add_f32 v252, v252, v16
  v_mov_b32 v16, v253
  s_nop 1
  v_permlane16_swap_b32 v253, v16
  v_add_f32 v253, v253, v16
  v_mov_b32 v16, v254
  s_nop 1
  v_permlane16_swap_b32 v254, v16
  v_add_f32 v254, v254, v16
  v_mov_b32 v16, v255
  s_nop 1
  v_permlane16_swap_b32 v255, v16
  v_add_f32 v255, v255, v16
  v_mov_b32 v16, v248
  s_nop 1
  v_permlane32_swap_b32 v248, v16
  v_add_f32 v248, v248, v16
  v_mov_b32 v16, v249
  s_nop 1
  v_permlane32_swap_b32 v249, v16
  v_add_f32 v249, v249, v16
  v_mov_b32 v16, v250
  s_nop 1
  v_permlane32_swap_b32 v250, v16
  v_add_f32 v250, v250, v16
  v_mov_b32 v16, v251
  s_nop 1
  v_permlane32_swap_b32 v251, v16
  v_add_f32 v251, v251, v16
  v_mov_b32 v16, v252
  s_nop 1
  v_permlane32_swap_b32 v252, v16
  v_add_f32 v252, v252, v16
  v_mov_b32 v16, v253
  s_nop 1
  v_permlane32_swap_b32 v253, v16
  v_add_f32 v253, v253, v16
  v_mov_b32 v16, v254
  s_nop 1
  v_permlane32_swap_b32 v254, v16
  v_add_f32 v254, v254, v16
  v_mov_b32 v16, v255
  s_nop 1
  v_permlane32_swap_b32 v255, v16
  v_add_f32 v255, v255, v16
  s_mul_i32 s34, s84, 7680
  s_lshl_b32 s35, s85, 8
  s_add_u32 s34, s34, s35
  s_add_u32 s34, s34, 26374144
  v_lshlrev_b32 v16, 5, v1
  s_mov_b64 exec, 0xff
  buffer_store_dwordx4 v[248:251], v16, s[24:27], s34 offen sc1
  buffer_store_dwordx4 v[252:255], v16, s[24:27], s34 offen offset:16 sc1
  s_mov_b64 exec, -1
  s_branch L_p0e_12
L_p0s_11:
  v_mov_b32 v224, 0
  v_mov_b32 v225, 0
  v_mov_b32 v226, 0
  v_mov_b32 v227, 0
  v_mov_b32 v228, 0
  v_mov_b32 v229, 0
  v_and_b32 v16, 0xffff0000, v208
  v_lshlrev_b32 v17, 16, v208
  v_add_f32 v224, v224, v16
  v_fmac_f32 v225, v16, v16
  v_add_f32 v224, v224, v17
  v_fmac_f32 v225, v17, v17
  v_and_b32 v16, 0xffff0000, v209
  v_lshlrev_b32 v17, 16, v209
  v_add_f32 v224, v224, v16
  v_fmac_f32 v225, v16, v16
  v_add_f32 v224, v224, v17
  v_fmac_f32 v225, v17, v17
  v_and_b32 v16, 0xffff0000, v210
  v_lshlrev_b32 v17, 16, v210
  v_add_f32 v224, v224, v16
  v_fmac_f32 v225, v16, v16
  v_add_f32 v224, v224, v17
  v_fmac_f32 v225, v17, v17
  v_and_b32 v16, 0xffff0000, v211
  v_lshlrev_b32 v17, 16, v211
  v_add_f32 v224, v224, v16
  v_fmac_f32 v225, v16, v16
  v_add_f32 v224, v224, v17
  v_fmac_f32 v225, v17, v17
  v_and_b32 v16, 0xffff0000, v212
  v_lshlrev_b32 v17, 16, v212
  v_add_f32 v224, v224, v16
  v_fmac_f32 v225, v16, v16
  v_add_f32 v224, v224, v17
  v_fmac_f32 v225, v17, v17
  v_and_b32 v16, 0xffff0000, v213
  v_lshlrev_b32 v17, 16, v213
  v_add_f32 v226, v226, v16
  v_fmac_f32 v227, v16, v16
  v_add_f32 v226, v226, v17
  v_fmac_f32 v227, v17, v17
  v_and_b32 v16, 0xffff0000, v214
  v_lshlrev_b32 v17, 16, v214
  v_add_f32 v226, v226, v16
  v_fmac_f32 v227, v16, v16
  v_add_f32 v226, v226, v17
  v_fmac_f32 v227, v17, v17
  v_and_b32 v16, 0xffff0000, v215
  v_lshlrev_b32 v17, 16, v215
  v_add_f32 v226, v226, v16
  v_fmac_f32 v227, v16, v16
  v_add_f32 v226, v226, v17
  v_fmac_f32 v227, v17, v17
  v_and_b32 v16, 0xffff0000, v216
  v_lshlrev_b32 v17, 16, v216
  v_add_f32 v226, v226, v16
  v_fmac_f32 v227, v16, v16
  v_add_f32 v226, v226, v17
  v_fmac_f32 v227, v17, v17
  v_and_b32 v16, 0xffff0000, v217
  v_lshlrev_b32 v17, 16, v217
  v_add_f32 v226, v226, v16
  v_fmac_f32 v227, v16, v16
  v_add_f32 v226, v226, v17
  v_fmac_f32 v227, v17, v17
  v_and_b32 v16, 0xffff0000, v218
  v_lshlrev_b32 v17, 16, v218
  v_add_f32 v228, v228, v16
  v_fmac_f32 v229, v16, v16
  v_add_f32 v228, v228, v17
  v_fmac_f32 v229, v17, v17
  v_and_b32 v16, 0xffff0000, v219
  v_lshlrev_b32 v17, 16, v219
  v_add_f32 v228, v228, v16
  v_fmac_f32 v229, v16, v16
  v_add_f32 v228, v228, v17
  v_fmac_f32 v229, v17, v17
  v_and_b32 v16, 0xffff0000, v220
  v_lshlrev_b32 v17, 16, v220
  v_add_f32 v228, v228, v16
  v_fmac_f32 v229, v16, v16
  v_add_f32 v228, v228, v17
  v_fmac_f32 v229, v17, v17
  v_and_b32 v16, 0xffff0000, v221
  v_lshlrev_b32 v17, 16, v221
  v_add_f32 v228, v228, v16
  v_fmac_f32 v229, v16, v16
  v_add_f32 v228, v228, v17
  v_fmac_f32 v229, v17, v17
  v_and_b32 v16, 0xffff0000, v222
  v_lshlrev_b32 v17, 16, v222
  v_add_f32 v228, v228, v16
  v_fmac_f32 v229, v16, v16
  v_add_f32 v228, v228, v17
  v_fmac_f32 v229, v17, v17
  v_add_f32_dpp v224, v224, v224 row_ror:8 row_mask:0xf bank_mask:0xf
  v_add_f32_dpp v225, v225, v225 row_ror:8 row_mask:0xf bank_mask:0xf
  v_add_f32_dpp v226, v226, v226 row_ror:8 row_mask:0xf bank_mask:0xf
  v_add_f32_dpp v227, v227, v227 row_ror:8 row_mask:0xf bank_mask:0xf
  v_add_f32_dpp v228, v228, v228 row_ror:8 row_mask:0xf bank_mask:0xf
  v_add_f32_dpp v229, v229, v229 row_ror:8 row_mask:0xf bank_mask:0xf
  v_add_f32_dpp v224, v224, v224 row_ror:4 row_mask:0xf bank_mask:0xf
  v_add_f32_dpp v225, v225, v225 row_ror:4 row_mask:0xf bank_mask:0xf
  v_add_f32_dpp v226, v226, v226 row_ror:4 row_mask:0xf bank_mask:0xf
  v_add_f32_dpp v227, v227, v227 row_ror:4 row_mask:0xf bank_mask:0xf
  v_add_f32_dpp v228, v228, v228 row_ror:4 row_mask:0xf bank_mask:0xf
  v_add_f32_dpp v229, v229, v229 row_ror:4 row_mask:0xf bank_mask:0xf
  v_add_f32_dpp v224, v224, v224 row_ror:2 row_mask:0xf bank_mask:0xf
  v_add_f32_dpp v225, v225, v225 row_ror:2 row_mask:0xf bank_mask:0xf
  v_add_f32_dpp v226, v226, v226 row_ror:2 row_mask:0xf bank_mask:0xf
  v_add_f32_dpp v227, v227, v227 row_ror:2 row_mask:0xf bank_mask:0xf
  v_add_f32_dpp v228, v228, v228 row_ror:2 row_mask:0xf bank_mask:0xf
  v_add_f32_dpp v229, v229, v229 row_ror:2 row_mask:0xf bank_mask:0xf
  v_add_f32_dpp v224, v224, v224 row_ror:1 row_mask:0xf bank_mask:0xf
  v_add_f32_dpp v225, v225, v225 row_ror:1 row_mask:0xf bank_mask:0xf
  v_add_f32_dpp v226, v226, v226 row_ror:1 row_mask:0xf bank_mask:0xf
  v_add_f32_dpp v227, v227, v227 row_ror:1 row_mask:0xf bank_mask:0xf
  v_add_f32_dpp v228, v228, v228 row_ror:1 row_mask:0xf bank_mask:0xf
  v_add_f32_dpp v229, v229, v229 row_ror:1 row_mask:0xf bank_mask:0xf
  v_mov_b32 v16, v224
  s_nop 1
  v_permlane16_swap_b32 v224, v16
  v_add_f32 v224, v224, v16
  v_mov_b32 v16, v225
  s_nop 1
  v_permlane16_swap_b32 v225, v16
  v_add_f32 v225, v225, v16
  v_mov_b32 v16, v226
  s_nop 1
  v_permlane16_swap_b32 v226, v16
  v_add_f32 v226, v226, v16
  v_mov_b32 v16, v227
  s_nop 1
  v_permlane16_swap_b32 v227, v16
  v_add_f32 v227, v227, v16
  v_mov_b32 v16, v228
  s_nop 1
  v_permlane16_swap_b32 v228, v16
  v_add_f32 v228, v228, v16
  v_mov_b32 v16, v229
  s_nop 1
  v_permlane16_swap_b32 v229, v16
  v_add_f32 v229, v229, v16
  v_mov_b32 v16, v224
  s_nop 1
  v_permlane32_swap_b32 v224, v16
  v_add_f32 v224, v224, v16
  v_mov_b32 v16, v225
  s_nop 1
  v_permlane32_swap_b32 v225, v16
  v_add_f32 v225, v225, v16
  v_mov_b32 v16, v226
  s_nop 1
  v_permlane32_swap_b32 v226, v16
  v_add_f32 v226, v226, v16
  v_mov_b32 v16, v227
  s_nop 1
  v_permlane32_swap_b32 v227, v16
  v_add_f32 v227, v227, v16
  v_mov_b32 v16, v228
  s_nop 1
  v_permlane32_swap_b32 v228, v16
  v_add_f32 v228, v228, v16
  v_mov_b32 v16, v229
  s_nop 1
  v_permlane32_swap_b32 v229, v16
  v_add_f32 v229, v229, v16
  v_mul_f32 v16, 0x3acccccd, v224
  v_mul_f32 v17, 0x3acccccd, v225
  v_fma_f32 v17, -v16, v16, v17
  v_max_f32 v17, 0, v17
  v_add_f32 v17, 0x3727c5ac, v17
  v_rsq_f32 v232, v17
  s_nop 0
  v_mul_f32 v233, v16, v232
  v_sub_f32 v233, 0, v233
  s_lshl_b32 s34, s84, 3
  s_add_u32 s34, s34, 26357760
  v_mov_b32 v16, 0
  s_mov_b64 exec, 1
  buffer_store_dwordx2 v[232:233], v16, s[24:27], s34 offen sc1
  s_mov_b64 exec, -1
  v_mul_f32 v16, 0x3acccccd, v226
  v_mul_f32 v17, 0x3acccccd, v227
  v_fma_f32 v17, -v16, v16, v17
  v_max_f32 v17, 0, v17
  v_add_f32 v17, 0x3727c5ac, v17
  v_rsq_f32 v234, v17
  s_nop 0
  v_mul_f32 v235, v16, v234
  v_sub_f32 v235, 0, v235
  s_lshl_b32 s34, s85, 3
  s_add_u32 s34, s34, 26357760
  v_mov_b32 v16, 0
  s_mov_b64 exec, 1
  buffer_store_dwordx2 v[234:235], v16, s[24:27], s34 offen sc1
  s_mov_b64 exec, -1
  v_mul_f32 v16, 0x3acccccd, v228
  v_mul_f32 v17, 0x3acccccd, v229
  v_fma_f32 v17, -v16, v16, v17
  v_max_f32 v17, 0, v17
  v_add_f32 v17, 0x3727c5ac, v17
  v_rsq_f32 v236, v17
  s_nop 0
  v_mul_f32 v237, v16, v236
  v_sub_f32 v237, 0, v237
  s_lshl_b32 s34, s86, 3
  s_add_u32 s34, s34, 26357760
  v_mov_b32 v16, 0
  s_mov_b64 exec, 1
  buffer_store_dwordx2 v[236:237], v16, s[24:27], s34 offen sc1
  s_mov_b64 exec, -1
L_p0e_12:
  s_branch L_spare_2
L_nsp_10:
  s_lshr_b32 s36, s3, 1
  s_and_b32 s37, s3, 1
  v_and_b32 v3, 31, v1
  v_lshrrev_b32 v4, 5, v1
  v_bfe_u32 v5, v3, 1, 3
  v_xor_b32 v5, v5, v4
  v_lshlrev_b32 v5, 4, v5
  v_lshl_add_u32 v5, v3, 7, v5
  s_lshl_b32 s34, s36, 13
  s_add_u32 s34, s34, 81920
  v_add_u32 v5, s34, v5
  v_mov_b32 v48, v5
  v_xor_b32 v49, 32, v5
  v_xor_b32 v50, 64, v5
  v_xor_b32 v51, 96, v5
  v_bfe_u32 v5, v1, 2, 2
  v_lshl_add_u32 v6, v4, 3, v5
  v_lshlrev_b32 v6, 7, v6
  v_bfe_u32 v7, v1, 4, 1
  v_bfe_u32 v8, v1, 1, 1
  v_lshl_add_u32 v7, v7, 1, v8
  s_lshl_b32 s34, s37, 2
  v_add_u32 v7, s34, v7
  v_bfe_u32 v8, v5, 1, 1
  v_lshlrev_b32 v8, 2, v8
  v_xor_b32 v7, v7, v8
  v_and_b32 v8, 1, v1
  v_lshlrev_b32 v8, 3, v8
  v_lshl_add_u32 v7, v7, 4, v8
  v_add_u32 v56, v6, v7
  v_add_u32 v57, 40960, v56
  s_mov_b32 s61, 4294901760
  s_mov_b32 s58, 0
  s_mov_b32 s62, 0
  s_cmp_ge_u32 s33, 20
  s_cbranch_scc1 L_qv_4
  s_mov_b32 s51, 1.0
  s_mov_b32 s48, 163840
  s_movk_i32 s49, 2560
  s_mov_b32 s50, 2621440
  s_sub_u32 s54, s33, 10
  s_cmp_ge_u32 s33, 10
  s_cbranch_scc1 L_isk_13
  s_mov_b32 s51, 0x3ea52b5c
  s_mov_b32 s48, 81920
  s_movk_i32 s49, 1280
  s_mov_b32 s50, 0
  s_mov_b32 s54, s33
L_isk_13:
  v_and_b32 v3, 31, v1
  v_lshrrev_b32 v4, 5, v1
  s_lshl_b32 s54, s54, 4
  v_lshlrev_b32 v9, 4, v3
  v_lshlrev_b32 v10, 3, v3
  v_add_u32 v10, 1024, v10
  s_movk_i32 s35, 205
  s_lshl_b32 s34, s37, 3
  s_add_u32 s34, s34, s54
  s_add_u32 s34, s34, 0
  v_add_u32 v11, s34, v4
  v_mul_u32_u24 v12, s35, v11
  v_lshrrev_b32 v12, 10, v12
  v_mul_u32_u24 v13, 5, v12
  v_sub_u32 v11, v11, v13
  v_lshrrev_b32 v13, 1, v11
  v_lshl_add_u32 v13, v13, 9, v9
  v_and_b32 v14, 1, v11
  v_lshl_add_u32 v13, v14, 3, v13
  v_cmp_eq_u32 vcc, 4, v11
  s_nop 1
  v_cndmask_b32 v13, v13, v10, vcc
  v_mul_lo_u32 v12, v12, s48
  v_add_u32 v72, v12, v13
  s_lshl_b32 s34, s37, 3
  s_add_u32 s34, s34, s54
  s_add_u32 s34, s34, 2
  v_add_u32 v11, s34, v4
  v_mul_u32_u24 v12, s35, v11
  v_lshrrev_b32 v12, 10, v12
  v_mul_u32_u24 v13, 5, v12
  v_sub_u32 v11, v11, v13
  v_lshrrev_b32 v13, 1, v11
  v_lshl_add_u32 v13, v13, 9, v9
  v_and_b32 v14, 1, v11
  v_lshl_add_u32 v13, v14, 3, v13
  v_cmp_eq_u32 vcc, 4, v11
  s_nop 1
  v_cndmask_b32 v13, v13, v10, vcc
  v_mul_lo_u32 v12, v12, s48
  v_add_u32 v73, v12, v13
  s_lshl_b32 s34, s37, 3
  s_add_u32 s34, s34, s54
  s_add_u32 s34, s34, 4
  v_add_u32 v11, s34, v4
  v_mul_u32_u24 v12, s35, v11
  v_lshrrev_b32 v12, 10, v12
  v_mul_u32_u24 v13, 5, v12
  v_sub_u32 v11, v11, v13
  v_lshrrev_b32 v13, 1, v11
  v_lshl_add_u32 v13, v13, 9, v9
  v_and_b32 v14, 1, v11
  v_lshl_add_u32 v13, v14, 3, v13
  v_cmp_eq_u32 vcc, 4, v11
  s_nop 1
  v_cndmask_b32 v13, v13, v10, vcc
  v_mul_lo_u32 v12, v12, s48
  v_add_u32 v74, v12, v13
  s_lshl_b32 s34, s37, 3
  s_add_u32 s34, s34, s54
  s_add_u32 s34, s34, 6
  v_add_u32 v11, s34, v4
  v_mul_u32_u24 v12, s35, v11
  v_lshrrev_b32 v12, 10, v12
  v_mul_u32_u24 v13, 5, v12
  v_sub_u32 v11, v11, v13
  v_lshrrev_b32 v13, 1, v11
  v_lshl_add_u32 v13, v13, 9, v9
  v_and_b32 v14, 1, v11
  v_lshl_add_u32 v13, v14, 3, v13
  v_cmp_eq_u32 vcc, 4, v11
  s_nop 1
  v_cndmask_b32 v13, v13, v10, vcc
  v_mul_lo_u32 v12, v12, s48
  v_add_u32 v75, v12, v13
  v_mov_b32 v80, 0
  v_mov_b32 v81, 0
  v_mov_b32 v82, 0
  v_mov_b32 v83, 0
  v_mov_b32 v84, 0
  v_mov_b32 v85, 0
  v_mov_b32 v86, 0
  v_mov_b32 v87, 0
  v_mov_b32 v88, 0
  v_mov_b32 v89, 0
  v_mov_b32 v90, 0
  v_mov_b32 v91, 0
  v_mov_b32 v92, 0
  v_mov_b32 v93, 0
  v_mov_b32 v94, 0
  v_mov_b32 v95, 0
  v_mov_b32 v96, 0
  v_mov_b32 v97, 0
  v_mov_b32 v98, 0
  v_mov_b32 v99, 0
  v_mov_b32 v100, 0
  v_mov_b32 v101, 0
  v_mov_b32 v102, 0
  v_mov_b32 v103, 0
  v_mov_b32 v104, 0
  v_mov_b32 v105, 0
  v_mov_b32 v106, 0
  v_mov_b32 v107, 0
  v_mov_b32 v108, 0
  v_mov_b32 v109, 0
  v_mov_b32 v110, 0
  v_mov_b32 v111, 0
  v_mov_b32 v112, 0
  v_mov_b32 v113, 0
  v_mov_b32 v114, 0
  v_mov_b32 v115, 0
  v_mov_b32 v116, 0
  v_mov_b32 v117, 0
  v_mov_b32 v118, 0
  v_mov_b32 v119, 0
  v_mov_b32 v120, 0
  v_mov_b32 v121, 0
  v_mov_b32 v122, 0
  v_mov_b32 v123, 0
  v_mov_b32 v124, 0
  v_mov_b32 v125, 0
  v_mov_b32 v126, 0
  v_mov_b32 v127, 0
  v_mov_b32 v128, 0
  v_mov_b32 v129, 0
  v_mov_b32 v130, 0
  v_mov_b32 v131, 0
  v_mov_b32 v132, 0
  v_mov_b32 v133, 0
  v_mov_b32 v134, 0
  v_mov_b32 v135, 0
  v_mov_b32 v136, 0
  v_mov_b32 v137, 0
  v_mov_b32 v138, 0
  v_mov_b32 v139, 0
  v_mov_b32 v140, 0
  v_mov_b32 v141, 0
  v_mov_b32 v142, 0
  v_mov_b32 v143, 0
  s_barrier
  ds_read_b128 v[144:147], v48 offset:0
  ds_read_b128 v[148:151], v48 offset:4096
  ds_read_b64_tr_b16 v[152:153], v56 offset:0
  ds_read_b64_tr_b16 v[154:155], v56 offset:512
  ds_read_b128 v[156:159], v49 offset:0
  ds_read_b128 v[160:163], v49 offset:4096
  ds_read_b64_tr_b16 v[164:165], v56 offset:2048
  ds_read_b64_tr_b16 v[166:167], v56 offset:2560
  s_waitcnt lgkmcnt(4)
  v_mfma_f32_32x32x16_bf16 v[80:95], v[152:155], v[144:147], v[80:95]
  ds_read_b128 v[168:171], v50 offset:0
  ds_read_b128 v[172:175], v50 offset:4096
  v_mfma_f32_32x32x16_bf16 v[96:111], v[152:155], v[148:151], v[96:111]
  ds_read_b64_tr_b16 v[176:177], v56 offset:4096
  ds_read_b64_tr_b16 v[178:179], v56 offset:4608
  s_waitcnt lgkmcnt(4)
  v_mfma_f32_32x32x16_bf16 v[80:95], v[164:167], v[156:159], v[80:95]
  ds_read_b128 v[180:183], v51 offset:0
  ds_read_b128 v[184:187], v51 offset:4096
  v_mfma_f32_32x32x16_bf16 v[96:111], v[164:167], v[160:163], v[96:111]
  ds_read_b64_tr_b16 v[188:189], v56 offset:6144
  ds_read_b64_tr_b16 v[190:191], v56 offset:6656
  s_waitcnt lgkmcnt(4)
  s_barrier
  s_add_u32 s58, s58, 1
  s_cmp_eq_u32 s58, 5
  s_cselect_b32 s59, s61, 16384
  s_cselect_b32 s58, 0, s58
  v_add_u32 v48, s59, v48
  v_add_u32 v49, s59, v49
  v_add_u32 v50, s59, v50
  v_add_u32 v51, s59, v51
  v_mfma_f32_32x32x16_bf16 v[80:95], v[176:179], v[168:171], v[80:95]
  ds_read_b128 v[144:147], v48 offset:0
  ds_read_b128 v[148:151], v48 offset:4096
  v_mfma_f32_32x32x16_bf16 v[96:111], v[176:179], v[172:175], v[96:111]
  ds_read_b64_tr_b16 v[152:153], v56 offset:8192
  ds_read_b64_tr_b16 v[154:155], v56 offset:8704
  s_waitcnt lgkmcnt(4)
  v_mfma_f32_32x32x16_bf16 v[80:95], v[188:191], v[180:183], v[80:95]
  ds_read_b128 v[156:159], v49 offset:0
  ds_read_b128 v[160:163], v49 offset:4096
  v_mfma_f32_32x32x16_bf16 v[96:111], v[188:191], v[184:187], v[96:111]
  ds_read_b64_tr_b16 v[164:165], v56 offset:10240
  ds_read_b64_tr_b16 v[166:167], v56 offset:10752
  s_waitcnt vmcnt(0)
  s_cmp_lg_u32 s3, 0
  s_cbranch_scc1 L_p0s_14
  s_cmp_ge_u32 s2, 240
  s_cbranch_scc1 L_p0e_15
  v_mov_b32 v248, 0
  v_mov_b32 v249, 0
  v_mov_b32 v250, 0
  v_mov_b32 v251, 0
  v_mov_b32 v252, 0
  v_mov_b32 v253, 0
  v_mov_b32 v254, 0
  v_mov_b32 v255, 0
  v_lshlrev_b32 v16, 16, v208
  v_and_b32 v17, 0xffff0000, v208
  v_add_f32 v248, v248, v16
  v_add_f32 v249, v249, v17
  v_lshlrev_b32 v16, 16, v209
  v_and_b32 v17, 0xffff0000, v209
  v_add_f32 v250, v250, v16
  v_add_f32 v251, v251, v17
  v_lshlrev_b32 v16, 16, v210
  v_and_b32 v17, 0xffff0000, v210
  v_add_f32 v252, v252, v16
  v_add_f32 v253, v253, v17
  v_lshlrev_b32 v16, 16, v211
  v_and_b32 v17, 0xffff0000, v211
  v_add_f32 v254, v254, v16
  v_add_f32 v255, v255, v17
  v_lshlrev_b32 v16, 16, v212
  v_and_b32 v17, 0xffff0000, v212
  v_add_f32 v248, v248, v16
  v_add_f32 v249, v249, v17
  v_lshlrev_b32 v16, 16, v213
  v_and_b32 v17, 0xffff0000, v213
  v_add_f32 v250, v250, v16
  v_add_f32 v251, v251, v17
  v_lshlrev_b32 v16, 16, v214
  v_and_b32 v17, 0xffff0000, v214
  v_add_f32 v252, v252, v16
  v_add_f32 v253, v253, v17
  v_lshlrev_b32 v16, 16, v215
  v_and_b32 v17, 0xffff0000, v215
  v_add_f32 v254, v254, v16
  v_add_f32 v255, v255, v17
  v_lshlrev_b32 v16, 16, v216
  v_and_b32 v17, 0xffff0000, v216
  v_add_f32 v248, v248, v16
  v_add_f32 v249, v249, v17
  v_lshlrev_b32 v16, 16, v217
  v_and_b32 v17, 0xffff0000, v217
  v_add_f32 v250, v250, v16
  v_add_f32 v251, v251, v17
  v_lshlrev_b32 v16, 16, v218
  v_and_b32 v17, 0xffff0000, v218
  v_add_f32 v252, v252, v16
  v_add_f32 v253, v253, v17
  v_lshlrev_b32 v16, 16, v219
  v_and_b32 v17, 0xffff0000, v219
  v_add_f32 v254, v254, v16
  v_add_f32 v255, v255, v17
  v_lshlrev_b32 v16, 16, v220
  v_and_b32 v17, 0xffff0000, v220
  v_add_f32 v248, v248, v16
  v_add_f32 v249, v249, v17
  v_lshlrev_b32 v16, 16, v221
  v_and_b32 v17, 0xffff0000, v221
  v_add_f32 v250, v250, v16
  v_add_f32 v251, v251, v17
  v_lshlrev_b32 v16, 16, v222
  v_and_b32 v17, 0xffff0000, v222
  v_add_f32 v252, v252, v16
  v_add_f32 v253, v253, v17
  v_lshlrev_b32 v16, 16, v223
  v_and_b32 v17, 0xffff0000, v223
  v_add_f32 v254, v254, v16
  v_add_f32 v255, v255, v17
  v_lshlrev_b32 v16, 16, v224
  v_and_b32 v17, 0xffff0000, v224
  v_add_f32 v248, v248, v16
  v_add_f32 v249, v249, v17
  v_lshlrev_b32 v16, 16, v225
  v_and_b32 v17, 0xffff0000, v225
  v_add_f32 v250, v250, v16
  v_add_f32 v251, v251, v17
  v_lshlrev_b32 v16, 16, v226
  v_and_b32 v17, 0xffff0000, v226
  v_add_f32 v252, v252, v16
  v_add_f32 v253, v253, v17
  v_lshlrev_b32 v16, 16, v227
  v_and_b32 v17, 0xffff0000, v227
  v_add_f32 v254, v254, v16
  v_add_f32 v255, v255, v17
  v_lshlrev_b32 v16, 16, v228
  v_and_b32 v17, 0xffff0000, v228
  v_add_f32 v248, v248, v16
  v_add_f32 v249, v249, v17
  v_lshlrev_b32 v16, 16, v229
  v_and_b32 v17, 0xffff0000, v229
  v_add_f32 v250, v250, v16
  v_add_f32 v251, v251, v17
  v_lshlrev_b32 v16, 16, v230
  v_and_b32 v17, 0xffff0000, v230
  v_add_f32 v252, v252, v16
  v_add_f32 v253, v253, v17
  v_lshlrev_b32 v16, 16, v231
  v_and_b32 v17, 0xffff0000, v231
  v_add_f32 v254, v254, v16
  v_add_f32 v255, v255, v17
  v_lshlrev_b32 v16, 16, v232
  v_and_b32 v17, 0xffff0000, v232
  v_add_f32 v248, v248, v16
  v_add_f32 v249, v249, v17
  v_lshlrev_b32 v16, 16, v233
  v_and_b32 v17, 0xffff0000, v233
  v_add_f32 v250, v250, v16
  v_add_f32 v251, v251, v17
  v_lshlrev_b32 v16, 16, v234
  v_and_b32 v17, 0xffff0000, v234
  v_add_f32 v252, v252, v16
  v_add_f32 v253, v253, v17
  v_lshlrev_b32 v16, 16, v235
  v_and_b32 v17, 0xffff0000, v235
  v_add_f32 v254, v254, v16
  v_add_f32 v255, v255, v17
  v_lshlrev_b32 v16, 16, v236
  v_and_b32 v17, 0xffff0000, v236
  v_add_f32 v248, v248, v16
  v_add_f32 v249, v249, v17
  v_lshlrev_b32 v16, 16, v237
  v_and_b32 v17, 0xffff0000, v237
  v_add_f32 v250, v250, v16
  v_add_f32 v251, v251, v17
  v_lshlrev_b32 v16, 16, v238
  v_and_b32 v17, 0xffff0000, v238
  v_add_f32 v252, v252, v16
  v_add_f32 v253, v253, v17
  v_lshlrev_b32 v16, 16, v239
  v_and_b32 v17, 0xffff0000, v239
  v_add_f32 v254, v254, v16
  v_add_f32 v255, v255, v17
  v_lshlrev_b32 v16, 16, v240
  v_and_b32 v17, 0xffff0000, v240
  v_add_f32 v248, v248, v16
  v_add_f32 v249, v249, v17
  v_lshlrev_b32 v16, 16, v241
  v_and_b32 v17, 0xffff0000, v241
  v_add_f32 v250, v250, v16
  v_add_f32 v251, v251, v17
  v_lshlrev_b32 v16, 16, v242
  v_and_b32 v17, 0xffff0000, v242
  v_add_f32 v252, v252, v16
  v_add_f32 v253, v253, v17
  v_lshlrev_b32 v16, 16, v243
  v_and_b32 v17, 0xffff0000, v243
  v_add_f32 v254, v254, v16
  v_add_f32 v255, v255, v17
  v_lshlrev_b32 v16, 16, v244
  v_and_b32 v17, 0xffff0000, v244
  v_add_f32 v248, v248, v16
  v_add_f32 v249, v249, v17
  v_lshlrev_b32 v16, 16, v245
  v_and_b32 v17, 0xffff0000, v245
  v_add_f32 v250, v250, v16
  v_add_f32 v251, v251, v17
  v_lshlrev_b32 v16, 16, v246
  v_and_b32 v17, 0xffff0000, v246
  v_add_f32 v252, v252, v16
  v_add_f32 v253, v253, v17
  v_lshlrev_b32 v16, 16, v247
  v_and_b32 v17, 0xffff0000, v247
  v_add_f32 v254, v254, v16
  v_add_f32 v255, v255, v17
  v_add_f32_dpp v248, v248, v248 row_ror:8 row_mask:0xf bank_mask:0xf
  v_add_f32_dpp v249, v249, v249 row_ror:8 row_mask:0xf bank_mask:0xf
  v_add_f32_dpp v250, v250, v250 row_ror:8 row_mask:0xf bank_mask:0xf
  v_add_f32_dpp v251, v251, v251 row_ror:8 row_mask:0xf bank_mask:0xf
  v_add_f32_dpp v252, v252, v252 row_ror:8 row_mask:0xf bank_mask:0xf
  v_add_f32_dpp v253, v253, v253 row_ror:8 row_mask:0xf bank_mask:0xf
  v_add_f32_dpp v254, v254, v254 row_ror:8 row_mask:0xf bank_mask:0xf
  v_add_f32_dpp v255, v255, v255 row_ror:8 row_mask:0xf bank_mask:0xf
  v_mov_b32 v16, v248
  s_nop 1
  v_permlane16_swap_b32 v248, v16
  v_add_f32 v248, v248, v16
  v_mov_b32 v16, v249
  s_nop 1
  v_permlane16_swap_b32 v249, v16
  v_add_f32 v249, v249, v16
  v_mov_b32 v16, v250
  s_nop 1
  v_permlane16_swap_b32 v250, v16
  v_add_f32 v250, v250, v16
  v_mov_b32 v16, v251
  s_nop 1
  v_permlane16_swap_b32 v251, v16
  v_add_f32 v251, v251, v16
  v_mov_b32 v16, v252
  s_nop 1
  v_permlane16_swap_b32 v252, v16
  v_add_f32 v252, v252, v16
  v_mov_b32 v16, v253
  s_nop 1
  v_permlane16_swap_b32 v253, v16
  v_add_f32 v253, v253, v16
  v_mov_b32 v16, v254
  s_nop 1
  v_permlane16_swap_b32 v254, v16
  v_add_f32 v254, v254, v16
  v_mov_b32 v16, v255
  s_nop 1
  v_permlane16_swap_b32 v255, v16
  v_add_f32 v255, v255, v16
  v_mov_b32 v16, v248
  s_nop 1
  v_permlane32_swap_b32 v248, v16
  v_add_f32 v248, v248, v16
  v_mov_b32 v16, v249
  s_nop 1
  v_permlane32_swap_b32 v249, v16
  v_add_f32 v249, v249, v16
  v_mov_b32 v16, v250
  s_nop 1
  v_permlane32_swap_b32 v250, v16
  v_add_f32 v250, v250, v16
  v_mov_b32 v16, v251
  s_nop 1
  v_permlane32_swap_b32 v251, v16
  v_add_f32 v251, v251, v16
  v_mov_b32 v16, v252
  s_nop 1
  v_permlane32_swap_b32 v252, v16
  v_add_f32 v252, v252, v16
  v_mov_b32 v16, v253
  s_nop 1
  v_permlane32_swap_b32 v253, v16
  v_add_f32 v253, v253, v16
  v_mov_b32 v16, v254
  s_nop 1
  v_permlane32_swap_b32 v254, v16
  v_add_f32 v254, v254, v16
  v_mov_b32 v16, v255
  s_nop 1
  v_permlane32_swap_b32 v255, v16
  v_add_f32 v255, v255, v16
  s_mul_i32 s34, s84, 7680
  s_lshl_b32 s35, s85, 8
  s_add_u32 s34, s34, s35
  s_add_u32 s34, s34, 26374144
  v_lshlrev_b32 v16, 5, v1
  s_mov_b64 exec, 0xff
  buffer_store_dwordx4 v[248:251], v16, s[24:27], s34 offen sc1
  buffer_store_dwordx4 v[252:255], v16, s[24:27], s34 offen offset:16 sc1
  s_mov_b64 exec, -1
  s_branch L_p0e_15
L_p0s_14:
  v_mov_b32 v224, 0
  v_mov_b32 v225, 0
  v_mov_b32 v226, 0
  v_mov_b32 v227, 0
  v_mov_b32 v228, 0
  v_mov_b32 v229, 0
  v_and_b32 v16, 0xffff0000, v208
  v_lshlrev_b32 v17, 16, v208
  v_add_f32 v224, v224, v16
  v_fmac_f32 v225, v16, v16
  v_add_f32 v224, v224, v17
  v_fmac_f32 v225, v17, v17
  v_and_b32 v16, 0xffff0000, v209
  v_lshlrev_b32 v17, 16, v209
  v_add_f32 v224, v224, v16
  v_fmac_f32 v225, v16, v16
  v_add_f32 v224, v224, v17
  v_fmac_f32 v225, v17, v17
  v_and_b32 v16, 0xffff0000, v210
  v_lshlrev_b32 v17, 16, v210
  v_add_f32 v224, v224, v16
  v_fmac_f32 v225, v16, v16
  v_add_f32 v224, v224, v17
  v_fmac_f32 v225, v17, v17
  v_and_b32 v16, 0xffff0000, v211
  v_lshlrev_b32 v17, 16, v211
  v_add_f32 v224, v224, v16
  v_fmac_f32 v225, v16, v16
  v_add_f32 v224, v224, v17
  v_fmac_f32 v225, v17, v17
  v_and_b32 v16, 0xffff0000, v212
  v_lshlrev_b32 v17, 16, v212
  v_add_f32 v224, v224, v16
  v_fmac_f32 v225, v16, v16
  v_add_f32 v224, v224, v17
  v_fmac_f32 v225, v17, v17
  v_and_b32 v16, 0xffff0000, v213
  v_lshlrev_b32 v17, 16, v213
  v_add_f32 v226, v226, v16
  v_fmac_f32 v227, v16, v16
  v_add_f32 v226, v226, v17
  v_fmac_f32 v227, v17, v17
  v_and_b32 v16, 0xffff0000, v214
  v_lshlrev_b32 v17, 16, v214
  v_add_f32 v226, v226, v16
  v_fmac_f32 v227, v16, v16
  v_add_f32 v226, v226, v17
  v_fmac_f32 v227, v17, v17
  v_and_b32 v16, 0xffff0000, v215
  v_lshlrev_b32 v17, 16, v215
  v_add_f32 v226, v226, v16
  v_fmac_f32 v227, v16, v16
  v_add_f32 v226, v226, v17
  v_fmac_f32 v227, v17, v17
  v_and_b32 v16, 0xffff0000, v216
  v_lshlrev_b32 v17, 16, v216
  v_add_f32 v226, v226, v16
  v_fmac_f32 v227, v16, v16
  v_add_f32 v226, v226, v17
  v_fmac_f32 v227, v17, v17
  v_and_b32 v16, 0xffff0000, v217
  v_lshlrev_b32 v17, 16, v217
  v_add_f32 v226, v226, v16
  v_fmac_f32 v227, v16, v16
  v_add_f32 v226, v226, v17
  v_fmac_f32 v227, v17, v17
  v_and_b32 v16, 0xffff0000, v218
  v_lshlrev_b32 v17, 16, v218
  v_add_f32 v228, v228, v16
  v_fmac_f32 v229, v16, v16
  v_add_f32 v228, v228, v17
  v_fmac_f32 v229, v17, v17
  v_and_b32 v16, 0xffff0000, v219
  v_lshlrev_b32 v17, 16, v219
  v_add_f32 v228, v228, v16
  v_fmac_f32 v229, v16, v16
  v_add_f32 v228, v228, v17
  v_fmac_f32 v229, v17, v17
  v_and_b32 v16, 0xffff0000, v220
  v_lshlrev_b32 v17, 16, v220
  v_add_f32 v228, v228, v16
  v_fmac_f32 v229, v16, v16
  v_add_f32 v228, v228, v17
  v_fmac_f32 v229, v17, v17
  v_and_b32 v16, 0xffff0000, v221
  v_lshlrev_b32 v17, 16, v221
  v_add_f32 v228, v228, v16
  v_fmac_f32 v229, v16, v16
  v_add_f32 v228, v228, v17
  v_fmac_f32 v229, v17, v17
  v_and_b32 v16, 0xffff0000, v222
  v_lshlrev_b32 v17, 16, v222
  v_add_f32 v228, v228, v16
  v_fmac_f32 v229, v16, v16
  v_add_f32 v228, v228, v17
  v_fmac_f32 v229, v17, v17
  v_add_f32_dpp v224, v224, v224 row_ror:8 row_mask:0xf bank_mask:0xf
  v_add_f32_dpp v225, v225, v225 row_ror:8 row_mask:0xf bank_mask:0xf
  v_add_f32_dpp v226, v226, v226 row_ror:8 row_mask:0xf bank_mask:0xf
  v_add_f32_dpp v227, v227, v227 row_ror:8 row_mask:0xf bank_mask:0xf
  v_add_f32_dpp v228, v228, v228 row_ror:8 row_mask:0xf bank_mask:0xf
  v_add_f32_dpp v229, v229, v229 row_ror:8 row_mask:0xf bank_mask:0xf
  v_add_f32_dpp v224, v224, v224 row_ror:4 row_mask:0xf bank_mask:0xf
  v_add_f32_dpp v225, v225, v225 row_ror:4 row_mask:0xf bank_mask:0xf
  v_add_f32_dpp v226, v226, v226 row_ror:4 row_mask:0xf bank_mask:0xf
  v_add_f32_dpp v227, v227, v227 row_ror:4 row_mask:0xf bank_mask:0xf
  v_add_f32_dpp v228, v228, v228 row_ror:4 row_mask:0xf bank_mask:0xf
  v_add_f32_dpp v229, v229, v229 row_ror:4 row_mask:0xf bank_mask:0xf
  v_add_f32_dpp v224, v224, v224 row_ror:2 row_mask:0xf bank_mask:0xf
  v_add_f32_dpp v225, v225, v225 row_ror:2 row_mask:0xf bank_mask:0xf
  v_add_f32_dpp v226, v226, v226 row_ror:2 row_mask:0xf bank_mask:0xf
  v_add_f32_dpp v227, v227, v227 row_ror:2 row_mask:0xf bank_mask:0xf
  v_add_f32_dpp v228, v228, v228 row_ror:2 row_mask:0xf bank_mask:0xf
  v_add_f32_dpp v229, v229, v229 row_ror:2 row_mask:0xf bank_mask:0xf
  v_add_f32_dpp v224, v224, v224 row_ror:1 row_mask:0xf bank_mask:0xf
  v_add_f32_dpp v225, v225, v225 row_ror:1 row_mask:0xf bank_mask:0xf
  v_add_f32_dpp v226, v226, v226 row_ror:1 row_mask:0xf bank_mask:0xf
  v_add_f32_dpp v227, v227, v227 row_ror:1 row_mask:0xf bank_mask:0xf
  v_add_f32_dpp v228, v228, v228 row_ror:1 row_mask:0xf bank_mask:0xf
  v_add_f32_dpp v229, v229, v229 row_ror:1 row_mask:0xf bank_mask:0xf
  v_mov_b32 v16, v224
  s_nop 1
  v_permlane16_swap_b32 v224, v16
  v_add_f32 v224, v224, v16
  v_mov_b32 v16, v225
  s_nop 1
  v_permlane16_swap_b32 v225, v16
  v_add_f32 v225, v225, v16
  v_mov_b32 v16, v226
  s_nop 1
  v_permlane16_swap_b32 v226, v16
  v_add_f32 v226, v226, v16
  v_mov_b32 v16, v227
  s_nop 1
  v_permlane16_swap_b32 v227, v16
  v_add_f32 v227, v227, v16
  v_mov_b32 v16, v228
  s_nop 1
  v_permlane16_swap_b32 v228, v16
  v_add_f32 v228, v228, v16
  v_mov_b32 v16, v229
  s_nop 1
  v_permlane16_swap_b32 v229, v16
  v_add_f32 v229, v229, v16
  v_mov_b32 v16, v224
  s_nop 1
  v_permlane32_swap_b32 v224, v16
  v_add_f32 v224, v224, v16
  v_mov_b32 v16, v225
  s_nop 1
  v_permlane32_swap_b32 v225, v16
  v_add_f32 v225, v225, v16
  v_mov_b32 v16, v226
  s_nop 1
  v_permlane32_swap_b32 v226, v16
  v_add_f32 v226, v226, v16
  v_mov_b32 v16, v227
  s_nop 1
  v_permlane32_swap_b32 v227, v16
  v_add_f32 v227, v227, v16
  v_mov_b32 v16, v228
  s_nop 1
  v_permlane32_swap_b32 v228, v16
  v_add_f32 v228, v228, v16
  v_mov_b32 v16, v229
  s_nop 1
  v_permlane32_swap_b32 v229, v16
  v_add_f32 v229, v229, v16
  v_mul_f32 v16, 0x3acccccd, v224
  v_mul_f32 v17, 0x3acccccd, v225
  v_fma_f32 v17, -v16, v16, v17
  v_max_f32 v17, 0, v17
  v_add_f32 v17, 0x3727c5ac, v17
  v_rsq_f32 v232, v17
  s_nop 0
  v_mul_f32 v233, v16, v232
  v_sub_f32 v233, 0, v233
  s_lshl_b32 s34, s84, 3
  s_add_u32 s34, s34, 26357760
  v_mov_b32 v16, 0
  s_mov_b64 exec, 1
  buffer_store_dwordx2 v[232:233], v16, s[24:27], s34 offen sc1
  s_mov_b64 exec, -1
  v_mul_f32 v16, 0x3acccccd, v226
  v_mul_f32 v17, 0x3acccccd, v227
  v_fma_f32 v17, -v16, v16, v17
  v_max_f32 v17, 0, v17
  v_add_f32 v17, 0x3727c5ac, v17
  v_rsq_f32 v234, v17
  s_nop 0
  v_mul_f32 v235, v16, v234
  v_sub_f32 v235, 0, v235
  s_lshl_b32 s34, s85, 3
  s_add_u32 s34, s34, 26357760
  v_mov_b32 v16, 0
  s_mov_b64 exec, 1
  buffer_store_dwordx2 v[234:235], v16, s[24:27], s34 offen sc1
  s_mov_b64 exec, -1
  v_mul_f32 v16, 0x3acccccd, v228
  v_mul_f32 v17, 0x3acccccd, v229
  v_fma_f32 v17, -v16, v16, v17
  v_max_f32 v17, 0, v17
  v_add_f32 v17, 0x3727c5ac, v17
  v_rsq_f32 v236, v17
  s_nop 0
  v_mul_f32 v237, v16, v236
  v_sub_f32 v237, 0, v237
  s_lshl_b32 s34, s86, 3
  s_add_u32 s34, s34, 26357760
  v_mov_b32 v16, 0
  s_mov_b64 exec, 1
  buffer_store_dwordx2 v[236:237], v16, s[24:27], s34 offen sc1
  s_mov_b64 exec, -1
L_p0e_15:
  s_waitcnt lgkmcnt(4)
  v_mfma_f32_32x32x16_bf16 v[80:95], v[152:155], v[144:147], v[80:95]
  ds_read_b128 v[168:171], v50 offset:0
  ds_read_b128 v[172:175], v50 offset:4096
  v_mfma_f32_32x32x16_bf16 v[96:111], v[152:155], v[148:151], v[96:111]
  ds_read_b64_tr_b16 v[176:177], v56 offset:12288
  ds_read_b64_tr_b16 v[178:179], v56 offset:12800
  s_waitcnt lgkmcnt(4)
  v_mfma_f32_32x32x16_bf16 v[80:95], v[164:167], v[156:159], v[80:95]
  ds_read_b128 v[180:183], v51 offset:0
  ds_read_b128 v[184:187], v51 offset:4096
  v_mfma_f32_32x32x16_bf16 v[96:111], v[164:167], v[160:163], v[96:111]
  ds_read_b64_tr_b16 v[188:189], v56 offset:14336
  ds_read_b64_tr_b16 v[190:191], v56 offset:14848
  s_waitcnt lgkmcnt(4)
  s_waitcnt vmcnt(0)
  s_barrier
  s_add_u32 s58, s58, 1
  s_cmp_eq_u32 s58, 5
  s_cselect_b32 s59, s61, 16384
  s_cselect_b32 s58, 0, s58
  v_add_u32 v48, s59, v48
  v_add_u32 v49, s59, v49
  v_add_u32 v50, s59, v50
  v_add_u32 v51, s59, v51
  s_cmp_lg_u32 s3, 0
  s_cbranch_scc1 L_np1_16
  v_mov_b32 v3, 1
  s_and_b32 s90, s2, 7
  s_mov_b64 exec, 1
  s_lshl_b32 s90, s90, 5
  v_mov_b32 v4, s90
  buffer_atomic_add v3, v4, s[28:31], 0 offen sc1
  s_mov_b64 exec, -1
L_np1_16:
  v_mfma_f32_32x32x16_bf16 v[80:95], v[176:179], v[168:171], v[80:95]
  ds_read_b128 v[144:147], v48 offset:0
  ds_read_b128 v[148:151], v48 offset:4096
  v_mfma_f32_32x32x16_bf16 v[96:111], v[176:179], v[172:175], v[96:111]
  ds_read_b64_tr_b16 v[152:153], v56 offset:16384
  ds_read_b64_tr_b16 v[154:155], v56 offset:16896
  s_waitcnt lgkmcnt(4)
  v_mfma_f32_32x32x16_bf16 v[80:95], v[188:191], v[180:183], v[80:95]
  ds_read_b128 v[156:159], v49 offset:0
  ds_read_b128 v[160:163], v49 offset:4096
  v_mfma_f32_32x32x16_bf16 v[96:111], v[188:191], v[184:187], v[96:111]
  ds_read_b64_tr_b16 v[164:165], v56 offset:18432
  ds_read_b64_tr_b16 v[166:167], v56 offset:18944
  s_waitcnt lgkmcnt(4)
  v_mfma_f32_32x32x16_bf16 v[80:95], v[152:155], v[144:147], v[80:95]
  ds_read_b128 v[168:171], v50 offset:0
  ds_read_b128 v[172:175], v50 offset:4096
  v_mfma_f32_32x32x16_bf16 v[96:111], v[152:155], v[148:151], v[96:111]
  ds_read_b64_tr_b16 v[176:177], v56 offset:20480
  ds_read_b64_tr_b16 v[178:179], v56 offset:20992
  s_waitcnt lgkmcnt(4)
  v_mfma_f32_32x32x16_bf16 v[80:95], v[164:167], v[156:159], v[80:95]
  ds_read_b128 v[180:183], v51 offset:0
  ds_read_b128 v[184:187], v51 offset:4096
  v_mfma_f32_32x32x16_bf16 v[96:111], v[164:167], v[160:163], v[96:111]
  ds_read_b64_tr_b16 v[188:189], v56 offset:22528
  ds_read_b64_tr_b16 v[190:191], v56 offset:23040
  s_waitcnt lgkmcnt(4)
  s_barrier
  s_add_u32 s58, s58, 1
  s_cmp_eq_u32 s58, 5
  s_cselect_b32 s59, s61, 16384
  s_cselect_b32 s58, 0, s58
  v_add_u32 v48, s59, v48
  v_add_u32 v49, s59, v49
  v_add_u32 v50, s59, v50
  v_add_u32 v51, s59, v51
  v_mfma_f32_32x32x16_bf16 v[80:95], v[176:179], v[168:171], v[80:95]
  ds_read_b128 v[144:147], v48 offset:0
  ds_read_b128 v[148:151], v48 offset:4096
  v_mfma_f32_32x32x16_bf16 v[96:111], v[176:179], v[172:175], v[96:111]
  ds_read_b64_tr_b16 v[152:153], v56 offset:24576
  ds_read_b64_tr_b16 v[154:155], v56 offset:25088
  s_waitcnt lgkmcnt(4)
  v_mfma_f32_32x32x16_bf16 v[80:95], v[188:191], v[180:183], v[80:95]
  ds_read_b128 v[156:159], v49 offset:0
  ds_read_b128 v[160:163], v49 offset:4096
  v_mfma_f32_32x32x16_bf16 v[96:111], v[188:191], v[184:187], v[96:111]
  ds_read_b64_tr_b16 v[164:165], v56 offset:26624
  ds_read_b64_tr_b16 v[166:167], v56 offset:27136
  s_waitcnt lgkmcnt(4)
  v_mfma_f32_32x32x16_bf16 v[80:95], v[152:155], v[144:147], v[80:95]
  ds_read_b128 v[168:171], v50 offset:0
  ds_read_b128 v[172:175], v50 offset:4096
  v_mfma_f32_32x32x16_bf16 v[96:111], v[152:155], v[148:151], v[96:111]
  ds_read_b64_tr_b16 v[176:177], v56 offset:28672
  ds_read_b64_tr_b16 v[178:179], v56 offset:29184
  s_waitcnt lgkmcnt(4)
  v_mfma_f32_32x32x16_bf16 v[80:95], v[164:167], v[156:159], v[80:95]
  ds_read_b128 v[180:183], v51 offset:0
  ds_read_b128 v[184:187], v51 offset:4096
  v_mfma_f32_32x32x16_bf16 v[96:111], v[164:167], v[160:163], v[96:111]
  ds_read_b64_tr_b16 v[188:189], v56 offset:30720
  ds_read_b64_tr_b16 v[190:191], v56 offset:31232
  s_waitcnt lgkmcnt(4)
  s_barrier
  s_add_u32 s58, s58, 1
  s_cmp_eq_u32 s58, 5
  s_cselect_b32 s59, s61, 16384
  s_cselect_b32 s58, 0, s58
  v_add_u32 v48, s59, v48
  v_add_u32 v49, s59, v49
  v_add_u32 v50, s59, v50
  v_add_u32 v51, s59, v51
  v_mfma_f32_32x32x16_bf16 v[80:95], v[176:179], v[168:171], v[80:95]
  ds_read_b128 v[144:147], v48 offset:0
  ds_read_b128 v[148:151], v48 offset:4096
  v_mfma_f32_32x32x16_bf16 v[96:111], v[176:179], v[172:175], v[96:111]
  ds_read_b64_tr_b16 v[152:153], v56 offset:32768
  ds_read_b64_tr_b16 v[154:155], v56 offset:33280
  s_waitcnt lgkmcnt(4)
  v_mfma_f32_32x32x16_bf16 v[80:95], v[188:191], v[180:183], v[80:95]
  ds_read_b128 v[156:159], v49 offset:0
  ds_read_b128 v[160:163], v49 offset:4096
  v_mfma_f32_32x32x16_bf16 v[96:111], v[188:191], v[184:187], v[96:111]
  ds_read_b64_tr_b16 v[164:165], v56 offset:34816
  ds_read_b64_tr_b16 v[166:167], v56 offset:35328
  s_waitcnt lgkmcnt(4)
  v_mfma_f32_32x32x16_bf16 v[80:95], v[152:155], v[144:147], v[80:95]
  ds_read_b128 v[168:171], v50 offset:0
  ds_read_b128 v[172:175], v50 offset:4096
  v_mfma_f32_32x32x16_bf16 v[96:111], v[152:155], v[148:151], v[96:111]
  ds_read_b64_tr_b16 v[176:177], v56 offset:36864
  ds_read_b64_tr_b16 v[178:179], v56 offset:37376
  s_waitcnt lgkmcnt(4)
  v_mfma_f32_32x32x16_bf16 v[80:95], v[164:167], v[156:159], v[80:95]
  ds_read_b128 v[180:183], v51 offset:0
  ds_read_b128 v[184:187], v51 offset:4096
  v_mfma_f32_32x32x16_bf16 v[96:111], v[164:167], v[160:163], v[96:111]
  ds_read_b64_tr_b16 v[188:189], v56 offset:38912
  ds_read_b64_tr_b16 v[190:191], v56 offset:39424
  s_waitcnt lgkmcnt(4)
  s_barrier
  s_add_u32 s58, s58, 1
  s_cmp_eq_u32 s58, 5
  s_cselect_b32 s59, s61, 16384
  s_cselect_b32 s58, 0, s58
  v_add_u32 v48, s59, v48
  v_add_u32 v49, s59, v49
  v_add_u32 v50, s59, v50
  v_add_u32 v51, s59, v51
  v_mfma_f32_32x32x16_bf16 v[80:95], v[176:179], v[168:171], v[80:95]
  ds_read_b128 v[144:147], v48 offset:0
  ds_read_b128 v[148:151], v48 offset:4096
  v_mfma_f32_32x32x16_bf16 v[96:111], v[176:179], v[172:175], v[96:111]
  ds_read_b64_tr_b16 v[152:153], v57 offset:0
  ds_read_b64_tr_b16 v[154:155], v57 offset:512
  s_waitcnt lgkmcnt(4)
  v_mfma_f32_32x32x16_bf16 v[80:95], v[188:191], v[180:183], v[80:95]
  ds_read_b128 v[156:159], v49 offset:0
  ds_read_b128 v[160:163], v49 offset:4096
  v_mfma_f32_32x32x16_bf16 v[96:111], v[188:191], v[184:187], v[96:111]
  ds_read_b64_tr_b16 v[164:165], v57 offset:2048
  ds_read_b64_tr_b16 v[166:167], v57 offset:2560
  s_waitcnt lgkmcnt(4)
  v_mfma_f32_32x32x16_bf16 v[80:95], v[152:155], v[144:147], v[80:95]
  ds_read_b128 v[168:171], v50 offset:0
  ds_read_b128 v[172:175], v50 offset:4096
  v_mfma_f32_32x32x16_bf16 v[96:111], v[152:155], v[148:151], v[96:111]
  ds_read_b64_tr_b16 v[176:177], v57 offset:4096
  ds_read_b64_tr_b16 v[178:179], v57 offset:4608
  s_waitcnt lgkmcnt(4)
  v_mfma_f32_32x32x16_bf16 v[80:95], v[164:167], v[156:159], v[80:95]
  ds_read_b128 v[180:183], v51 offset:0
  ds_read_b128 v[184:187], v51 offset:4096
  v_mfma_f32_32x32x16_bf16 v[96:111], v[164:167], v[160:163], v[96:111]
  ds_read_b64_tr_b16 v[188:189], v57 offset:6144
  ds_read_b64_tr_b16 v[190:191], v57 offset:6656
  s_waitcnt lgkmcnt(4)
  s_barrier
  s_add_u32 s58, s58, 1
  s_cmp_eq_u32 s58, 5
  s_cselect_b32 s59, s61, 16384
  s_cselect_b32 s58, 0, s58
  v_add_u32 v48, s59, v48
  v_add_u32 v49, s59, v49
  v_add_u32 v50, s59, v50
  v_add_u32 v51, s59, v51
  v_mfma_f32_32x32x16_bf16 v[80:95], v[176:179], v[168:171], v[80:95]
  ds_read_b128 v[144:147], v48 offset:0
  ds_read_b128 v[148:151], v48 offset:4096
  v_mfma_f32_32x32x16_bf16 v[96:111], v[176:179], v[172:175], v[96:111]
  ds_read_b64_tr_b16 v[152:153], v57 offset:8192
  ds_read_b64_tr_b16 v[154:155], v57 offset:8704
  s_waitcnt lgkmcnt(4)
  v_mfma_f32_32x32x16_bf16 v[80:95], v[188:191], v[180:183], v[80:95]
  ds_read_b128 v[156:159], v49 offset:0
  ds_read_b128 v[160:163], v49 offset:4096
  v_mfma_f32_32x32x16_bf16 v[96:111], v[188:191], v[184:187], v[96:111]
  ds_read_b64_tr_b16 v[164:165], v57 offset:10240
  ds_read_b64_tr_b16 v[166:167], v57 offset:10752
  s_waitcnt lgkmcnt(4)
  v_mfma_f32_32x32x16_bf16 v[80:95], v[152:155], v[144:147], v[80:95]
  ds_read_b128 v[168:171], v50 offset:0
  ds_read_b128 v[172:175], v50 offset:4096
  v_mfma_f32_32x32x16_bf16 v[96:111], v[152:155], v[148:151], v[96:111]
  ds_read_b64_tr_b16 v[176:177], v57 offset:12288
  ds_read_b64_tr_b16 v[178:179], v57 offset:12800
  s_waitcnt lgkmcnt(4)
  v_mfma_f32_32x32x16_bf16 v[80:95], v[164:167], v[156:159], v[80:95]
  ds_read_b128 v[180:183], v51 offset:0
  ds_read_b128 v[184:187], v51 offset:4096
  v_mfma_f32_32x32x16_bf16 v[96:111], v[164:167], v[160:163], v[96:111]
  ds_read_b64_tr_b16 v[188:189], v57 offset:14336
  ds_read_b64_tr_b16 v[190:191], v57 offset:14848
  s_waitcnt lgkmcnt(4)
  s_barrier
  s_add_u32 s58, s58, 1
  s_cmp_eq_u32 s58, 5
  s_cselect_b32 s59, s61, 16384
  s_cselect_b32 s58, 0, s58
  v_add_u32 v48, s59, v48
  v_add_u32 v49, s59, v49
  v_add_u32 v50, s59, v50
  v_add_u32 v51, s59, v51
  v_mfma_f32_32x32x16_bf16 v[80:95], v[176:179], v[168:171], v[80:95]
  ds_read_b128 v[144:147], v48 offset:0
  ds_read_b128 v[148:151], v48 offset:4096
  v_mfma_f32_32x32x16_bf16 v[96:111], v[176:179], v[172:175], v[96:111]
  ds_read_b64_tr_b16 v[152:153], v57 offset:16384
  ds_read_b64_tr_b16 v[154:155], v57 offset:16896
  s_waitcnt lgkmcnt(4)
  v_mfma_f32_32x32x16_bf16 v[80:95], v[188:191], v[180:183], v[80:95]
  ds_read_b128 v[156:159], v49 offset:0
  ds_read_b128 v[160:163], v49 offset:4096
  v_mfma_f32_32x32x16_bf16 v[96:111], v[188:191], v[184:187], v[96:111]
  ds_read_b64_tr_b16 v[164:165], v57 offset:18432
  ds_read_b64_tr_b16 v[166:167], v57 offset:18944
  s_waitcnt lgkmcnt(4)
  v_mfma_f32_32x32x16_bf16 v[80:95], v[152:155], v[144:147], v[80:95]
  ds_read_b128 v[168:171], v50 offset:0
  ds_read_b128 v[172:175], v50 offset:4096
  v_mfma_f32_32x32x16_bf16 v[96:111], v[152:155], v[148:151], v[96:111]
  ds_read_b64_tr_b16 v[176:177], v57 offset:20480
  ds_read_b64_tr_b16 v[178:179], v57 offset:20992
  s_waitcnt lgkmcnt(4)
  v_mfma_f32_32x32x16_bf16 v[80:95], v[164:167], v[156:159], v[80:95]
  ds_read_b128 v[180:183], v51 offset:0
  ds_read_b128 v[184:187], v51 offset:4096
  v_mfma_f32_32x32x16_bf16 v[96:111], v[164:167], v[160:163], v[96:111]
  ds_read_b64_tr_b16 v[188:189], v57 offset:22528
  ds_read_b64_tr_b16 v[190:191], v57 offset:23040
  s_waitcnt lgkmcnt(4)
  s_barrier
  s_add_u32 s58, s58, 1
  s_cmp_eq_u32 s58, 5
  s_cselect_b32 s59, s61, 16384
  s_cselect_b32 s58, 0, s58
  v_add_u32 v48, s59, v48
  v_add_u32 v49, s59, v49
  v_add_u32 v50, s59, v50
  v_add_u32 v51, s59, v51
  v_mfma_f32_32x32x16_bf16 v[80:95], v[176:179], v[168:171], v[80:95]
  ds_read_b128 v[144:147], v48 offset:0
  ds_read_b128 v[148:151], v48 offset:4096
  v_mfma_f32_32x32x16_bf16 v[96:111], v[176:179], v[172:175], v[96:111]
  ds_read_b64_tr_b16 v[152:153], v57 offset:24576
  ds_read_b64_tr_b16 v[154:155], v57 offset:25088
  s_waitcnt lgkmcnt(4)
  v_mfma_f32_32x32x16_bf16 v[80:95], v[188:191], v[180:183], v[80:95]
  ds_read_b128 v[156:159], v49 offset:0
  ds_read_b128 v[160:163], v49 offset:4096
  v_mfma_f32_32x32x16_bf16 v[96:111], v[188:191], v[184:187], v[96:111]
  ds_read_b64_tr_b16 v[164:165], v57 offset:26624
  ds_read_b64_tr_b16 v[166:167], v57 offset:27136
  s_waitcnt lgkmcnt(4)
  v_mfma_f32_32x32x16_bf16 v[80:95], v[152:155], v[144:147], v[80:95]
  ds_read_b128 v[168:171], v50 offset:0
  ds_read_b128 v[172:175], v50 offset:4096
  v_mfma_f32_32x32x16_bf16 v[96:111], v[152:155], v[148:151], v[96:111]
  ds_read_b64_tr_b16 v[176:177], v57 offset:28672
  ds_read_b64_tr_b16 v[178:179], v57 offset:29184
  s_waitcnt lgkmcnt(4)
  v_mfma_f32_32x32x16_bf16 v[80:95], v[164:167], v[156:159], v[80:95]
  ds_read_b128 v[180:183], v51 offset:0
  ds_read_b128 v[184:187], v51 offset:4096
  v_mfma_f32_32x32x16_bf16 v[96:111], v[164:167], v[160:163], v[96:111]
  ds_read_b64_tr_b16 v[188:189], v57 offset:30720
  ds_read_b64_tr_b16 v[190:191], v57 offset:31232
  s_waitcnt lgkmcnt(4)
  s_barrier
  s_add_u32 s58, s58, 1
  s_cmp_eq_u32 s58, 5
  s_cselect_b32 s59, s61, 16384
  s_cselect_b32 s58, 0, s58
  v_add_u32 v48, s59, v48
  v_add_u32 v49, s59, v49
  v_add_u32 v50, s59, v50
  v_add_u32 v51, s59, v51
  v_mfma_f32_32x32x16_bf16 v[80:95], v[176:179], v[168:171], v[80:95]
  ds_read_b128 v[144:147], v48 offset:0
  ds_read_b128 v[148:151], v48 offset:4096
  v_mfma_f32_32x32x16_bf16 v[96:111], v[176:179], v[172:175], v[96:111]
  ds_read_b64_tr_b16 v[152:153], v57 offset:32768
  ds_read_b64_tr_b16 v[154:155], v57 offset:33280
  s_waitcnt lgkmcnt(4)
  v_mfma_f32_32x32x16_bf16 v[80:95], v[188:191], v[180:183], v[80:95]
  ds_read_b128 v[156:159], v49 offset:0
  ds_read_b128 v[160:163], v49 offset:4096
  v_mfma_f32_32x32x16_bf16 v[96:111], v[188:191], v[184:187], v[96:111]
  ds_read_b64_tr_b16 v[164:165], v57 offset:34816
  ds_read_b64_tr_b16 v[166:167], v57 offset:35328
  s_waitcnt lgkmcnt(4)
  v_mfma_f32_32x32x16_bf16 v[80:95], v[152:155], v[144:147], v[80:95]
  ds_read_b128 v[168:171], v50 offset:0
  ds_read_b128 v[172:175], v50 offset:4096
  v_mfma_f32_32x32x16_bf16 v[96:111], v[152:155], v[148:151], v[96:111]
  ds_read_b64_tr_b16 v[176:177], v57 offset:36864
  ds_read_b64_tr_b16 v[178:179], v57 offset:37376
  s_waitcnt lgkmcnt(4)
  v_mfma_f32_32x32x16_bf16 v[80:95], v[164:167], v[156:159], v[80:95]
  ds_read_b128 v[180:183], v51 offset:0
  ds_read_b128 v[184:187], v51 offset:4096
  v_mfma_f32_32x32x16_bf16 v[96:111], v[164:167], v[160:163], v[96:111]
  ds_read_b64_tr_b16 v[188:189], v57 offset:38912
  ds_read_b64_tr_b16 v[190:191], v57 offset:39424
  s_waitcnt lgkmcnt(4)
  s_barrier
  s_add_u32 s58, s58, 1
  s_cmp_eq_u32 s58, 5
  s_cselect_b32 s59, s61, 16384
  s_cselect_b32 s58, 0, s58
  v_add_u32 v48, s59, v48
  v_add_u32 v49, s59, v49
  v_add_u32 v50, s59, v50
  v_add_u32 v51, s59, v51
  v_mfma_f32_32x32x16_bf16 v[80:95], v[176:179], v[168:171], v[80:95]
  ds_read_b128 v[144:147], v48 offset:0
  ds_read_b128 v[148:151], v48 offset:4096
  v_mfma_f32_32x32x16_bf16 v[96:111], v[176:179], v[172:175], v[96:111]
  ds_read_b64_tr_b16 v[152:153], v56 offset:0
  ds_read_b64_tr_b16 v[154:155], v56 offset:512
  s_waitcnt lgkmcnt(4)
  v_mfma_f32_32x32x16_bf16 v[80:95], v[188:191], v[180:183], v[80:95]
  ds_read_b128 v[156:159], v49 offset:0
  ds_read_b128 v[160:163], v49 offset:4096
  v_mfma_f32_32x32x16_bf16 v[96:111], v[188:191], v[184:187], v[96:111]
  ds_read_b64_tr_b16 v[164:165], v56 offset:2048
  ds_read_b64_tr_b16 v[166:167], v56 offset:2560
  s_waitcnt lgkmcnt(4)
  v_mfma_f32_32x32x16_bf16 v[112:127], v[152:155], v[144:147], v[112:127]
  ds_read_b128 v[168:171], v50 offset:0
  ds_read_b128 v[172:175], v50 offset:4096
  v_mfma_f32_32x32x16_bf16 v[128:143], v[152:155], v[148:151], v[128:143]
  ds_read_b64_tr_b16 v[176:177], v56 offset:4096
  ds_read_b64_tr_b16 v[178:179], v56 offset:4608
  s_waitcnt lgkmcnt(4)
  v_mfma_f32_32x32x16_bf16 v[112:127], v[164:167], v[156:159], v[112:127]
  ds_read_b128 v[180:183], v51 offset:0
  ds_read_b128 v[184:187], v51 offset:4096
  v_mfma_f32_32x32x16_bf16 v[128:143], v[164:167], v[160:163], v[128:143]
  ds_read_b64_tr_b16 v[188:189], v56 offset:6144
  ds_read_b64_tr_b16 v[190:191], v56 offset:6656
  s_waitcnt lgkmcnt(4)
  s_barrier
  s_add_u32 s58, s58, 1
  s_cmp_eq_u32 s58, 5
  s_cselect_b32 s59, s61, 16384
  s_cselect_b32 s58, 0, s58
  v_add_u32 v48, s59, v48
  v_add_u32 v49, s59, v49
  v_add_u32 v50, s59, v50
  v_add_u32 v51, s59, v51
  v_mfma_f32_32x32x16_bf16 v[112:127], v[176:179], v[168:171], v[112:127]
  ds_read_b128 v[144:147], v48 offset:0
  ds_read_b128 v[148:151], v48 offset:4096
  v_mfma_f32_32x32x16_bf16 v[128:143], v[176:179], v[172:175], v[128:143]
  ds_read_b64_tr_b16 v[152:153], v56 offset:8192
  ds_read_b64_tr_b16 v[154:155], v56 offset:8704
  s_waitcnt lgkmcnt(4)
  v_mfma_f32_32x32x16_bf16 v[112:127], v[188:191], v[180:183], v[112:127]
  ds_read_b128 v[156:159], v49 offset:0
  ds_read_b128 v[160:163], v49 offset:4096
  v_mfma_f32_32x32x16_bf16 v[128:143], v[188:191], v[184:187], v[128:143]
  ds_read_b64_tr_b16 v[164:165], v56 offset:10240
  ds_read_b64_tr_b16 v[166:167], v56 offset:10752
  s_waitcnt lgkmcnt(4)
  v_mfma_f32_32x32x16_bf16 v[112:127], v[152:155], v[144:147], v[112:127]
  ds_read_b128 v[168:171], v50 offset:0
  ds_read_b128 v[172:175], v50 offset:4096
  v_mfma_f32_32x32x16_bf16 v[128:143], v[152:155], v[148:151], v[128:143]
  ds_read_b64_tr_b16 v[176:177], v56 offset:12288
  ds_read_b64_tr_b16 v[178:179], v56 offset:12800
  s_waitcnt lgkmcnt(4)
  v_mfma_f32_32x32x16_bf16 v[112:127], v[164:167], v[156:159], v[112:127]
  ds_read_b128 v[180:183], v51 offset:0
  ds_read_b128 v[184:187], v51 offset:4096
  v_mfma_f32_32x32x16_bf16 v[128:143], v[164:167], v[160:163], v[128:143]
  ds_read_b64_tr_b16 v[188:189], v56 offset:14336
  ds_read_b64_tr_b16 v[190:191], v56 offset:14848
  s_waitcnt lgkmcnt(4)
  s_barrier
  s_add_u32 s58, s58, 1
  s_cmp_eq_u32 s58, 5
  s_cselect_b32 s59, s61, 16384
  s_cselect_b32 s58, 0, s58
  v_add_u32 v48, s59, v48
  v_add_u32 v49, s59, v49
  v_add_u32 v50, s59, v50
  v_add_u32 v51, s59, v51
  v_mfma_f32_32x32x16_bf16 v[112:127], v[176:179], v[168:171], v[112:127]
  ds_read_b128 v[144:147], v48 offset:0
  ds_read_b128 v[148:151], v48 offset:4096
  v_mfma_f32_32x32x16_bf16 v[128:143], v[176:179], v[172:175], v[128:143]
  ds_read_b64_tr_b16 v[152:153], v56 offset:16384
  ds_read_b64_tr_b16 v[154:155], v56 offset:16896
  s_waitcnt lgkmcnt(4)
  v_mfma_f32_32x32x16_bf16 v[112:127], v[188:191], v[180:183], v[112:127]
  ds_read_b128 v[156:159], v49 offset:0
  ds_read_b128 v[160:163], v49 offset:4096
  v_mfma_f32_32x32x16_bf16 v[128:143], v[188:191], v[184:187], v[128:143]
  ds_read_b64_tr_b16 v[164:165], v56 offset:18432
  ds_read_b64_tr_b16 v[166:167], v56 offset:18944
  s_mov_b32 s90, 0
L_poll_17:
  s_mov_b64 exec, 0xff
  v_lshlrev_b32 v60, 5, v1
  buffer_load_dword v61, v60, s[28:31], 0 offen sc1
  s_mov_b64 exec, -1
  s_waitcnt vmcnt(0)
  v_cmp_le_u32 vcc, 32, v61
  s_nop 2
  s_and_b32 s91, vcc_lo, 0xff
  s_cmp_eq_u32 s91, 0xff
  s_cbranch_scc1 L_polld_18
  s_sleep 2
  s_add_u32 s90, s90, 1
  s_cmp_lt_u32 s90, 0x40000
  s_cbranch_scc1 L_poll_17
L_polld_18:
  v_and_b32 v60, 31, v1
  s_lshl_b32 s34, s3, 5
  s_and_b32 s34, s34, 63
  s_lshl_b32 s35, s33, 6
  s_add_u32 s34, s34, s35
  v_add_lshl_u32 v60, v60, s34, 2
  s_mov_b32 s34, 26374144
  buffer_load_dword v64, v60, s[24:27], s34 offen sc1
  s_mov_b32 s34, 26381824
  buffer_load_dword v65, v60, s[24:27], s34 offen sc1
  s_mov_b32 s34, 26389504
  buffer_load_dword v66, v60, s[24:27], s34 offen sc1
  s_mov_b32 s34, 26397184
  buffer_load_dword v67, v60, s[24:27], s34 offen sc1
  s_mov_b32 s34, 26404864
  buffer_load_dword v68, v60, s[24:27], s34 offen sc1
  s_mov_b32 s34, 26412544
  buffer_load_dword v69, v60, s[24:27], s34 offen sc1
  s_mov_b32 s34, 26420224
  buffer_load_dword v70, v60, s[24:27], s34 offen sc1
  s_mov_b32 s34, 26427904
  buffer_load_dword v71, v60, s[24:27], s34 offen sc1
  s_lshl_b32 s34, s32, 7
  s_lshl_b32 s35, s36, 6
  s_add_u32 s34, s34, s35
  s_add_u32 s34, s34, 0
  s_lshl_b32 s34, s34, 3
  s_add_u32 s34, s34, 26357760
  v_and_b32 v60, 31, v1
  v_lshlrev_b32 v60, 3, v60
  buffer_load_dwordx2 v[208:209], v60, s[24:27], s34 offen sc1
  s_lshl_b32 s34, s32, 7
  s_lshl_b32 s35, s36, 6
  s_add_u32 s34, s34, s35
  s_add_u32 s34, s34, 32
  s_lshl_b32 s34, s34, 3
  s_add_u32 s34, s34, 26357760
  v_and_b32 v60, 31, v1
  v_lshlrev_b32 v60, 3, v60
  buffer_load_dwordx2 v[210:211], v60, s[24:27], s34 offen sc1
  s_lshl_b32 s34, s32, 7
  s_lshl_b32 s35, s36, 6
  s_add_u32 s34, s34, s35
  s_add_u32 s34, s34, 1024
  s_lshl_b32 s34, s34, 3
  s_add_u32 s34, s34, 26357760
  v_and_b32 v60, 31, v1
  v_lshlrev_b32 v60, 3, v60
  buffer_load_dwordx2 v[212:213], v60, s[24:27], s34 offen sc1
  s_lshl_b32 s34, s32, 7
  s_lshl_b32 s35, s36, 6
  s_add_u32 s34, s34, s35
  s_add_u32 s34, s34, 1056
  s_lshl_b32 s34, s34, 3
  s_add_u32 s34, s34, 26357760
  v_and_b32 v60, 31, v1
  v_lshlrev_b32 v60, 3, v60
  buffer_load_dwordx2 v[214:215], v60, s[24:27], s34 offen sc1
  s_waitcnt lgkmcnt(4)
  v_mfma_f32_32x32x16_bf16 v[112:127], v[152:155], v[144:147], v[112:127]
  ds_read_b128 v[168:171], v50 offset:0
  ds_read_b128 v[172:175], v50 offset:4096
  v_mfma_f32_32x32x16_bf16 v[128:143], v[152:155], v[148:151], v[128:143]
  ds_read_b64_tr_b16 v[176:177], v56 offset:20480
  ds_read_b64_tr_b16 v[178:179], v56 offset:20992
  s_waitcnt lgkmcnt(4)
  v_mfma_f32_32x32x16_bf16 v[112:127], v[164:167], v[156:159], v[112:127]
  ds_read_b128 v[180:183], v51 offset:0
  ds_read_b128 v[184:187], v51 offset:4096
  v_mfma_f32_32x32x16_bf16 v[128:143], v[164:167], v[160:163], v[128:143]
  ds_read_b64_tr_b16 v[188:189], v56 offset:22528
  ds_read_b64_tr_b16 v[190:191], v56 offset:23040
  s_waitcnt lgkmcnt(4)
  s_barrier
  s_add_u32 s58, s58, 1
  s_cmp_eq_u32 s58, 5
  s_cselect_b32 s59, s61, 16384
  s_cselect_b32 s58, 0, s58
  v_add_u32 v48, s59, v48
  v_add_u32 v49, s59, v49
  v_add_u32 v50, s59, v50
  v_add_u32 v51, s59, v51
  v_mfma_f32_32x32x16_bf16 v[112:127], v[176:179], v[168:171], v[112:127]
  ds_read_b128 v[144:147], v48 offset:0
  ds_read_b128 v[148:151], v48 offset:4096
  v_mfma_f32_32x32x16_bf16 v[128:143], v[176:179], v[172:175], v[128:143]
  ds_read_b64_tr_b16 v[152:153], v56 offset:24576
  ds_read_b64_tr_b16 v[154:155], v56 offset:25088
  s_waitcnt lgkmcnt(4)
  v_mfma_f32_32x32x16_bf16 v[112:127], v[188:191], v[180:183], v[112:127]
  ds_read_b128 v[156:159], v49 offset:0
  ds_read_b128 v[160:163], v49 offset:4096
  v_mfma_f32_32x32x16_bf16 v[128:143], v[188:191], v[184:187], v[128:143]
  ds_read_b64_tr_b16 v[164:165], v56 offset:26624
  ds_read_b64_tr_b16 v[166:167], v56 offset:27136
  s_waitcnt lgkmcnt(4)
  v_mfma_f32_32x32x16_bf16 v[112:127], v[152:155], v[144:147], v[112:127]
  ds_read_b128 v[168:171], v50 offset:0
  ds_read_b128 v[172:175], v50 offset:4096
  v_mfma_f32_32x32x16_bf16 v[128:143], v[152:155], v[148:151], v[128:143]
  ds_read_b64_tr_b16 v[176:177], v56 offset:28672
  ds_read_b64_tr_b16 v[178:179], v56 offset:29184
  s_waitcnt lgkmcnt(4)
  v_mfma_f32_32x32x16_bf16 v[112:127], v[164:167], v[156:159], v[112:127]
  ds_read_b128 v[180:183], v51 offset:0
  ds_read_b128 v[184:187], v51 offset:4096
  v_mfma_f32_32x32x16_bf16 v[128:143], v[164:167], v[160:163], v[128:143]
  ds_read_b64_tr_b16 v[188:189], v56 offset:30720
  ds_read_b64_tr_b16 v[190:191], v56 offset:31232
  s_waitcnt lgkmcnt(4)
  s_barrier
  s_add_u32 s58, s58, 1
  s_cmp_eq_u32 s58, 5
  s_cselect_b32 s59, s61, 16384
  s_cselect_b32 s58, 0, s58
  v_add_u32 v48, s59, v48
  v_add_u32 v49, s59, v49
  v_add_u32 v50, s59, v50
  v_add_u32 v51, s59, v51
  v_mfma_f32_32x32x16_bf16 v[112:127], v[176:179], v[168:171], v[112:127]
  ds_read_b128 v[144:147], v48 offset:0
  ds_read_b128 v[148:151], v48 offset:4096
  v_mfma_f32_32x32x16_bf16 v[128:143], v[176:179], v[172:175], v[128:143]
  ds_read_b64_tr_b16 v[152:153], v56 offset:32768
  ds_read_b64_tr_b16 v[154:155], v56 offset:33280
  s_waitcnt lgkmcnt(4)
  v_mfma_f32_32x32x16_bf16 v[112:127], v[188:191], v[180:183], v[112:127]
  ds_read_b128 v[156:159], v49 offset:0
  ds_read_b128 v[160:163], v49 offset:4096
  v_mfma_f32_32x32x16_bf16 v[128:143], v[188:191], v[184:187], v[128:143]
  ds_read_b64_tr_b16 v[164:165], v56 offset:34816
  ds_read_b64_tr_b16 v[166:167], v56 offset:35328
  s_waitcnt lgkmcnt(4)
  v_mfma_f32_32x32x16_bf16 v[112:127], v[152:155], v[144:147], v[112:127]
  ds_read_b128 v[168:171], v50 offset:0
  ds_read_b128 v[172:175], v50 offset:4096
  v_mfma_f32_32x32x16_bf16 v[128:143], v[152:155], v[148:151], v[128:143]
  ds_read_b64_tr_b16 v[176:177], v56 offset:36864
  ds_read_b64_tr_b16 v[178:179], v56 offset:37376
  s_waitcnt lgkmcnt(4)
  v_mfma_f32_32x32x16_bf16 v[112:127], v[164:167], v[156:159], v[112:127]
  ds_read_b128 v[180:183], v51 offset:0
  ds_read_b128 v[184:187], v51 offset:4096
  v_mfma_f32_32x32x16_bf16 v[128:143], v[164:167], v[160:163], v[128:143]
  ds_read_b64_tr_b16 v[188:189], v56 offset:38912
  ds_read_b64_tr_b16 v[190:191], v56 offset:39424
  s_waitcnt lgkmcnt(4)
  s_barrier
  s_add_u32 s58, s58, 1
  s_cmp_eq_u32 s58, 5
  s_cselect_b32 s59, s61, 16384
  s_cselect_b32 s58, 0, s58
  v_add_u32 v48, s59, v48
  v_add_u32 v49, s59, v49
  v_add_u32 v50, s59, v50
  v_add_u32 v51, s59, v51
  v_mfma_f32_32x32x16_bf16 v[112:127], v[176:179], v[168:171], v[112:127]
  ds_read_b128 v[144:147], v48 offset:0
  ds_read_b128 v[148:151], v48 offset:4096
  v_mfma_f32_32x32x16_bf16 v[128:143], v[176:179], v[172:175], v[128:143]
  ds_read_b64_tr_b16 v[152:153], v57 offset:0
  ds_read_b64_tr_b16 v[154:155], v57 offset:512
  s_waitcnt lgkmcnt(4)
  v_mfma_f32_32x32x16_bf16 v[112:127], v[188:191], v[180:183], v[112:127]
  ds_read_b128 v[156:159], v49 offset:0
  ds_read_b128 v[160:163], v49 offset:4096
  v_mfma_f32_32x32x16_bf16 v[128:143], v[188:191], v[184:187], v[128:143]
  ds_read_b64_tr_b16 v[164:165], v57 offset:2048
  ds_read_b64_tr_b16 v[166:167], v57 offset:2560
  s_waitcnt vmcnt(0)
  v_add_f32 v64, v64, v65
  v_add_f32 v64, v64, v66
  v_add_f32 v64, v64, v67
  v_add_f32 v64, v64, v68
  v_add_f32 v64, v64, v69
  v_add_f32 v64, v64, v70
  v_add_f32 v64, v64, v71
  v_lshrrev_b32 v4, 5, v1
  v_lshl_add_u32 v5, v4, 2, 0
  v_lshlrev_b32 v5, 2, v5
  ds_bpermute_b32 v16, v5, v64
  v_lshl_add_u32 v5, v4, 2, 1
  v_lshlrev_b32 v5, 2, v5
  ds_bpermute_b32 v17, v5, v64
  v_lshl_add_u32 v5, v4, 2, 2
  v_lshlrev_b32 v5, 2, v5
  ds_bpermute_b32 v18, v5, v64
  v_lshl_add_u32 v5, v4, 2, 3
  v_lshlrev_b32 v5, 2, v5
  ds_bpermute_b32 v19, v5, v64
  v_lshl_add_u32 v5, v4, 2, 8
  v_lshlrev_b32 v5, 2, v5
  ds_bpermute_b32 v20, v5, v64
  v_lshl_add_u32 v5, v4, 2, 9
  v_lshlrev_b32 v5, 2, v5
  ds_bpermute_b32 v21, v5, v64
  v_lshl_add_u32 v5, v4, 2, 10
  v_lshlrev_b32 v5, 2, v5
  ds_bpermute_b32 v22, v5, v64
  v_lshl_add_u32 v5, v4, 2, 11
  v_lshlrev_b32 v5, 2, v5
  ds_bpermute_b32 v23, v5, v64
  v_lshl_add_u32 v5, v4, 2, 16
  v_lshlrev_b32 v5, 2, v5
  ds_bpermute_b32 v24, v5, v64
  v_lshl_add_u32 v5, v4, 2, 17
  v_lshlrev_b32 v5, 2, v5
  ds_bpermute_b32 v25, v5, v64
  v_lshl_add_u32 v5, v4, 2, 18
  v_lshlrev_b32 v5, 2, v5
  ds_bpermute_b32 v26, v5, v64
  v_lshl_add_u32 v5, v4, 2, 19
  v_lshlrev_b32 v5, 2, v5
  ds_bpermute_b32 v27, v5, v64
  v_lshl_add_u32 v5, v4, 2, 24
  v_lshlrev_b32 v5, 2, v5
  ds_bpermute_b32 v28, v5, v64
  v_lshl_add_u32 v5, v4, 2, 25
  v_lshlrev_b32 v5, 2, v5
  ds_bpermute_b32 v29, v5, v64
  v_lshl_add_u32 v5, v4, 2, 26
  v_lshlrev_b32 v5, 2, v5
  ds_bpermute_b32 v30, v5, v64
  v_lshl_add_u32 v5, v4, 2, 27
  v_lshlrev_b32 v5, 2, v5
  ds_bpermute_b32 v31, v5, v64
  s_waitcnt lgkmcnt(0)
  s_lshl_b32 s35, s36, 1
  s_add_u32 s34, s35, 0
  s_lshl_b32 s35, s32, 2
  s_add_u32 s34, s34, s35
  s_mul_i32 s34, s34, s49
  s_add_u32 s52, s34, s50
  s_lshl_b32 s35, s36, 1
  s_add_u32 s34, s35, 1
  s_lshl_b32 s35, s32, 2
  s_add_u32 s34, s34, s35
  s_mul_i32 s34, s34, s49
  s_add_u32 s53, s34, s50
  v_mul_f32 v4, s51, v208
  v_mul_f32 v6, s51, v209
  v_mul_f32 v5, s51, v210
  v_mul_f32 v7, s51, v211
  v_mul_f32 v32, v6, v16
  v_mul_f32 v33, v6, v17
  v_mul_f32 v34, v6, v18
  v_mul_f32 v35, v6, v19
  v_fmac_f32 v32, v4, v80
  v_fmac_f32 v33, v4, v81
  v_fmac_f32 v34, v4, v82
  v_fmac_f32 v35, v4, v83
  v_cvt_pk_bf16_f32 v36, v32, v33
  v_cvt_pk_bf16_f32 v37, v34, v35
  buffer_store_dwordx2 v[36:37], v72, s[24:27], s52 offen sc1
  v_mul_f32 v38, v6, v20
  v_mul_f32 v39, v6, v21
  v_mul_f32 v40, v6, v22
  v_mul_f32 v41, v6, v23
  v_fmac_f32 v38, v4, v84
  v_fmac_f32 v39, v4, v85
  v_fmac_f32 v40, v4, v86
  v_fmac_f32 v41, v4, v87
  v_cvt_pk_bf16_f32 v42, v38, v39
  v_cvt_pk_bf16_f32 v43, v40, v41
  buffer_store_dwordx2 v[42:43], v73, s[24:27], s52 offen sc1
  v_mul_f32 v32, v6, v24
  v_mul_f32 v33, v6, v25
  v_mul_f32 v34, v6, v26
  v_mul_f32 v35, v6, v27
  v_fmac_f32 v32, v4, v88
  v_fmac_f32 v33, v4, v89
  v_fmac_f32 v34, v4, v90
  v_fmac_f32 v35, v4, v91
  v_cvt_pk_bf16_f32 v36, v32, v33
  v_cvt_pk_bf16_f32 v37, v34, v35
  buffer_store_dwordx2 v[36:37], v74, s[24:27], s52 offen sc1
  v_mul_f32 v38, v6, v28
  v_mul_f32 v39, v6, v29
  v_mul_f32 v40, v6, v30
  v_mul_f32 v41, v6, v31
  v_fmac_f32 v38, v4, v92
  v_fmac_f32 v39, v4, v93
  v_fmac_f32 v40, v4, v94
  v_fmac_f32 v41, v4, v95
  v_cvt_pk_bf16_f32 v42, v38, v39
  v_cvt_pk_bf16_f32 v43, v40, v41
  buffer_store_dwordx2 v[42:43], v75, s[24:27], s52 offen sc1
  v_mul_f32 v32, v7, v16
  v_mul_f32 v33, v7, v17
  v_mul_f32 v34, v7, v18
  v_mul_f32 v35, v7, v19
  v_fmac_f32 v32, v5, v96
  v_fmac_f32 v33, v5, v97
  v_fmac_f32 v34, v5, v98
  v_fmac_f32 v35, v5, v99
  v_cvt_pk_bf16_f32 v36, v32, v33
  v_cvt_pk_bf16_f32 v37, v34, v35
  buffer_store_dwordx2 v[36:37], v72, s[24:27], s53 offen sc1
  v_mul_f32 v38, v7, v20
  v_mul_f32 v39, v7, v21
  v_mul_f32 v40, v7, v22
  v_mul_f32 v41, v7, v23
  v_fmac_f32 v38, v5, v100
  v_fmac_f32 v39, v5, v101
  v_fmac_f32 v40, v5, v102
  v_fmac_f32 v41, v5, v103
  v_cvt_pk_bf16_f32 v42, v38, v39
  v_cvt_pk_bf16_f32 v43, v40, v41
  buffer_store_dwordx2 v[42:43], v73, s[24:27], s53 offen sc1
  v_mul_f32 v32, v7, v24
  v_mul_f32 v33, v7, v25
  v_mul_f32 v34, v7, v26
  v_mul_f32 v35, v7, v27
  v_fmac_f32 v32, v5, v104
  v_fmac_f32 v33, v5, v105
  v_fmac_f32 v34, v5, v106
  v_fmac_f32 v35, v5, v107
  v_cvt_pk_bf16_f32 v36, v32, v33
  v_cvt_pk_bf16_f32 v37, v34, v35
  buffer_store_dwordx2 v[36:37], v74, s[24:27], s53 offen sc1
  v_mul_f32 v38, v7, v28
  v_mul_f32 v39, v7, v29
  v_mul_f32 v40, v7, v30
  v_mul_f32 v41, v7, v31
  v_fmac_f32 v38, v5, v108
  v_fmac_f32 v39, v5, v109
  v_fmac_f32 v40, v5, v110
  v_fmac_f32 v41, v5, v111
  v_cvt_pk_bf16_f32 v42, v38, v39
  v_cvt_pk_bf16_f32 v43, v40, v41
  buffer_store_dwordx2 v[42:43], v75, s[24:27], s53 offen sc1
  s_waitcnt lgkmcnt(4)
  v_mfma_f32_32x32x16_bf16 v[112:127], v[152:155], v[144:147], v[112:127]
  ds_read_b128 v[168:171], v50 offset:0
  ds_read_b128 v[172:175], v50 offset:4096
  v_mfma_f32_32x32x16_bf16 v[128:143], v[152:155], v[148:151], v[128:143]
  ds_read_b64_tr_b16 v[176:177], v57 offset:4096
  ds_read_b64_tr_b16 v[178:179], v57 offset:4608
  s_waitcnt lgkmcnt(4)
  v_mfma_f32_32x32x16_bf16 v[112:127], v[164:167], v[156:159], v[112:127]
  ds_read_b128 v[180:183], v51 offset:0
  ds_read_b128 v[184:187], v51 offset:4096
  v_mfma_f32_32x32x16_bf16 v[128:143], v[164:167], v[160:163], v[128:143]
  ds_read_b64_tr_b16 v[188:189], v57 offset:6144
  ds_read_b64_tr_b16 v[190:191], v57 offset:6656
  s_waitcnt lgkmcnt(4)
  s_barrier
  s_add_u32 s58, s58, 1
  s_cmp_eq_u32 s58, 5
  s_cselect_b32 s59, s61, 16384
  s_cselect_b32 s58, 0, s58
  v_add_u32 v48, s59, v48
  v_add_u32 v49, s59, v49
  v_add_u32 v50, s59, v50
  v_add_u32 v51, s59, v51
  v_mfma_f32_32x32x16_bf16 v[112:127], v[176:179], v[168:171], v[112:127]
  ds_read_b128 v[144:147], v48 offset:0
  ds_read_b128 v[148:151], v48 offset:4096
  v_mfma_f32_32x32x16_bf16 v[128:143], v[176:179], v[172:175], v[128:143]
  ds_read_b64_tr_b16 v[152:153], v57 offset:8192
  ds_read_b64_tr_b16 v[154:155], v57 offset:8704
  s_waitcnt lgkmcnt(4)
  v_mfma_f32_32x32x16_bf16 v[112:127], v[188:191], v[180:183], v[112:127]
  ds_read_b128 v[156:159], v49 offset:0
  ds_read_b128 v[160:163], v49 offset:4096
  v_mfma_f32_32x32x16_bf16 v[128:143], v[188:191], v[184:187], v[128:143]
  ds_read_b64_tr_b16 v[164:165], v57 offset:10240
  ds_read_b64_tr_b16 v[166:167], v57 offset:10752
  s_waitcnt lgkmcnt(4)
  v_mfma_f32_32x32x16_bf16 v[112:127], v[152:155], v[144:147], v[112:127]
  ds_read_b128 v[168:171], v50 offset:0
  ds_read_b128 v[172:175], v50 offset:4096
  v_mfma_f32_32x32x16_bf16 v[128:143], v[152:155], v[148:151], v[128:143]
  ds_read_b64_tr_b16 v[176:177], v57 offset:12288
  ds_read_b64_tr_b16 v[178:179], v57 offset:12800
  s_waitcnt lgkmcnt(4)
  v_mfma_f32_32x32x16_bf16 v[112:127], v[164:167], v[156:159], v[112:127]
  ds_read_b128 v[180:183], v51 offset:0
  ds_read_b128 v[184:187], v51 offset:4096
  v_mfma_f32_32x32x16_bf16 v[128:143], v[164:167], v[160:163], v[128:143]
  ds_read_b64_tr_b16 v[188:189], v57 offset:14336
  ds_read_b64_tr_b16 v[190:191], v57 offset:14848
  s_waitcnt lgkmcnt(4)
  s_waitcnt vmcnt(0)
  s_barrier
  s_add_u32 s58, s58, 1
  s_cmp_eq_u32 s58, 5
  s_cselect_b32 s59, s61, 16384
  s_cselect_b32 s58, 0, s58
  v_add_u32 v48, s59, v48
  v_add_u32 v49, s59, v49
  v_add_u32 v50, s59, v50
  v_add_u32 v51, s59, v51
  s_cmp_lg_u32 s3, 0
  s_cbranch_scc1 L_qnp_19
  s_add_u32 s34, s33, 120
  s_lshl_b32 s90, s34, 8
  s_add_u32 s90, s90, 26681344
  v_mov_b32 v3, 1
  v_mov_b32 v4, 0
  s_mov_b64 exec, 1
  buffer_atomic_add v3, v4, s[24:27], s90 offen sc1
  s_mov_b64 exec, -1
L_qnp_19:
  v_mfma_f32_32x32x16_bf16 v[112:127], v[176:179], v[168:171], v[112:127]
  ds_read_b128 v[144:147], v48 offset:0
  ds_read_b128 v[148:151], v48 offset:4096
  v_mfma_f32_32x32x16_bf16 v[128:143], v[176:179], v[172:175], v[128:143]
  ds_read_b64_tr_b16 v[152:153], v57 offset:16384
  ds_read_b64_tr_b16 v[154:155], v57 offset:16896
  s_waitcnt lgkmcnt(4)
  v_mfma_f32_32x32x16_bf16 v[112:127], v[188:191], v[180:183], v[112:127]
  ds_read_b128 v[156:159], v49 offset:0
  ds_read_b128 v[160:163], v49 offset:4096
  v_mfma_f32_32x32x16_bf16 v[128:143], v[188:191], v[184:187], v[128:143]
  ds_read_b64_tr_b16 v[164:165], v57 offset:18432
  ds_read_b64_tr_b16 v[166:167], v57 offset:18944
  s_waitcnt lgkmcnt(4)
  v_mfma_f32_32x32x16_bf16 v[112:127], v[152:155], v[144:147], v[112:127]
  ds_read_b128 v[168:171], v50 offset:0
  ds_read_b128 v[172:175], v50 offset:4096
  v_mfma_f32_32x32x16_bf16 v[128:143], v[152:155], v[148:151], v[128:143]
  ds_read_b64_tr_b16 v[176:177], v57 offset:20480
  ds_read_b64_tr_b16 v[178:179], v57 offset:20992
  s_waitcnt lgkmcnt(4)
  v_mfma_f32_32x32x16_bf16 v[112:127], v[164:167], v[156:159], v[112:127]
  ds_read_b128 v[180:183], v51 offset:0
  ds_read_b128 v[184:187], v51 offset:4096
  v_mfma_f32_32x32x16_bf16 v[128:143], v[164:167], v[160:163], v[128:143]
  ds_read_b64_tr_b16 v[188:189], v57 offset:22528
  ds_read_b64_tr_b16 v[190:191], v57 offset:23040
  s_waitcnt lgkmcnt(4)
  s_barrier
  s_add_u32 s58, s58, 1
  s_cmp_eq_u32 s58, 5
  s_cselect_b32 s59, s61, 16384
  s_cselect_b32 s58, 0, s58
  v_add_u32 v48, s59, v48
  v_add_u32 v49, s59, v49
  v_add_u32 v50, s59, v50
  v_add_u32 v51, s59, v51
  v_mfma_f32_32x32x16_bf16 v[112:127], v[176:179], v[168:171], v[112:127]
  ds_read_b128 v[144:147], v48 offset:0
  ds_read_b128 v[148:151], v48 offset:4096
  v_mfma_f32_32x32x16_bf16 v[128:143], v[176:179], v[172:175], v[128:143]
  ds_read_b64_tr_b16 v[152:153], v57 offset:24576
  ds_read_b64_tr_b16 v[154:155], v57 offset:25088
  s_waitcnt lgkmcnt(4)
  v_mfma_f32_32x32x16_bf16 v[112:127], v[188:191], v[180:183], v[112:127]
  ds_read_b128 v[156:159], v49 offset:0
  ds_read_b128 v[160:163], v49 offset:4096
  v_mfma_f32_32x32x16_bf16 v[128:143], v[188:191], v[184:187], v[128:143]
  ds_read_b64_tr_b16 v[164:165], v57 offset:26624
  ds_read_b64_tr_b16 v[166:167], v57 offset:27136
  s_waitcnt lgkmcnt(4)
  v_mfma_f32_32x32x16_bf16 v[112:127], v[152:155], v[144:147], v[112:127]
  ds_read_b128 v[168:171], v50 offset:0
  ds_read_b128 v[172:175], v50 offset:4096
  v_mfma_f32_32x32x16_bf16 v[128:143], v[152:155], v[148:151], v[128:143]
  ds_read_b64_tr_b16 v[176:177], v57 offset:28672
  ds_read_b64_tr_b16 v[178:179], v57 offset:29184
  s_waitcnt lgkmcnt(4)
  v_mfma_f32_32x32x16_bf16 v[112:127], v[164:167], v[156:159], v[112:127]
  ds_read_b128 v[180:183], v51 offset:0
  ds_read_b128 v[184:187], v51 offset:4096
  v_mfma_f32_32x32x16_bf16 v[128:143], v[164:167], v[160:163], v[128:143]
  ds_read_b64_tr_b16 v[188:189], v57 offset:30720
  ds_read_b64_tr_b16 v[190:191], v57 offset:31232
  s_waitcnt lgkmcnt(4)
  s_barrier
  s_add_u32 s58, s58, 1
  s_cmp_eq_u32 s58, 5
  s_cselect_b32 s59, s61, 16384
  s_cselect_b32 s58, 0, s58
  v_add_u32 v48, s59, v48
  v_add_u32 v49, s59, v49
  v_add_u32 v50, s59, v50
  v_add_u32 v51, s59, v51
  v_mfma_f32_32x32x16_bf16 v[112:127], v[176:179], v[168:171], v[112:127]
  ds_read_b128 v[144:147], v48 offset:0
  ds_read_b128 v[148:151], v48 offset:4096
  v_mfma_f32_32x32x16_bf16 v[128:143], v[176:179], v[172:175], v[128:143]
  ds_read_b64_tr_b16 v[152:153], v57 offset:32768
  ds_read_b64_tr_b16 v[154:155], v57 offset:33280
  s_waitcnt lgkmcnt(4)
  v_mfma_f32_32x32x16_bf16 v[112:127], v[188:191], v[180:183], v[112:127]
  ds_read_b128 v[156:159], v49 offset:0
  ds_read_b128 v[160:163], v49 offset:4096
  v_mfma_f32_32x32x16_bf16 v[128:143], v[188:191], v[184:187], v[128:143]
  ds_read_b64_tr_b16 v[164:165], v57 offset:34816
  ds_read_b64_tr_b16 v[166:167], v57 offset:35328
  s_waitcnt lgkmcnt(4)
  v_mfma_f32_32x32x16_bf16 v[112:127], v[152:155], v[144:147], v[112:127]
  ds_read_b128 v[168:171], v50 offset:0
  ds_read_b128 v[172:175], v50 offset:4096
  v_mfma_f32_32x32x16_bf16 v[128:143], v[152:155], v[148:151], v[128:143]
  ds_read_b64_tr_b16 v[176:177], v57 offset:36864
  ds_read_b64_tr_b16 v[178:179], v57 offset:37376
  s_waitcnt lgkmcnt(4)
  v_mfma_f32_32x32x16_bf16 v[112:127], v[164:167], v[156:159], v[112:127]
  ds_read_b128 v[180:183], v51 offset:0
  ds_read_b128 v[184:187], v51 offset:4096
  v_mfma_f32_32x32x16_bf16 v[128:143], v[164:167], v[160:163], v[128:143]
  ds_read_b64_tr_b16 v[188:189], v57 offset:38912
  ds_read_b64_tr_b16 v[190:191], v57 offset:39424
  s_waitcnt lgkmcnt(4)
  v_mfma_f32_32x32x16_bf16 v[112:127], v[176:179], v[168:171], v[112:127]
  v_mfma_f32_32x32x16_bf16 v[128:143], v[176:179], v[172:175], v[128:143]
  s_waitcnt lgkmcnt(0)
  v_mfma_f32_32x32x16_bf16 v[112:127], v[188:191], v[180:183], v[112:127]
  v_mfma_f32_32x32x16_bf16 v[128:143], v[188:191], v[184:187], v[128:143]
  s_waitcnt vmcnt(0)
  s_lshl_b32 s35, s36, 1
  s_add_u32 s34, s35, 32
  s_lshl_b32 s35, s32, 2
  s_add_u32 s34, s34, s35
  s_mul_i32 s34, s34, s49
  s_add_u32 s52, s34, s50
  s_lshl_b32 s35, s36, 1
  s_add_u32 s34, s35, 33
  s_lshl_b32 s35, s32, 2
  s_add_u32 s34, s34, s35
  s_mul_i32 s34, s34, s49
  s_add_u32 s53, s34, s50
  v_mul_f32 v4, s51, v212
  v_mul_f32 v6, s51, v213
  v_mul_f32 v5, s51, v214
  v_mul_f32 v7, s51, v215
  v_mul_f32 v32, v6, v16
  v_mul_f32 v33, v6, v17
  v_mul_f32 v34, v6, v18
  v_mul_f32 v35, v6, v19
  v_fmac_f32 v32, v4, v112
  v_fmac_f32 v33, v4, v113
  v_fmac_f32 v34, v4, v114
  v_fmac_f32 v35, v4, v115
  v_cvt_pk_bf16_f32 v36, v32, v33
  v_cvt_pk_bf16_f32 v37, v34, v35
  buffer_store_dwordx2 v[36:37], v72, s[24:27], s52 offen sc1
  v_mul_f32 v38, v6, v20
  v_mul_f32 v39, v6, v21
  v_mul_f32 v40, v6, v22
  v_mul_f32 v41, v6, v23
  v_fmac_f32 v38, v4, v116
  v_fmac_f32 v39, v4, v117
  v_fmac_f32 v40, v4, v118
  v_fmac_f32 v41, v4, v119
  v_cvt_pk_bf16_f32 v42, v38, v39
  v_cvt_pk_bf16_f32 v43, v40, v41
  buffer_store_dwordx2 v[42:43], v73, s[24:27], s52 offen sc1
  v_mul_f32 v32, v6, v24
  v_mul_f32 v33, v6, v25
  v_mul_f32 v34, v6, v26
  v_mul_f32 v35, v6, v27
  v_fmac_f32 v32, v4, v120
  v_fmac_f32 v33, v4, v121
  v_fmac_f32 v34, v4, v122
  v_fmac_f32 v35, v4, v123
  v_cvt_pk_bf16_f32 v36, v32, v33
  v_cvt_pk_bf16_f32 v37, v34, v35
  buffer_store_dwordx2 v[36:37], v74, s[24:27], s52 offen sc1
  v_mul_f32 v38, v6, v28
  v_mul_f32 v39, v6, v29
  v_mul_f32 v40, v6, v30
  v_mul_f32 v41, v6, v31
  v_fmac_f32 v38, v4, v124
  v_fmac_f32 v39, v4, v125
  v_fmac_f32 v40, v4, v126
  v_fmac_f32 v41, v4, v127
  v_cvt_pk_bf16_f32 v42, v38, v39
  v_cvt_pk_bf16_f32 v43, v40, v41
  buffer_store_dwordx2 v[42:43], v75, s[24:27], s52 offen sc1
  v_mul_f32 v32, v7, v16
  v_mul_f32 v33, v7, v17
  v_mul_f32 v34, v7, v18
  v_mul_f32 v35, v7, v19
  v_fmac_f32 v32, v5, v128
  v_fmac_f32 v33, v5, v129
  v_fmac_f32 v34, v5, v130
  v_fmac_f32 v35, v5, v131
  v_cvt_pk_bf16_f32 v36, v32, v33
  v_cvt_pk_bf16_f32 v37, v34, v35
  buffer_store_dwordx2 v[36:37], v72, s[24:27], s53 offen sc1
  v_mul_f32 v38, v7, v20
  v_mul_f32 v39, v7, v21
  v_mul_f32 v40, v7, v22
  v_mul_f32 v41, v7, v23
  v_fmac_f32 v38, v5, v132
  v_fmac_f32 v39, v5, v133
  v_fmac_f32 v40, v5, v134
  v_fmac_f32 v41, v5, v135
  v_cvt_pk_bf16_f32 v42, v38, v39
  v_cvt_pk_bf16_f32 v43, v40, v41
  buffer_store_dwordx2 v[42:43], v73, s[24:27], s53 offen sc1
  v_mul_f32 v32, v7, v24
  v_mul_f32 v33, v7, v25
  v_mul_f32 v34, v7, v26
  v_mul_f32 v35, v7, v27
  v_fmac_f32 v32, v5, v136
  v_fmac_f32 v33, v5, v137
  v_fmac_f32 v34, v5, v138
  v_fmac_f32 v35, v5, v139
  v_cvt_pk_bf16_f32 v36, v32, v33
  v_cvt_pk_bf16_f32 v37, v34, v35
  buffer_store_dwordx2 v[36:37], v74, s[24:27], s53 offen sc1
  v_mul_f32 v38, v7, v28
  v_mul_f32 v39, v7, v29
  v_mul_f32 v40, v7, v30
  v_mul_f32 v41, v7, v31
  v_fmac_f32 v38, v5, v140
  v_fmac_f32 v39, v5, v141
  v_fmac_f32 v40, v5, v142
  v_fmac_f32 v41, v5, v143
  v_cvt_pk_bf16_f32 v42, v38, v39
  v_cvt_pk_bf16_f32 v43, v40, v41
  buffer_store_dwordx2 v[42:43], v75, s[24:27], s53 offen sc1
  s_waitcnt vmcnt(0)
  s_barrier
  s_cmp_lg_u32 s3, 0
  s_cbranch_scc1 L_qnp_20
  s_add_u32 s34, s33, 150
  s_lshl_b32 s90, s34, 8
  s_add_u32 s90, s90, 26681344
  v_mov_b32 v3, 1
  v_mov_b32 v4, 0
  s_mov_b64 exec, 1
  buffer_atomic_add v3, v4, s[24:27], s90 offen sc1
  s_mov_b64 exec, -1
L_qnp_20:
  s_branch L_p1_done
L_qv_4:
  s_movk_i32 s49, 2560
  s_mov_b32 s50, 2622720
  v_and_b32 v3, 31, v1
  v_lshrrev_b32 v4, 5, v1
  s_sub_u32 s54, s33, 20
  s_lshl_b32 s54, s54, 6
  s_movk_i32 s55, 3277
  s_mov_b32 s48, 163840
  s_lshl_b32 s34, s37, 5
  s_add_u32 s34, s34, s54
  v_add_u32 v8, s34, v3
  v_mul_u32_u24 v9, s55, v8
  v_lshrrev_b32 v9, 16, v9
  v_mul_u32_u24 v10, 20, v9
  v_sub_u32 v8, v8, v10
  v_mul_lo_u32 v9, v9, s48
  v_lshl_add_u32 v9, v8, 4, v9
  v_mul_u32_u24 v10, 320, v4
  v_add_u32 v72, v9, v10
  v_mov_b32 v80, 0
  v_mov_b32 v81, 0
  v_mov_b32 v82, 0
  v_mov_b32 v83, 0
  v_mov_b32 v84, 0
  v_mov_b32 v85, 0
  v_mov_b32 v86, 0
  v_mov_b32 v87, 0
  v_mov_b32 v88, 0
  v_mov_b32 v89, 0
  v_mov_b32 v90, 0
  v_mov_b32 v91, 0
  v_mov_b32 v92, 0
  v_mov_b32 v93, 0
  v_mov_b32 v94, 0
  v_mov_b32 v95, 0
  v_mov_b32 v96, 0
  v_mov_b32 v97, 0
  v_mov_b32 v98, 0
  v_mov_b32 v99, 0
  v_mov_b32 v100, 0
  v_mov_b32 v101, 0
  v_mov_b32 v102, 0
  v_mov_b32 v103, 0
  v_mov_b32 v104, 0
  v_mov_b32 v105, 0
  v_mov_b32 v106, 0
  v_mov_b32 v107, 0
  v_mov_b32 v108, 0
  v_mov_b32 v109, 0
  v_mov_b32 v110, 0
  v_mov_b32 v111, 0
  v_mov_b32 v112, 0
  v_mov_b32 v113, 0
  v_mov_b32 v114, 0
  v_mov_b32 v115, 0
  v_mov_b32 v116, 0
  v_mov_b32 v117, 0
  v_mov_b32 v118, 0
  v_mov_b32 v119, 0
  v_mov_b32 v120, 0
  v_mov_b32 v121, 0
  v_mov_b32 v122, 0
  v_mov_b32 v123, 0
  v_mov_b32 v124, 0
  v_mov_b32 v125, 0
  v_mov_b32 v126, 0
  v_mov_b32 v127, 0
  v_mov_b32 v128, 0
  v_mov_b32 v129, 0
  v_mov_b32 v130, 0
  v_mov_b32 v131, 0
  v_mov_b32 v132, 0
  v_mov_b32 v133, 0
  v_mov_b32 v134, 0
  v_mov_b32 v135, 0
  v_mov_b32 v136, 0
  v_mov_b32 v137, 0
  v_mov_b32 v138, 0
  v_mov_b32 v139, 0
  v_mov_b32 v140, 0
  v_mov_b32 v141, 0
  v_mov_b32 v142, 0
  v_mov_b32 v143, 0
  s_barrier
  ds_read_b128 v[144:147], v48 offset:0
  ds_read_b128 v[148:151], v48 offset:4096
  ds_read_b64_tr_b16 v[152:153], v56 offset:0
  ds_read_b64_tr_b16 v[154:155], v56 offset:512
  ds_read_b128 v[156:159], v49 offset:0
  ds_read_b128 v[160:163], v49 offset:4096
  ds_read_b64_tr_b16 v[164:165], v56 offset:2048
  ds_read_b64_tr_b16 v[166:167], v56 offset:2560
  s_waitcnt lgkmcnt(4)
  v_mfma_f32_32x32x16_bf16 v[80:95], v[144:147], v[152:155], v[80:95]
  ds_read_b128 v[168:171], v50 offset:0
  ds_read_b128 v[172:175], v50 offset:4096
  v_mfma_f32_32x32x16_bf16 v[96:111], v[148:151], v[152:155], v[96:111]
  ds_read_b64_tr_b16 v[176:177], v56 offset:4096
  ds_read_b64_tr_b16 v[178:179], v56 offset:4608
  s_waitcnt lgkmcnt(4)
  v_mfma_f32_32x32x16_bf16 v[80:95], v[156:159], v[164:167], v[80:95]
  ds_read_b128 v[180:183], v51 offset:0
  ds_read_b128 v[184:187], v51 offset:4096
  v_mfma_f32_32x32x16_bf16 v[96:111], v[160:163], v[164:167], v[96:111]
  ds_read_b64_tr_b16 v[188:189], v56 offset:6144
  ds_read_b64_tr_b16 v[190:191], v56 offset:6656
  s_waitcnt lgkmcnt(4)
  s_barrier
  s_add_u32 s58, s58, 1
  s_cmp_eq_u32 s58, 5
  s_cselect_b32 s59, s61, 16384
  s_cselect_b32 s58, 0, s58
  v_add_u32 v48, s59, v48
  v_add_u32 v49, s59, v49
  v_add_u32 v50, s59, v50
  v_add_u32 v51, s59, v51
  v_mfma_f32_32x32x16_bf16 v[80:95], v[168:171], v[176:179], v[80:95]
  ds_read_b128 v[144:147], v48 offset:0
  ds_read_b128 v[148:151], v48 offset:4096
  v_mfma_f32_32x32x16_bf16 v[96:111], v[172:175], v[176:179], v[96:111]
  ds_read_b64_tr_b16 v[152:153], v56 offset:8192
  ds_read_b64_tr_b16 v[154:155], v56 offset:8704
  s_waitcnt lgkmcnt(4)
  v_mfma_f32_32x32x16_bf16 v[80:95], v[180:183], v[188:191], v[80:95]
  ds_read_b128 v[156:159], v49 offset:0
  ds_read_b128 v[160:163], v49 offset:4096
  v_mfma_f32_32x32x16_bf16 v[96:111], v[184:187], v[188:191], v[96:111]
  ds_read_b64_tr_b16 v[164:165], v56 offset:10240
  ds_read_b64_tr_b16 v[166:167], v56 offset:10752
  s_waitcnt vmcnt(0)
  s_cmp_lg_u32 s3, 0
  s_cbranch_scc1 L_p0s_21
  s_cmp_ge_u32 s2, 240
  s_cbranch_scc1 L_p0e_22
  v_mov_b32 v248, 0
  v_mov_b32 v249, 0
  v_mov_b32 v250, 0
  v_mov_b32 v251, 0
  v_mov_b32 v252, 0
  v_mov_b32 v253, 0
  v_mov_b32 v254, 0
  v_mov_b32 v255, 0
  v_lshlrev_b32 v16, 16, v208
  v_and_b32 v17, 0xffff0000, v208
  v_add_f32 v248, v248, v16
  v_add_f32 v249, v249, v17
  v_lshlrev_b32 v16, 16, v209
  v_and_b32 v17, 0xffff0000, v209
  v_add_f32 v250, v250, v16
  v_add_f32 v251, v251, v17
  v_lshlrev_b32 v16, 16, v210
  v_and_b32 v17, 0xffff0000, v210
  v_add_f32 v252, v252, v16
  v_add_f32 v253, v253, v17
  v_lshlrev_b32 v16, 16, v211
  v_and_b32 v17, 0xffff0000, v211
  v_add_f32 v254, v254, v16
  v_add_f32 v255, v255, v17
  v_lshlrev_b32 v16, 16, v212
  v_and_b32 v17, 0xffff0000, v212
  v_add_f32 v248, v248, v16
  v_add_f32 v249, v249, v17
  v_lshlrev_b32 v16, 16, v213
  v_and_b32 v17, 0xffff0000, v213
  v_add_f32 v250, v250, v16
  v_add_f32 v251, v251, v17
  v_lshlrev_b32 v16, 16, v214
  v_and_b32 v17, 0xffff0000, v214
  v_add_f32 v252, v252, v16
  v_add_f32 v253, v253, v17
  v_lshlrev_b32 v16, 16, v215
  v_and_b32 v17, 0xffff0000, v215
  v_add_f32 v254, v254, v16
  v_add_f32 v255, v255, v17
  v_lshlrev_b32 v16, 16, v216
  v_and_b32 v17, 0xffff0000, v216
  v_add_f32 v248, v248, v16
  v_add_f32 v249, v249, v17
  v_lshlrev_b32 v16, 16, v217
  v_and_b32 v17, 0xffff0000, v217
  v_add_f32 v250, v250, v16
  v_add_f32 v251, v251, v17
  v_lshlrev_b32 v16, 16, v218
  v_and_b32 v17, 0xffff0000, v218
  v_add_f32 v252, v252, v16
  v_add_f32 v253, v253, v17
  v_lshlrev_b32 v16, 16, v219
  v_and_b32 v17, 0xffff0000, v219
  v_add_f32 v254, v254, v16
  v_add_f32 v255, v255, v17
  v_lshlrev_b32 v16, 16, v220
  v_and_b32 v17, 0xffff0000, v220
  v_add_f32 v248, v248, v16
  v_add_f32 v249, v249, v17
  v_lshlrev_b32 v16, 16, v221
  v_and_b32 v17, 0xffff0000, v221
  v_add_f32 v250, v250, v16
  v_add_f32 v251, v251, v17
  v_lshlrev_b32 v16, 16, v222
  v_and_b32 v17, 0xffff0000, v222
  v_add_f32 v252, v252, v16
  v_add_f32 v253, v253, v17
  v_lshlrev_b32 v16, 16, v223
  v_and_b32 v17, 0xffff0000, v223
  v_add_f32 v254, v254, v16
  v_add_f32 v255, v255, v17
  v_lshlrev_b32 v16, 16, v224
  v_and_b32 v17, 0xffff0000, v224
  v_add_f32 v248, v248, v16
  v_add_f32 v249, v249, v17
  v_lshlrev_b32 v16, 16, v225
  v_and_b32 v17, 0xffff0000, v225
  v_add_f32 v250, v250, v16
  v_add_f32 v251, v251, v17
  v_lshlrev_b32 v16, 16, v226
  v_and_b32 v17, 0xffff0000, v226
  v_add_f32 v252, v252, v16
  v_add_f32 v253, v253, v17
  v_lshlrev_b32 v16, 16, v227
  v_and_b32 v17, 0xffff0000, v227
  v_add_f32 v254, v254, v16
  v_add_f32 v255, v255, v17
  v_lshlrev_b32 v16, 16, v228
  v_and_b32 v17, 0xffff0000, v228
  v_add_f32 v248, v248, v16
  v_add_f32 v249, v249, v17
  v_lshlrev_b32 v16, 16, v229
  v_and_b32 v17, 0xffff0000, v229
  v_add_f32 v250, v250, v16
  v_add_f32 v251, v251, v17
  v_lshlrev_b32 v16, 16, v230
  v_and_b32 v17, 0xffff0000, v230
  v_add_f32 v252, v252, v16
  v_add_f32 v253, v253, v17
  v_lshlrev_b32 v16, 16, v231
  v_and_b32 v17, 0xffff0000, v231
  v_add_f32 v254, v254, v16
  v_add_f32 v255, v255, v17
  v_lshlrev_b32 v16, 16, v232
  v_and_b32 v17, 0xffff0000, v232
  v_add_f32 v248, v248, v16
  v_add_f32 v249, v249, v17
  v_lshlrev_b32 v16, 16, v233
  v_and_b32 v17, 0xffff0000, v233
  v_add_f32 v250, v250, v16
  v_add_f32 v251, v251, v17
  v_lshlrev_b32 v16, 16, v234
  v_and_b32 v17, 0xffff0000, v234
  v_add_f32 v252, v252, v16
  v_add_f32 v253, v253, v17
  v_lshlrev_b32 v16, 16, v235
  v_and_b32 v17, 0xffff0000, v235
  v_add_f32 v254, v254, v16
  v_add_f32 v255, v255, v17
  v_lshlrev_b32 v16, 16, v236
  v_and_b32 v17, 0xffff0000, v236
  v_add_f32 v248, v248, v16
  v_add_f32 v249, v249, v17
  v_lshlrev_b32 v16, 16, v237
  v_and_b32 v17, 0xffff0000, v237
  v_add_f32 v250, v250, v16
  v_add_f32 v251, v251, v17
  v_lshlrev_b32 v16, 16, v238
  v_and_b32 v17, 0xffff0000, v238
  v_add_f32 v252, v252, v16
  v_add_f32 v253, v253, v17
  v_lshlrev_b32 v16, 16, v239
  v_and_b32 v17, 0xffff0000, v239
  v_add_f32 v254, v254, v16
  v_add_f32 v255, v255, v17
  v_lshlrev_b32 v16, 16, v240
  v_and_b32 v17, 0xffff0000, v240
  v_add_f32 v248, v248, v16
  v_add_f32 v249, v249, v17
  v_lshlrev_b32 v16, 16, v241
  v_and_b32 v17, 0xffff0000, v241
  v_add_f32 v250, v250, v16
  v_add_f32 v251, v251, v17
  v_lshlrev_b32 v16, 16, v242
  v_and_b32 v17, 0xffff0000, v242
  v_add_f32 v252, v252, v16
  v_add_f32 v253, v253, v17
  v_lshlrev_b32 v16, 16, v243
  v_and_b32 v17, 0xffff0000, v243
  v_add_f32 v254, v254, v16
  v_add_f32 v255, v255, v17
  v_lshlrev_b32 v16, 16, v244
  v_and_b32 v17, 0xffff0000, v244
  v_add_f32 v248, v248, v16
  v_add_f32 v249, v249, v17
  v_lshlrev_b32 v16, 16, v245
  v_and_b32 v17, 0xffff0000, v245
  v_add_f32 v250, v250, v16
  v_add_f32 v251, v251, v17
  v_lshlrev_b32 v16, 16, v246
  v_and_b32 v17, 0xffff0000, v246
  v_add_f32 v252, v252, v16
  v_add_f32 v253, v253, v17
  v_lshlrev_b32 v16, 16, v247
  v_and_b32 v17, 0xffff0000, v247
  v_add_f32 v254, v254, v16
  v_add_f32 v255, v255, v17
  v_add_f32_dpp v248, v248, v248 row_ror:8 row_mask:0xf bank_mask:0xf
  v_add_f32_dpp v249, v249, v249 row_ror:8 row_mask:0xf bank_mask:0xf
  v_add_f32_dpp v250, v250, v250 row_ror:8 row_mask:0xf bank_mask:0xf
  v_add_f32_dpp v251, v251, v251 row_ror:8 row_mask:0xf bank_mask:0xf
  v_add_f32_dpp v252, v252, v252 row_ror:8 row_mask:0xf bank_mask:0xf
  v_add_f32_dpp v253, v253, v253 row_ror:8 row_mask:0xf bank_mask:0xf
  v_add_f32_dpp v254, v254, v254 row_ror:8 row_mask:0xf bank_mask:0xf
  v_add_f32_dpp v255, v255, v255 row_ror:8 row_mask:0xf bank_mask:0xf
  v_mov_b32 v16, v248
  s_nop 1
  v_permlane16_swap_b32 v248, v16
  v_add_f32 v248, v248, v16
  v_mov_b32 v16, v249
  s_nop 1
  v_permlane16_swap_b32 v249, v16
  v_add_f32 v249, v249, v16
  v_mov_b32 v16, v250
  s_nop 1
  v_permlane16_swap_b32 v250, v16
  v_add_f32 v250, v250, v16
  v_mov_b32 v16, v251
  s_nop 1
  v_permlane16_swap_b32 v251, v16
  v_add_f32 v251, v251, v16
  v_mov_b32 v16, v252
  s_nop 1
  v_permlane16_swap_b32 v252, v16
  v_add_f32 v252, v252, v16
  v_mov_b32 v16, v253
  s_nop 1
  v_permlane16_swap_b32 v253, v16
  v_add_f32 v253, v253, v16
  v_mov_b32 v16, v254
  s_nop 1
  v_permlane16_swap_b32 v254, v16
  v_add_f32 v254, v254, v16
  v_mov_b32 v16, v255
  s_nop 1
  v_permlane16_swap_b32 v255, v16
  v_add_f32 v255, v255, v16
  v_mov_b32 v16, v248
  s_nop 1
  v_permlane32_swap_b32 v248, v16
  v_add_f32 v248, v248, v16
  v_mov_b32 v16, v249
  s_nop 1
  v_permlane32_swap_b32 v249, v16
  v_add_f32 v249, v249, v16
  v_mov_b32 v16, v250
  s_nop 1
  v_permlane32_swap_b32 v250, v16
  v_add_f32 v250, v250, v16
  v_mov_b32 v16, v251
  s_nop 1
  v_permlane32_swap_b32 v251, v16
  v_add_f32 v251, v251, v16
  v_mov_b32 v16, v252
  s_nop 1
  v_permlane32_swap_b32 v252, v16
  v_add_f32 v252, v252, v16
  v_mov_b32 v16, v253
  s_nop 1
  v_permlane32_swap_b32 v253, v16
  v_add_f32 v253, v253, v16
  v_mov_b32 v16, v254
  s_nop 1
  v_permlane32_swap_b32 v254, v16
  v_add_f32 v254, v254, v16
  v_mov_b32 v16, v255
  s_nop 1
  v_permlane32_swap_b32 v255, v16
  v_add_f32 v255, v255, v16
  s_mul_i32 s34, s84, 7680
  s_lshl_b32 s35, s85, 8
  s_add_u32 s34, s34, s35
  s_add_u32 s34, s34, 26374144
  v_lshlrev_b32 v16, 5, v1
  s_mov_b64 exec, 0xff
  buffer_store_dwordx4 v[248:251], v16, s[24:27], s34 offen sc1
  buffer_store_dwordx4 v[252:255], v16, s[24:27], s34 offen offset:16 sc1
  s_mov_b64 exec, -1
  s_branch L_p0e_22
L_p0s_21:
  v_mov_b32 v224, 0
  v_mov_b32 v225, 0
  v_mov_b32 v226, 0
  v_mov_b32 v227, 0
  v_mov_b32 v228, 0
  v_mov_b32 v229, 0
  v_and_b32 v16, 0xffff0000, v208
  v_lshlrev_b32 v17, 16, v208
  v_add_f32 v224, v224, v16
  v_fmac_f32 v225, v16, v16
  v_add_f32 v224, v224, v17
  v_fmac_f32 v225, v17, v17
  v_and_b32 v16, 0xffff0000, v209
  v_lshlrev_b32 v17, 16, v209
  v_add_f32 v224, v224, v16
  v_fmac_f32 v225, v16, v16
  v_add_f32 v224, v224, v17
  v_fmac_f32 v225, v17, v17
  v_and_b32 v16, 0xffff0000, v210
  v_lshlrev_b32 v17, 16, v210
  v_add_f32 v224, v224, v16
  v_fmac_f32 v225, v16, v16
  v_add_f32 v224, v224, v17
  v_fmac_f32 v225, v17, v17
  v_and_b32 v16, 0xffff0000, v211
  v_lshlrev_b32 v17, 16, v211
  v_add_f32 v224, v224, v16
  v_fmac_f32 v225, v16, v16
  v_add_f32 v224, v224, v17
  v_fmac_f32 v225, v17, v17
  v_and_b32 v16, 0xffff0000, v212
  v_lshlrev_b32 v17, 16, v212
  v_add_f32 v224, v224, v16
  v_fmac_f32 v225, v16, v16
  v_add_f32 v224, v224, v17
  v_fmac_f32 v225, v17, v17
  v_and_b32 v16, 0xffff0000, v213
  v_lshlrev_b32 v17, 16, v213
  v_add_f32 v226, v226, v16
  v_fmac_f32 v227, v16, v16
  v_add_f32 v226, v226, v17
  v_fmac_f32 v227, v17, v17
  v_and_b32 v16, 0xffff0000, v214
  v_lshlrev_b32 v17, 16, v214
  v_add_f32 v226, v226, v16
  v_fmac_f32 v227, v16, v16
  v_add_f32 v226, v226, v17
  v_fmac_f32 v227, v17, v17
  v_and_b32 v16, 0xffff0000, v215
  v_lshlrev_b32 v17, 16, v215
  v_add_f32 v226, v226, v16
  v_fmac_f32 v227, v16, v16
  v_add_f32 v226, v226, v17
  v_fmac_f32 v227, v17, v17
  v_and_b32 v16, 0xffff0000, v216
  v_lshlrev_b32 v17, 16, v216
  v_add_f32 v226, v226, v16
  v_fmac_f32 v227, v16, v16
  v_add_f32 v226, v226, v17
  v_fmac_f32 v227, v17, v17
  v_and_b32 v16, 0xffff0000, v217
  v_lshlrev_b32 v17, 16, v217
  v_add_f32 v226, v226, v16
  v_fmac_f32 v227, v16, v16
  v_add_f32 v226, v226, v17
  v_fmac_f32 v227, v17, v17
  v_and_b32 v16, 0xffff0000, v218
  v_lshlrev_b32 v17, 16, v218
  v_add_f32 v228, v228, v16
  v_fmac_f32 v229, v16, v16
  v_add_f32 v228, v228, v17
  v_fmac_f32 v229, v17, v17
  v_and_b32 v16, 0xffff0000, v219
  v_lshlrev_b32 v17, 16, v219
  v_add_f32 v228, v228, v16
  v_fmac_f32 v229, v16, v16
  v_add_f32 v228, v228, v17
  v_fmac_f32 v229, v17, v17
  v_and_b32 v16, 0xffff0000, v220
  v_lshlrev_b32 v17, 16, v220
  v_add_f32 v228, v228, v16
  v_fmac_f32 v229, v16, v16
  v_add_f32 v228, v228, v17
  v_fmac_f32 v229, v17, v17
  v_and_b32 v16, 0xffff0000, v221
  v_lshlrev_b32 v17, 16, v221
  v_add_f32 v228, v228, v16
  v_fmac_f32 v229, v16, v16
  v_add_f32 v228, v228, v17
  v_fmac_f32 v229, v17, v17
  v_and_b32 v16, 0xffff0000, v222
  v_lshlrev_b32 v17, 16, v222
  v_add_f32 v228, v228, v16
  v_fmac_f32 v229, v16, v16
  v_add_f32 v228, v228, v17
  v_fmac_f32 v229, v17, v17
  v_add_f32_dpp v224, v224, v224 row_ror:8 row_mask:0xf bank_mask:0xf
  v_add_f32_dpp v225, v225, v225 row_ror:8 row_mask:0xf bank_mask:0xf
  v_add_f32_dpp v226, v226, v226 row_ror:8 row_mask:0xf bank_mask:0xf
  v_add_f32_dpp v227, v227, v227 row_ror:8 row_mask:0xf bank_mask:0xf
  v_add_f32_dpp v228, v228, v228 row_ror:8 row_mask:0xf bank_mask:0xf
  v_add_f32_dpp v229, v229, v229 row_ror:8 row_mask:0xf bank_mask:0xf
  v_add_f32_dpp v224, v224, v224 row_ror:4 row_mask:0xf bank_mask:0xf
  v_add_f32_dpp v225, v225, v225 row_ror:4 row_mask:0xf bank_mask:0xf
  v_add_f32_dpp v226, v226, v226 row_ror:4 row_mask:0xf bank_mask:0xf
  v_add_f32_dpp v227, v227, v227 row_ror:4 row_mask:0xf bank_mask:0xf
  v_add_f32_dpp v228, v228, v228 row_ror:4 row_mask:0xf bank_mask:0xf
  v_add_f32_dpp v229, v229, v229 row_ror:4 row_mask:0xf bank_mask:0xf
  v_add_f32_dpp v224, v224, v224 row_ror:2 row_mask:0xf bank_mask:0xf
  v_add_f32_dpp v225, v225, v225 row_ror:2 row_mask:0xf bank_mask:0xf
  v_add_f32_dpp v226, v226, v226 row_ror:2 row_mask:0xf bank_mask:0xf
  v_add_f32_dpp v227, v227, v227 row_ror:2 row_mask:0xf bank_mask:0xf
  v_add_f32_dpp v228, v228, v228 row_ror:2 row_mask:0xf bank_mask:0xf
  v_add_f32_dpp v229, v229, v229 row_ror:2 row_mask:0xf bank_mask:0xf
  v_add_f32_dpp v224, v224, v224 row_ror:1 row_mask:0xf bank_mask:0xf
  v_add_f32_dpp v225, v225, v225 row_ror:1 row_mask:0xf bank_mask:0xf
  v_add_f32_dpp v226, v226, v226 row_ror:1 row_mask:0xf bank_mask:0xf
  v_add_f32_dpp v227, v227, v227 row_ror:1 row_mask:0xf bank_mask:0xf
  v_add_f32_dpp v228, v228, v228 row_ror:1 row_mask:0xf bank_mask:0xf
  v_add_f32_dpp v229, v229, v229 row_ror:1 row_mask:0xf bank_mask:0xf
  v_mov_b32 v16, v224
  s_nop 1
  v_permlane16_swap_b32 v224, v16
  v_add_f32 v224, v224, v16
  v_mov_b32 v16, v225
  s_nop 1
  v_permlane16_swap_b32 v225, v16
  v_add_f32 v225, v225, v16
  v_mov_b32 v16, v226
  s_nop 1
  v_permlane16_swap_b32 v226, v16
  v_add_f32 v226, v226, v16
  v_mov_b32 v16, v227
  s_nop 1
  v_permlane16_swap_b32 v227, v16
  v_add_f32 v227, v227, v16
  v_mov_b32 v16, v228
  s_nop 1
  v_permlane16_swap_b32 v228, v16
  v_add_f32 v228, v228, v16
  v_mov_b32 v16, v229
  s_nop 1
  v_permlane16_swap_b32 v229, v16
  v_add_f32 v229, v229, v16
  v_mov_b32 v16, v224
  s_nop 1
  v_permlane32_swap_b32 v224, v16
  v_add_f32 v224, v224, v16
  v_mov_b32 v16, v225
  s_nop 1
  v_permlane32_swap_b32 v225, v16
  v_add_f32 v225, v225, v16
  v_mov_b32 v16, v226
  s_nop 1
  v_permlane32_swap_b32 v226, v16
  v_add_f32 v226, v226, v16
  v_mov_b32 v16, v227
  s_nop 1
  v_permlane32_swap_b32 v227, v16
  v_add_f32 v227, v227, v16
  v_mov_b32 v16, v228
  s_nop 1
  v_permlane32_swap_b32 v228, v16
  v_add_f32 v228, v228, v16
  v_mov_b32 v16, v229
  s_nop 1
  v_permlane32_swap_b32 v229, v16
  v_add_f32 v229, v229, v16
  v_mul_f32 v16, 0x3acccccd, v224
  v_mul_f32 v17, 0x3acccccd, v225
  v_fma_f32 v17, -v16, v16, v17
  v_max_f32 v17, 0, v17
  v_add_f32 v17, 0x3727c5ac, v17
  v_rsq_f32 v232, v17
  s_nop 0
  v_mul_f32 v233, v16, v232
  v_sub_f32 v233, 0, v233
  s_lshl_b32 s34, s84, 3
  s_add_u32 s34, s34, 26357760
  v_mov_b32 v16, 0
  s_mov_b64 exec, 1
  buffer_store_dwordx2 v[232:233], v16, s[24:27], s34 offen sc1
  s_mov_b64 exec, -1
  v_mul_f32 v16, 0x3acccccd, v226
  v_mul_f32 v17, 0x3acccccd, v227
  v_fma_f32 v17, -v16, v16, v17
  v_max_f32 v17, 0, v17
  v_add_f32 v17, 0x3727c5ac, v17
  v_rsq_f32 v234, v17
  s_nop 0
  v_mul_f32 v235, v16, v234
  v_sub_f32 v235, 0, v235
  s_lshl_b32 s34, s85, 3
  s_add_u32 s34, s34, 26357760
  v_mov_b32 v16, 0
  s_mov_b64 exec, 1
  buffer_store_dwordx2 v[234:235], v16, s[24:27], s34 offen sc1
  s_mov_b64 exec, -1
  v_mul_f32 v16, 0x3acccccd, v228
  v_mul_f32 v17, 0x3acccccd, v229
  v_fma_f32 v17, -v16, v16, v17
  v_max_f32 v17, 0, v17
  v_add_f32 v17, 0x3727c5ac, v17
  v_rsq_f32 v236, v17
  s_nop 0
  v_mul_f32 v237, v16, v236
  v_sub_f32 v237, 0, v237
  s_lshl_b32 s34, s86, 3
  s_add_u32 s34, s34, 26357760
  v_mov_b32 v16, 0
  s_mov_b64 exec, 1
  buffer_store_dwordx2 v[236:237], v16, s[24:27], s34 offen sc1
  s_mov_b64 exec, -1
L_p0e_22:
  s_waitcnt lgkmcnt(4)
  v_mfma_f32_32x32x16_bf16 v[80:95], v[144:147], v[152:155], v[80:95]
  ds_read_b128 v[168:171], v50 offset:0
  ds_read_b128 v[172:175], v50 offset:4096
  v_mfma_f32_32x32x16_bf16 v[96:111], v[148:151], v[152:155], v[96:111]
  ds_read_b64_tr_b16 v[176:177], v56 offset:12288
  ds_read_b64_tr_b16 v[178:179], v56 offset:12800
  s_waitcnt lgkmcnt(4)
  v_mfma_f32_32x32x16_bf16 v[80:95], v[156:159], v[164:167], v[80:95]
  ds_read_b128 v[180:183], v51 offset:0
  ds_read_b128 v[184:187], v51 offset:4096
  v_mfma_f32_32x32x16_bf16 v[96:111], v[160:163], v[164:167], v[96:111]
  ds_read_b64_tr_b16 v[188:189], v56 offset:14336
  ds_read_b64_tr_b16 v[190:191], v56 offset:14848
  s_waitcnt lgkmcnt(4)
  s_waitcnt vmcnt(0)
  s_barrier
  s_add_u32 s58, s58, 1
  s_cmp_eq_u32 s58, 5
  s_cselect_b32 s59, s61, 16384
  s_cselect_b32 s58, 0, s58
  v_add_u32 v48, s59, v48
  v_add_u32 v49, s59, v49
  v_add_u32 v50, s59, v50
  v_add_u32 v51, s59, v51
  s_cmp_lg_u32 s3, 0
  s_cbranch_scc1 L_np1_23
  v_mov_b32 v3, 1
  s_and_b32 s90, s2, 7
  s_mov_b64 exec, 1
  s_lshl_b32 s90, s90, 5
  v_mov_b32 v4, s90
  buffer_atomic_add v3, v4, s[28:31], 0 offen sc1
  s_mov_b64 exec, -1
L_np1_23:
  v_mfma_f32_32x32x16_bf16 v[80:95], v[168:171], v[176:179], v[80:95]
  ds_read_b128 v[144:147], v48 offset:0
  ds_read_b128 v[148:151], v48 offset:4096
  v_mfma_f32_32x32x16_bf16 v[96:111], v[172:175], v[176:179], v[96:111]
  ds_read_b64_tr_b16 v[152:153], v56 offset:16384
  ds_read_b64_tr_b16 v[154:155], v56 offset:16896
  s_waitcnt lgkmcnt(4)
  v_mfma_f32_32x32x16_bf16 v[80:95], v[180:183], v[188:191], v[80:95]
  ds_read_b128 v[156:159], v49 offset:0
  ds_read_b128 v[160:163], v49 offset:4096
  v_mfma_f32_32x32x16_bf16 v[96:111], v[184:187], v[188:191], v[96:111]
  ds_read_b64_tr_b16 v[164:165], v56 offset:18432
  ds_read_b64_tr_b16 v[166:167], v56 offset:18944
  s_waitcnt lgkmcnt(4)
  v_mfma_f32_32x32x16_bf16 v[80:95], v[144:147], v[152:155], v[80:95]
  ds_read_b128 v[168:171], v50 offset:0
  ds_read_b128 v[172:175], v50 offset:4096
  v_mfma_f32_32x32x16_bf16 v[96:111], v[148:151], v[152:155], v[96:111]
  ds_read_b64_tr_b16 v[176:177], v56 offset:20480
  ds_read_b64_tr_b16 v[178:179], v56 offset:20992
  s_waitcnt lgkmcnt(4)
  v_mfma_f32_32x32x16_bf16 v[80:95], v[156:159], v[164:167], v[80:95]
  ds_read_b128 v[180:183], v51 offset:0
  ds_read_b128 v[184:187], v51 offset:4096
  v_mfma_f32_32x32x16_bf16 v[96:111], v[160:163], v[164:167], v[96:111]
  ds_read_b64_tr_b16 v[188:189], v56 offset:22528
  ds_read_b64_tr_b16 v[190:191], v56 offset:23040
  s_waitcnt lgkmcnt(4)
  s_barrier
  s_add_u32 s58, s58, 1
  s_cmp_eq_u32 s58, 5
  s_cselect_b32 s59, s61, 16384
  s_cselect_b32 s58, 0, s58
  v_add_u32 v48, s59, v48
  v_add_u32 v49, s59, v49
  v_add_u32 v50, s59, v50
  v_add_u32 v51, s59, v51
  v_mfma_f32_32x32x16_bf16 v[80:95], v[168:171], v[176:179], v[80:95]
  ds_read_b128 v[144:147], v48 offset:0
  ds_read_b128 v[148:151], v48 offset:4096
  v_mfma_f32_32x32x16_bf16 v[96:111], v[172:175], v[176:179], v[96:111]
  ds_read_b64_tr_b16 v[152:153], v56 offset:24576
  ds_read_b64_tr_b16 v[154:155], v56 offset:25088
  s_waitcnt lgkmcnt(4)
  v_mfma_f32_32x32x16_bf16 v[80:95], v[180:183], v[188:191], v[80:95]
  ds_read_b128 v[156:159], v49 offset:0
  ds_read_b128 v[160:163], v49 offset:4096
  v_mfma_f32_32x32x16_bf16 v[96:111], v[184:187], v[188:191], v[96:111]
  ds_read_b64_tr_b16 v[164:165], v56 offset:26624
  ds_read_b64_tr_b16 v[166:167], v56 offset:27136
  s_waitcnt lgkmcnt(4)
  v_mfma_f32_32x32x16_bf16 v[80:95], v[144:147], v[152:155], v[80:95]
  ds_read_b128 v[168:171], v50 offset:0
  ds_read_b128 v[172:175], v50 offset:4096
  v_mfma_f32_32x32x16_bf16 v[96:111], v[148:151], v[152:155], v[96:111]
  ds_read_b64_tr_b16 v[176:177], v56 offset:28672
  ds_read_b64_tr_b16 v[178:179], v56 offset:29184
  s_waitcnt lgkmcnt(4)
  v_mfma_f32_32x32x16_bf16 v[80:95], v[156:159], v[164:167], v[80:95]
  ds_read_b128 v[180:183], v51 offset:0
  ds_read_b128 v[184:187], v51 offset:4096
  v_mfma_f32_32x32x16_bf16 v[96:111], v[160:163], v[164:167], v[96:111]
  ds_read_b64_tr_b16 v[188:189], v56 offset:30720
  ds_read_b64_tr_b16 v[190:191], v56 offset:31232
  s_waitcnt lgkmcnt(4)
  s_barrier
  s_add_u32 s58, s58, 1
  s_cmp_eq_u32 s58, 5
  s_cselect_b32 s59, s61, 16384
  s_cselect_b32 s58, 0, s58
  v_add_u32 v48, s59, v48
  v_add_u32 v49, s59, v49
  v_add_u32 v50, s59, v50
  v_add_u32 v51, s59, v51
  v_mfma_f32_32x32x16_bf16 v[80:95], v[168:171], v[176:179], v[80:95]
  ds_read_b128 v[144:147], v48 offset:0
  ds_read_b128 v[148:151], v48 offset:4096
  v_mfma_f32_32x32x16_bf16 v[96:111], v[172:175], v[176:179], v[96:111]
  ds_read_b64_tr_b16 v[152:153], v56 offset:32768
  ds_read_b64_tr_b16 v[154:155], v56 offset:33280
  s_waitcnt lgkmcnt(4)
  v_mfma_f32_32x32x16_bf16 v[80:95], v[180:183], v[188:191], v[80:95]
  ds_read_b128 v[156:159], v49 offset:0
  ds_read_b128 v[160:163], v49 offset:4096
  v_mfma_f32_32x32x16_bf16 v[96:111], v[184:187], v[188:191], v[96:111]
  ds_read_b64_tr_b16 v[164:165], v56 offset:34816
  ds_read_b64_tr_b16 v[166:167], v56 offset:35328
  s_waitcnt lgkmcnt(4)
  v_mfma_f32_32x32x16_bf16 v[80:95], v[144:147], v[152:155], v[80:95]
  ds_read_b128 v[168:171], v50 offset:0
  ds_read_b128 v[172:175], v50 offset:4096
  v_mfma_f32_32x32x16_bf16 v[96:111], v[148:151], v[152:155], v[96:111]
  ds_read_b64_tr_b16 v[176:177], v56 offset:36864
  ds_read_b64_tr_b16 v[178:179], v56 offset:37376
  s_waitcnt lgkmcnt(4)
  v_mfma_f32_32x32x16_bf16 v[80:95], v[156:159], v[164:167], v[80:95]
  ds_read_b128 v[180:183], v51 offset:0
  ds_read_b128 v[184:187], v51 offset:4096
  v_mfma_f32_32x32x16_bf16 v[96:111], v[160:163], v[164:167], v[96:111]
  ds_read_b64_tr_b16 v[188:189], v56 offset:38912
  ds_read_b64_tr_b16 v[190:191], v56 offset:39424
  s_waitcnt lgkmcnt(4)
  s_barrier
  s_add_u32 s58, s58, 1
  s_cmp_eq_u32 s58, 5
  s_cselect_b32 s59, s61, 16384
  s_cselect_b32 s58, 0, s58
  v_add_u32 v48, s59, v48
  v_add_u32 v49, s59, v49
  v_add_u32 v50, s59, v50
  v_add_u32 v51, s59, v51
  v_mfma_f32_32x32x16_bf16 v[80:95], v[168:171], v[176:179], v[80:95]
  ds_read_b128 v[144:147], v48 offset:0
  ds_read_b128 v[148:151], v48 offset:4096
  v_mfma_f32_32x32x16_bf16 v[96:111], v[172:175], v[176:179], v[96:111]
  ds_read_b64_tr_b16 v[152:153], v57 offset:0
  ds_read_b64_tr_b16 v[154:155], v57 offset:512
  s_waitcnt lgkmcnt(4)
  v_mfma_f32_32x32x16_bf16 v[80:95], v[180:183], v[188:191], v[80:95]
  ds_read_b128 v[156:159], v49 offset:0
  ds_read_b128 v[160:163], v49 offset:4096
  v_mfma_f32_32x32x16_bf16 v[96:111], v[184:187], v[188:191], v[96:111]
  ds_read_b64_tr_b16 v[164:165], v57 offset:2048
  ds_read_b64_tr_b16 v[166:167], v57 offset:2560
  s_waitcnt lgkmcnt(4)
  v_mfma_f32_32x32x16_bf16 v[80:95], v[144:147], v[152:155], v[80:95]
  ds_read_b128 v[168:171], v50 offset:0
  ds_read_b128 v[172:175], v50 offset:4096
  v_mfma_f32_32x32x16_bf16 v[96:111], v[148:151], v[152:155], v[96:111]
  ds_read_b64_tr_b16 v[176:177], v57 offset:4096
  ds_read_b64_tr_b16 v[178:179], v57 offset:4608
  s_waitcnt lgkmcnt(4)
  v_mfma_f32_32x32x16_bf16 v[80:95], v[156:159], v[164:167], v[80:95]
  ds_read_b128 v[180:183], v51 offset:0
  ds_read_b128 v[184:187], v51 offset:4096
  v_mfma_f32_32x32x16_bf16 v[96:111], v[160:163], v[164:167], v[96:111]
  ds_read_b64_tr_b16 v[188:189], v57 offset:6144
  ds_read_b64_tr_b16 v[190:191], v57 offset:6656
  s_waitcnt lgkmcnt(4)
  s_barrier
  s_add_u32 s58, s58, 1
  s_cmp_eq_u32 s58, 5
  s_cselect_b32 s59, s61, 16384
  s_cselect_b32 s58, 0, s58
  v_add_u32 v48, s59, v48
  v_add_u32 v49, s59, v49
  v_add_u32 v50, s59, v50
  v_add_u32 v51, s59, v51
  v_mfma_f32_32x32x16_bf16 v[80:95], v[168:171], v[176:179], v[80:95]
  ds_read_b128 v[144:147], v48 offset:0
  ds_read_b128 v[148:151], v48 offset:4096
  v_mfma_f32_32x32x16_bf16 v[96:111], v[172:175], v[176:179], v[96:111]
  ds_read_b64_tr_b16 v[152:153], v57 offset:8192
  ds_read_b64_tr_b16 v[154:155], v57 offset:8704
  s_waitcnt lgkmcnt(4)
  v_mfma_f32_32x32x16_bf16 v[80:95], v[180:183], v[188:191], v[80:95]
  ds_read_b128 v[156:159], v49 offset:0
  ds_read_b128 v[160:163], v49 offset:4096
  v_mfma_f32_32x32x16_bf16 v[96:111], v[184:187], v[188:191], v[96:111]
  ds_read_b64_tr_b16 v[164:165], v57 offset:10240
  ds_read_b64_tr_b16 v[166:167], v57 offset:10752
  s_waitcnt lgkmcnt(4)
  v_mfma_f32_32x32x16_bf16 v[80:95], v[144:147], v[152:155], v[80:95]
  ds_read_b128 v[168:171], v50 offset:0
  ds_read_b128 v[172:175], v50 offset:4096
  v_mfma_f32_32x32x16_bf16 v[96:111], v[148:151], v[152:155], v[96:111]
  ds_read_b64_tr_b16 v[176:177], v57 offset:12288
  ds_read_b64_tr_b16 v[178:179], v57 offset:12800
  s_waitcnt lgkmcnt(4)
  v_mfma_f32_32x32x16_bf16 v[80:95], v[156:159], v[164:167], v[80:95]
  ds_read_b128 v[180:183], v51 offset:0
  ds_read_b128 v[184:187], v51 offset:4096
  v_mfma_f32_32x32x16_bf16 v[96:111], v[160:163], v[164:167], v[96:111]
  ds_read_b64_tr_b16 v[188:189], v57 offset:14336
  ds_read_b64_tr_b16 v[190:191], v57 offset:14848
  s_waitcnt lgkmcnt(4)
  s_barrier
  s_add_u32 s58, s58, 1
  s_cmp_eq_u32 s58, 5
  s_cselect_b32 s59, s61, 16384
  s_cselect_b32 s58, 0, s58
  v_add_u32 v48, s59, v48
  v_add_u32 v49, s59, v49
  v_add_u32 v50, s59, v50
  v_add_u32 v51, s59, v51
  v_mfma_f32_32x32x16_bf16 v[80:95], v[168:171], v[176:179], v[80:95]
  ds_read_b128 v[144:147], v48 offset:0
  ds_read_b128 v[148:151], v48 offset:4096
  v_mfma_f32_32x32x16_bf16 v[96:111], v[172:175], v[176:179], v[96:111]
  ds_read_b64_tr_b16 v[152:153], v57 offset:16384
  ds_read_b64_tr_b16 v[154:155], v57 offset:16896
  s_waitcnt lgkmcnt(4)
  v_mfma_f32_32x32x16_bf16 v[80:95], v[180:183], v[188:191], v[80:95]
  ds_read_b128 v[156:159], v49 offset:0
  ds_read_b128 v[160:163], v49 offset:4096
  v_mfma_f32_32x32x16_bf16 v[96:111], v[184:187], v[188:191], v[96:111]
  ds_read_b64_tr_b16 v[164:165], v57 offset:18432
  ds_read_b64_tr_b16 v[166:167], v57 offset:18944
  s_waitcnt lgkmcnt(4)
  v_mfma_f32_32x32x16_bf16 v[80:95], v[144:147], v[152:155], v[80:95]
  ds_read_b128 v[168:171], v50 offset:0
  ds_read_b128 v[172:175], v50 offset:4096
  v_mfma_f32_32x32x16_bf16 v[96:111], v[148:151], v[152:155], v[96:111]
  ds_read_b64_tr_b16 v[176:177], v57 offset:20480
  ds_read_b64_tr_b16 v[178:179], v57 offset:20992
  s_waitcnt lgkmcnt(4)
  v_mfma_f32_32x32x16_bf16 v[80:95], v[156:159], v[164:167], v[80:95]
  ds_read_b128 v[180:183], v51 offset:0
  ds_read_b128 v[184:187], v51 offset:4096
  v_mfma_f32_32x32x16_bf16 v[96:111], v[160:163], v[164:167], v[96:111]
  ds_read_b64_tr_b16 v[188:189], v57 offset:22528
  ds_read_b64_tr_b16 v[190:191], v57 offset:23040
  s_waitcnt lgkmcnt(4)
  s_barrier
  s_add_u32 s58, s58, 1
  s_cmp_eq_u32 s58, 5
  s_cselect_b32 s59, s61, 16384
  s_cselect_b32 s58, 0, s58
  v_add_u32 v48, s59, v48
  v_add_u32 v49, s59, v49
  v_add_u32 v50, s59, v50
  v_add_u32 v51, s59, v51
  v_mfma_f32_32x32x16_bf16 v[80:95], v[168:171], v[176:179], v[80:95]
  ds_read_b128 v[144:147], v48 offset:0
  ds_read_b128 v[148:151], v48 offset:4096
  v_mfma_f32_32x32x16_bf16 v[96:111], v[172:175], v[176:179], v[96:111]
  ds_read_b64_tr_b16 v[152:153], v57 offset:24576
  ds_read_b64_tr_b16 v[154:155], v57 offset:25088
  s_waitcnt lgkmcnt(4)
  v_mfma_f32_32x32x16_bf16 v[80:95], v[180:183], v[188:191], v[80:95]
  ds_read_b128 v[156:159], v49 offset:0
  ds_read_b128 v[160:163], v49 offset:4096
  v_mfma_f32_32x32x16_bf16 v[96:111], v[184:187], v[188:191], v[96:111]
  ds_read_b64_tr_b16 v[164:165], v57 offset:26624
  ds_read_b64_tr_b16 v[166:167], v57 offset:27136
  s_waitcnt lgkmcnt(4)
  v_mfma_f32_32x32x16_bf16 v[80:95], v[144:147], v[152:155], v[80:95]
  ds_read_b128 v[168:171], v50 offset:0
  ds_read_b128 v[172:175], v50 offset:4096
  v_mfma_f32_32x32x16_bf16 v[96:111], v[148:151], v[152:155], v[96:111]
  ds_read_b64_tr_b16 v[176:177], v57 offset:28672
  ds_read_b64_tr_b16 v[178:179], v57 offset:29184
  s_waitcnt lgkmcnt(4)
  v_mfma_f32_32x32x16_bf16 v[80:95], v[156:159], v[164:167], v[80:95]
  ds_read_b128 v[180:183], v51 offset:0
  ds_read_b128 v[184:187], v51 offset:4096
  v_mfma_f32_32x32x16_bf16 v[96:111], v[160:163], v[164:167], v[96:111]
  ds_read_b64_tr_b16 v[188:189], v57 offset:30720
  ds_read_b64_tr_b16 v[190:191], v57 offset:31232
  s_waitcnt lgkmcnt(4)
  s_barrier
  s_add_u32 s58, s58, 1
  s_cmp_eq_u32 s58, 5
  s_cselect_b32 s59, s61, 16384
  s_cselect_b32 s58, 0, s58
  v_add_u32 v48, s59, v48
  v_add_u32 v49, s59, v49
  v_add_u32 v50, s59, v50
  v_add_u32 v51, s59, v51
  v_mfma_f32_32x32x16_bf16 v[80:95], v[168:171], v[176:179], v[80:95]
  ds_read_b128 v[144:147], v48 offset:0
  ds_read_b128 v[148:151], v48 offset:4096
  v_mfma_f32_32x32x16_bf16 v[96:111], v[172:175], v[176:179], v[96:111]
  ds_read_b64_tr_b16 v[152:153], v57 offset:32768
  ds_read_b64_tr_b16 v[154:155], v57 offset:33280
  s_waitcnt lgkmcnt(4)
  v_mfma_f32_32x32x16_bf16 v[80:95], v[180:183], v[188:191], v[80:95]
  ds_read_b128 v[156:159], v49 offset:0
  ds_read_b128 v[160:163], v49 offset:4096
  v_mfma_f32_32x32x16_bf16 v[96:111], v[184:187], v[188:191], v[96:111]
  ds_read_b64_tr_b16 v[164:165], v57 offset:34816
  ds_read_b64_tr_b16 v[166:167], v57 offset:35328
  s_waitcnt lgkmcnt(4)
  v_mfma_f32_32x32x16_bf16 v[80:95], v[144:147], v[152:155], v[80:95]
  ds_read_b128 v[168:171], v50 offset:0
  ds_read_b128 v[172:175], v50 offset:4096
  v_mfma_f32_32x32x16_bf16 v[96:111], v[148:151], v[152:155], v[96:111]
  ds_read_b64_tr_b16 v[176:177], v57 offset:36864
  ds_read_b64_tr_b16 v[178:179], v57 offset:37376
  s_waitcnt lgkmcnt(4)
  v_mfma_f32_32x32x16_bf16 v[80:95], v[156:159], v[164:167], v[80:95]
  ds_read_b128 v[180:183], v51 offset:0
  ds_read_b128 v[184:187], v51 offset:4096
  v_mfma_f32_32x32x16_bf16 v[96:111], v[160:163], v[164:167], v[96:111]
  ds_read_b64_tr_b16 v[188:189], v57 offset:38912
  ds_read_b64_tr_b16 v[190:191], v57 offset:39424
  s_waitcnt lgkmcnt(4)
  s_barrier
  s_add_u32 s58, s58, 1
  s_cmp_eq_u32 s58, 5
  s_cselect_b32 s59, s61, 16384
  s_cselect_b32 s58, 0, s58
  v_add_u32 v48, s59, v48
  v_add_u32 v49, s59, v49
  v_add_u32 v50, s59, v50
  v_add_u32 v51, s59, v51
  v_mfma_f32_32x32x16_bf16 v[80:95], v[168:171], v[176:179], v[80:95]
  ds_read_b128 v[144:147], v48 offset:0
  ds_read_b128 v[148:151], v48 offset:4096
  v_mfma_f32_32x32x16_bf16 v[96:111], v[172:175], v[176:179], v[96:111]
  ds_read_b64_tr_b16 v[152:153], v56 offset:0
  ds_read_b64_tr_b16 v[154:155], v56 offset:512
  s_waitcnt lgkmcnt(4)
  v_mfma_f32_32x32x16_bf16 v[80:95], v[180:183], v[188:191], v[80:95]
  ds_read_b128 v[156:159], v49 offset:0
  ds_read_b128 v[160:163], v49 offset:4096
  v_mfma_f32_32x32x16_bf16 v[96:111], v[184:187], v[188:191], v[96:111]
  ds_read_b64_tr_b16 v[164:165], v56 offset:2048
  ds_read_b64_tr_b16 v[166:167], v56 offset:2560
  s_waitcnt lgkmcnt(4)
  v_mfma_f32_32x32x16_bf16 v[112:127], v[144:147], v[152:155], v[112:127]
  ds_read_b128 v[168:171], v50 offset:0
  ds_read_b128 v[172:175], v50 offset:4096
  v_mfma_f32_32x32x16_bf16 v[128:143], v[148:151], v[152:155], v[128:143]
  ds_read_b64_tr_b16 v[176:177], v56 offset:4096
  ds_read_b64_tr_b16 v[178:179], v56 offset:4608
  s_waitcnt lgkmcnt(4)
  v_mfma_f32_32x32x16_bf16 v[112:127], v[156:159], v[164:167], v[112:127]
  ds_read_b128 v[180:183], v51 offset:0
  ds_read_b128 v[184:187], v51 offset:4096
  v_mfma_f32_32x32x16_bf16 v[128:143], v[160:163], v[164:167], v[128:143]
  ds_read_b64_tr_b16 v[188:189], v56 offset:6144
  ds_read_b64_tr_b16 v[190:191], v56 offset:6656
  s_waitcnt lgkmcnt(4)
  s_barrier
  s_add_u32 s58, s58, 1
  s_cmp_eq_u32 s58, 5
  s_cselect_b32 s59, s61, 16384
  s_cselect_b32 s58, 0, s58
  v_add_u32 v48, s59, v48
  v_add_u32 v49, s59, v49
  v_add_u32 v50, s59, v50
  v_add_u32 v51, s59, v51
  v_mfma_f32_32x32x16_bf16 v[112:127], v[168:171], v[176:179], v[112:127]
  ds_read_b128 v[144:147], v48 offset:0
  ds_read_b128 v[148:151], v48 offset:4096
  v_mfma_f32_32x32x16_bf16 v[128:143], v[172:175], v[176:179], v[128:143]
  ds_read_b64_tr_b16 v[152:153], v56 offset:8192
  ds_read_b64_tr_b16 v[154:155], v56 offset:8704
  s_waitcnt lgkmcnt(4)
  v_mfma_f32_32x32x16_bf16 v[112:127], v[180:183], v[188:191], v[112:127]
  ds_read_b128 v[156:159], v49 offset:0
  ds_read_b128 v[160:163], v49 offset:4096
  v_mfma_f32_32x32x16_bf16 v[128:143], v[184:187], v[188:191], v[128:143]
  ds_read_b64_tr_b16 v[164:165], v56 offset:10240
  ds_read_b64_tr_b16 v[166:167], v56 offset:10752
  s_waitcnt lgkmcnt(4)
  v_mfma_f32_32x32x16_bf16 v[112:127], v[144:147], v[152:155], v[112:127]
  ds_read_b128 v[168:171], v50 offset:0
  ds_read_b128 v[172:175], v50 offset:4096
  v_mfma_f32_32x32x16_bf16 v[128:143], v[148:151], v[152:155], v[128:143]
  ds_read_b64_tr_b16 v[176:177], v56 offset:12288
  ds_read_b64_tr_b16 v[178:179], v56 offset:12800
  s_waitcnt lgkmcnt(4)
  v_mfma_f32_32x32x16_bf16 v[112:127], v[156:159], v[164:167], v[112:127]
  ds_read_b128 v[180:183], v51 offset:0
  ds_read_b128 v[184:187], v51 offset:4096
  v_mfma_f32_32x32x16_bf16 v[128:143], v[160:163], v[164:167], v[128:143]
  ds_read_b64_tr_b16 v[188:189], v56 offset:14336
  ds_read_b64_tr_b16 v[190:191], v56 offset:14848
  s_waitcnt lgkmcnt(4)
  s_barrier
  s_add_u32 s58, s58, 1
  s_cmp_eq_u32 s58, 5
  s_cselect_b32 s59, s61, 16384
  s_cselect_b32 s58, 0, s58
  v_add_u32 v48, s59, v48
  v_add_u32 v49, s59, v49
  v_add_u32 v50, s59, v50
  v_add_u32 v51, s59, v51
  v_mfma_f32_32x32x16_bf16 v[112:127], v[168:171], v[176:179], v[112:127]
  ds_read_b128 v[144:147], v48 offset:0
  ds_read_b128 v[148:151], v48 offset:4096
  v_mfma_f32_32x32x16_bf16 v[128:143], v[172:175], v[176:179], v[128:143]
  ds_read_b64_tr_b16 v[152:153], v56 offset:16384
  ds_read_b64_tr_b16 v[154:155], v56 offset:16896
  s_waitcnt lgkmcnt(4)
  v_mfma_f32_32x32x16_bf16 v[112:127], v[180:183], v[188:191], v[112:127]
  ds_read_b128 v[156:159], v49 offset:0
  ds_read_b128 v[160:163], v49 offset:4096
  v_mfma_f32_32x32x16_bf16 v[128:143], v[184:187], v[188:191], v[128:143]
  ds_read_b64_tr_b16 v[164:165], v56 offset:18432
  ds_read_b64_tr_b16 v[166:167], v56 offset:18944
  s_mov_b32 s90, 0
L_poll_24:
  s_mov_b64 exec, 0xff
  v_lshlrev_b32 v60, 5, v1
  buffer_load_dword v61, v60, s[28:31], 0 offen sc1
  s_mov_b64 exec, -1
  s_waitcnt vmcnt(0)
  v_cmp_le_u32 vcc, 32, v61
  s_nop 2
  s_and_b32 s91, vcc_lo, 0xff
  s_cmp_eq_u32 s91, 0xff
  s_cbranch_scc1 L_polld_25
  s_sleep 2
  s_add_u32 s90, s90, 1
  s_cmp_lt_u32 s90, 0x40000
  s_cbranch_scc1 L_poll_24
L_polld_25:
  v_and_b32 v60, 31, v1
  s_lshl_b32 s34, s3, 5
  s_and_b32 s34, s34, 63
  s_lshl_b32 s35, s33, 6
  s_add_u32 s34, s34, s35
  v_add_lshl_u32 v60, v60, s34, 2
  s_mov_b32 s34, 26374144
  buffer_load_dword v64, v60, s[24:27], s34 offen sc1
  s_mov_b32 s34, 26381824
  buffer_load_dword v65, v60, s[24:27], s34 offen sc1
  s_mov_b32 s34, 26389504
  buffer_load_dword v66, v60, s[24:27], s34 offen sc1
  s_mov_b32 s34, 26397184
  buffer_load_dword v67, v60, s[24:27], s34 offen sc1
  s_mov_b32 s34, 26404864
  buffer_load_dword v68, v60, s[24:27], s34 offen sc1
  s_mov_b32 s34, 26412544
  buffer_load_dword v69, v60, s[24:27], s34 offen sc1
  s_mov_b32 s34, 26420224
  buffer_load_dword v70, v60, s[24:27], s34 offen sc1
  s_mov_b32 s34, 26427904
  buffer_load_dword v71, v60, s[24:27], s34 offen sc1
  s_lshl_b32 s34, s32, 7
  s_lshl_b32 s35, s36, 6
  s_add_u32 s34, s34, s35
  s_add_u32 s34, s34, 0
  s_lshl_b32 s34, s34, 3
  s_add_u32 s34, s34, 26357760
  v_lshrrev_b32 v60, 5, v1
  v_lshlrev_b32 v60, 5, v60
  buffer_load_dwordx4 v[192:195], v60, s[24:27], s34 offen offset:0 sc1
  buffer_load_dwordx4 v[196:199], v60, s[24:27], s34 offen offset:16 sc1
  buffer_load_dwordx4 v[200:203], v60, s[24:27], s34 offen offset:64 sc1
  buffer_load_dwordx4 v[204:207], v60, s[24:27], s34 offen offset:80 sc1
  buffer_load_dwordx4 v[208:211], v60, s[24:27], s34 offen offset:128 sc1
  buffer_load_dwordx4 v[212:215], v60, s[24:27], s34 offen offset:144 sc1
  buffer_load_dwordx4 v[216:219], v60, s[24:27], s34 offen offset:192 sc1
  buffer_load_dwordx4 v[220:223], v60, s[24:27], s34 offen offset:208 sc1
  s_lshl_b32 s34, s32, 7
  s_lshl_b32 s35, s36, 6
  s_add_u32 s34, s34, s35
  s_add_u32 s34, s34, 32
  s_lshl_b32 s34, s34, 3
  s_add_u32 s34, s34, 26357760
  v_lshrrev_b32 v60, 5, v1
  v_lshlrev_b32 v60, 5, v60
  buffer_load_dwordx4 v[224:227], v60, s[24:27], s34 offen offset:0 sc1
  buffer_load_dwordx4 v[228:231], v60, s[24:27], s34 offen offset:16 sc1
  buffer_load_dwordx4 v[232:235], v60, s[24:27], s34 offen offset:64 sc1
  buffer_load_dwordx4 v[236:239], v60, s[24:27], s34 offen offset:80 sc1
  buffer_load_dwordx4 v[240:243], v60, s[24:27], s34 offen offset:128 sc1
  buffer_load_dwordx4 v[244:247], v60, s[24:27], s34 offen offset:144 sc1
  buffer_load_dwordx4 v[248:251], v60, s[24:27], s34 offen offset:192 sc1
  buffer_load_dwordx4 v[252:255], v60, s[24:27], s34 offen offset:208 sc1
  s_waitcnt lgkmcnt(4)
  v_mfma_f32_32x32x16_bf16 v[112:127], v[144:147], v[152:155], v[112:127]
  ds_read_b128 v[168:171], v50 offset:0
  ds_read_b128 v[172:175], v50 offset:4096
  v_mfma_f32_32x32x16_bf16 v[128:143], v[148:151], v[152:155], v[128:143]
  ds_read_b64_tr_b16 v[176:177], v56 offset:20480
  ds_read_b64_tr_b16 v[178:179], v56 offset:20992
  s_waitcnt lgkmcnt(4)
  v_mfma_f32_32x32x16_bf16 v[112:127], v[156:159], v[164:167], v[112:127]
  ds_read_b128 v[180:183], v51 offset:0
  ds_read_b128 v[184:187], v51 offset:4096
  v_mfma_f32_32x32x16_bf16 v[128:143], v[160:163], v[164:167], v[128:143]
  ds_read_b64_tr_b16 v[188:189], v56 offset:22528
  ds_read_b64_tr_b16 v[190:191], v56 offset:23040
  s_waitcnt lgkmcnt(4)
  s_barrier
  s_add_u32 s58, s58, 1
  s_cmp_eq_u32 s58, 5
  s_cselect_b32 s59, s61, 16384
  s_cselect_b32 s58, 0, s58
  v_add_u32 v48, s59, v48
  v_add_u32 v49, s59, v49
  v_add_u32 v50, s59, v50
  v_add_u32 v51, s59, v51
  v_mfma_f32_32x32x16_bf16 v[112:127], v[168:171], v[176:179], v[112:127]
  ds_read_b128 v[144:147], v48 offset:0
  ds_read_b128 v[148:151], v48 offset:4096
  v_mfma_f32_32x32x16_bf16 v[128:143], v[172:175], v[176:179], v[128:143]
  ds_read_b64_tr_b16 v[152:153], v56 offset:24576
  ds_read_b64_tr_b16 v[154:155], v56 offset:25088
  s_waitcnt lgkmcnt(4)
  v_mfma_f32_32x32x16_bf16 v[112:127], v[180:183], v[188:191], v[112:127]
  ds_read_b128 v[156:159], v49 offset:0
  ds_read_b128 v[160:163], v49 offset:4096
  v_mfma_f32_32x32x16_bf16 v[128:143], v[184:187], v[188:191], v[128:143]
  ds_read_b64_tr_b16 v[164:165], v56 offset:26624
  ds_read_b64_tr_b16 v[166:167], v56 offset:27136
  s_waitcnt lgkmcnt(4)
  v_mfma_f32_32x32x16_bf16 v[112:127], v[144:147], v[152:155], v[112:127]
  ds_read_b128 v[168:171], v50 offset:0
  ds_read_b128 v[172:175], v50 offset:4096
  v_mfma_f32_32x32x16_bf16 v[128:143], v[148:151], v[152:155], v[128:143]
  ds_read_b64_tr_b16 v[176:177], v56 offset:28672
  ds_read_b64_tr_b16 v[178:179], v56 offset:29184
  s_waitcnt lgkmcnt(4)
  v_mfma_f32_32x32x16_bf16 v[112:127], v[156:159], v[164:167], v[112:127]
  ds_read_b128 v[180:183], v51 offset:0
  ds_read_b128 v[184:187], v51 offset:4096
  v_mfma_f32_32x32x16_bf16 v[128:143], v[160:163], v[164:167], v[128:143]
  ds_read_b64_tr_b16 v[188:189], v56 offset:30720
  ds_read_b64_tr_b16 v[190:191], v56 offset:31232
  s_waitcnt lgkmcnt(4)
  s_barrier
  s_add_u32 s58, s58, 1
  s_cmp_eq_u32 s58, 5
  s_cselect_b32 s59, s61, 16384
  s_cselect_b32 s58, 0, s58
  v_add_u32 v48, s59, v48
  v_add_u32 v49, s59, v49
  v_add_u32 v50, s59, v50
  v_add_u32 v51, s59, v51
  v_mfma_f32_32x32x16_bf16 v[112:127], v[168:171], v[176:179], v[112:127]
  ds_read_b128 v[144:147], v48 offset:0
  ds_read_b128 v[148:151], v48 offset:4096
  v_mfma_f32_32x32x16_bf16 v[128:143], v[172:175], v[176:179], v[128:143]
  ds_read_b64_tr_b16 v[152:153], v56 offset:32768
  ds_read_b64_tr_b16 v[154:155], v56 offset:33280
  s_waitcnt lgkmcnt(4)
  v_mfma_f32_32x32x16_bf16 v[112:127], v[180:183], v[188:191], v[112:127]
  ds_read_b128 v[156:159], v49 offset:0
  ds_read_b128 v[160:163], v49 offset:4096
  v_mfma_f32_32x32x16_bf16 v[128:143], v[184:187], v[188:191], v[128:143]
  ds_read_b64_tr_b16 v[164:165], v56 offset:34816
  ds_read_b64_tr_b16 v[166:167], v56 offset:35328
  s_waitcnt lgkmcnt(4)
  v_mfma_f32_32x32x16_bf16 v[112:127], v[144:147], v[152:155], v[112:127]
  ds_read_b128 v[168:171], v50 offset:0
  ds_read_b128 v[172:175], v50 offset:4096
  v_mfma_f32_32x32x16_bf16 v[128:143], v[148:151], v[152:155], v[128:143]
  ds_read_b64_tr_b16 v[176:177], v56 offset:36864
  ds_read_b64_tr_b16 v[178:179], v56 offset:37376
  s_waitcnt lgkmcnt(4)
  v_mfma_f32_32x32x16_bf16 v[112:127], v[156:159], v[164:167], v[112:127]
  ds_read_b128 v[180:183], v51 offset:0
  ds_read_b128 v[184:187], v51 offset:4096
  v_mfma_f32_32x32x16_bf16 v[128:143], v[160:163], v[164:167], v[128:143]
  ds_read_b64_tr_b16 v[188:189], v56 offset:38912
  ds_read_b64_tr_b16 v[190:191], v56 offset:39424
  s_waitcnt lgkmcnt(4)
  s_barrier
  s_add_u32 s58, s58, 1
  s_cmp_eq_u32 s58, 5
  s_cselect_b32 s59, s61, 16384
  s_cselect_b32 s58, 0, s58
  v_add_u32 v48, s59, v48
  v_add_u32 v49, s59, v49
  v_add_u32 v50, s59, v50
  v_add_u32 v51, s59, v51
  v_mfma_f32_32x32x16_bf16 v[112:127], v[168:171], v[176:179], v[112:127]
  ds_read_b128 v[144:147], v48 offset:0
  ds_read_b128 v[148:151], v48 offset:4096
  v_mfma_f32_32x32x16_bf16 v[128:143], v[172:175], v[176:179], v[128:143]
  ds_read_b64_tr_b16 v[152:153], v57 offset:0
  ds_read_b64_tr_b16 v[154:155], v57 offset:512
  s_waitcnt lgkmcnt(4)
  v_mfma_f32_32x32x16_bf16 v[112:127], v[180:183], v[188:191], v[112:127]
  ds_read_b128 v[156:159], v49 offset:0
  ds_read_b128 v[160:163], v49 offset:4096
  v_mfma_f32_32x32x16_bf16 v[128:143], v[184:187], v[188:191], v[128:143]
  ds_read_b64_tr_b16 v[164:165], v57 offset:2048
  ds_read_b64_tr_b16 v[166:167], v57 offset:2560
  s_waitcnt vmcnt(0)
  v_add_f32 v64, v64, v65
  v_add_f32 v64, v64, v66
  v_add_f32 v64, v64, v67
  v_add_f32 v64, v64, v68
  v_add_f32 v64, v64, v69
  v_add_f32 v64, v64, v70
  v_add_f32 v64, v64, v71
  v_mov_b32 v16, v64
  s_lshl_b32 s35, s36, 1
  s_add_u32 s34, s35, 0
  s_lshl_b32 s35, s32, 2
  s_add_u32 s34, s34, s35
  s_mul_i32 s34, s34, s49
  s_add_u32 s52, s34, s50
  s_lshl_b32 s35, s36, 1
  s_add_u32 s34, s35, 1
  s_lshl_b32 s35, s32, 2
  s_add_u32 s34, s34, s35
  s_mul_i32 s34, s34, s49
  s_add_u32 s53, s34, s50
  v_mul_f32 v18, v193, v16
  v_mul_f32 v19, v195, v16
  v_mul_f32 v20, v197, v16
  v_mul_f32 v21, v199, v16
  v_fmac_f32 v18, v192, v80
  v_fmac_f32 v19, v194, v81
  v_fmac_f32 v20, v196, v82
  v_fmac_f32 v21, v198, v83
  v_mul_f32 v22, v201, v16
  v_mul_f32 v23, v203, v16
  v_mul_f32 v24, v205, v16
  v_mul_f32 v25, v207, v16
  v_fmac_f32 v22, v200, v84
  v_fmac_f32 v23, v202, v85
  v_fmac_f32 v24, v204, v86
  v_fmac_f32 v25, v206, v87
  v_cvt_pk_bf16_f32 v26, v18, v19
  v_cvt_pk_bf16_f32 v27, v20, v21
  v_cvt_pk_bf16_f32 v28, v22, v23
  v_cvt_pk_bf16_f32 v29, v24, v25
  buffer_store_dwordx4 v[26:29], v72, s[24:27], s52 offen offset:0 sc1
  v_mul_f32 v30, v209, v16
  v_mul_f32 v31, v211, v16
  v_mul_f32 v32, v213, v16
  v_mul_f32 v33, v215, v16
  v_fmac_f32 v30, v208, v88
  v_fmac_f32 v31, v210, v89
  v_fmac_f32 v32, v212, v90
  v_fmac_f32 v33, v214, v91
  v_mul_f32 v34, v217, v16
  v_mul_f32 v35, v219, v16
  v_mul_f32 v36, v221, v16
  v_mul_f32 v37, v223, v16
  v_fmac_f32 v34, v216, v92
  v_fmac_f32 v35, v218, v93
  v_fmac_f32 v36, v220, v94
  v_fmac_f32 v37, v222, v95
  v_cvt_pk_bf16_f32 v38, v30, v31
  v_cvt_pk_bf16_f32 v39, v32, v33
  v_cvt_pk_bf16_f32 v40, v34, v35
  v_cvt_pk_bf16_f32 v41, v36, v37
  buffer_store_dwordx4 v[38:41], v72, s[24:27], s52 offen offset:640 sc1
  v_mul_f32 v18, v225, v16
  v_mul_f32 v19, v227, v16
  v_mul_f32 v20, v229, v16
  v_mul_f32 v21, v231, v16
  v_fmac_f32 v18, v224, v96
  v_fmac_f32 v19, v226, v97
  v_fmac_f32 v20, v228, v98
  v_fmac_f32 v21, v230, v99
  v_mul_f32 v22, v233, v16
  v_mul_f32 v23, v235, v16
  v_mul_f32 v24, v237, v16
  v_mul_f32 v25, v239, v16
  v_fmac_f32 v22, v232, v100
  v_fmac_f32 v23, v234, v101
  v_fmac_f32 v24, v236, v102
  v_fmac_f32 v25, v238, v103
  v_cvt_pk_bf16_f32 v26, v18, v19
  v_cvt_pk_bf16_f32 v27, v20, v21
  v_cvt_pk_bf16_f32 v28, v22, v23
  v_cvt_pk_bf16_f32 v29, v24, v25
  buffer_store_dwordx4 v[26:29], v72, s[24:27], s53 offen offset:0 sc1
  v_mul_f32 v30, v241, v16
  v_mul_f32 v31, v243, v16
  v_mul_f32 v32, v245, v16
  v_mul_f32 v33, v247, v16
  v_fmac_f32 v30, v240, v104
  v_fmac_f32 v31, v242, v105
  v_fmac_f32 v32, v244, v106
  v_fmac_f32 v33, v246, v107
  v_mul_f32 v34, v249, v16
  v_mul_f32 v35, v251, v16
  v_mul_f32 v36, v253, v16
  v_mul_f32 v37, v255, v16
  v_fmac_f32 v34, v248, v108
  v_fmac_f32 v35, v250, v109
  v_fmac_f32 v36, v252, v110
  v_fmac_f32 v37, v254, v111
  v_cvt_pk_bf16_f32 v38, v30, v31
  v_cvt_pk_bf16_f32 v39, v32, v33
  v_cvt_pk_bf16_f32 v40, v34, v35
  v_cvt_pk_bf16_f32 v41, v36, v37
  buffer_store_dwordx4 v[38:41], v72, s[24:27], s53 offen offset:640 sc1
  s_lshl_b32 s34, s32, 7
  s_lshl_b32 s35, s36, 6
  s_add_u32 s34, s34, s35
  s_add_u32 s34, s34, 1024
  s_lshl_b32 s34, s34, 3
  s_add_u32 s34, s34, 26357760
  v_lshrrev_b32 v60, 5, v1
  v_lshlrev_b32 v60, 5, v60
  buffer_load_dwordx4 v[192:195], v60, s[24:27], s34 offen offset:0 sc1
  buffer_load_dwordx4 v[196:199], v60, s[24:27], s34 offen offset:16 sc1
  buffer_load_dwordx4 v[200:203], v60, s[24:27], s34 offen offset:64 sc1
  buffer_load_dwordx4 v[204:207], v60, s[24:27], s34 offen offset:80 sc1
  buffer_load_dwordx4 v[208:211], v60, s[24:27], s34 offen offset:128 sc1
  buffer_load_dwordx4 v[212:215], v60, s[24:27], s34 offen offset:144 sc1
  buffer_load_dwordx4 v[216:219], v60, s[24:27], s34 offen offset:192 sc1
  buffer_load_dwordx4 v[220:223], v60, s[24:27], s34 offen offset:208 sc1
  s_lshl_b32 s34, s32, 7
  s_lshl_b32 s35, s36, 6
  s_add_u32 s34, s34, s35
  s_add_u32 s34, s34, 1056
  s_lshl_b32 s34, s34, 3
  s_add_u32 s34, s34, 26357760
  v_lshrrev_b32 v60, 5, v1
  v_lshlrev_b32 v60, 5, v60
  buffer_load_dwordx4 v[224:227], v60, s[24:27], s34 offen offset:0 sc1
  buffer_load_dwordx4 v[228:231], v60, s[24:27], s34 offen offset:16 sc1
  buffer_load_dwordx4 v[232:235], v60, s[24:27], s34 offen offset:64 sc1
  buffer_load_dwordx4 v[236:239], v60, s[24:27], s34 offen offset:80 sc1
  buffer_load_dwordx4 v[240:243], v60, s[24:27], s34 offen offset:128 sc1
  buffer_load_dwordx4 v[244:247], v60, s[24:27], s34 offen offset:144 sc1
  buffer_load_dwordx4 v[248:251], v60, s[24:27], s34 offen offset:192 sc1
  buffer_load_dwordx4 v[252:255], v60, s[24:27], s34 offen offset:208 sc1
  s_waitcnt lgkmcnt(4)
  v_mfma_f32_32x32x16_bf16 v[112:127], v[144:147], v[152:155], v[112:127]
  ds_read_b128 v[168:171], v50 offset:0
  ds_read_b128 v[172:175], v50 offset:4096
  v_mfma_f32_32x32x16_bf16 v[128:143], v[148:151], v[152:155], v[128:143]
  ds_read_b64_tr_b16 v[176:177], v57 offset:4096
  ds_read_b64_tr_b16 v[178:179], v57 offset:4608
  s_waitcnt lgkmcnt(4)
  v_mfma_f32_32x32x16_bf16 v[112:127], v[156:159], v[164:167], v[112:127]
  ds_read_b128 v[180:183], v51 offset:0
  ds_read_b128 v[184:187], v51 offset:4096
  v_mfma_f32_32x32x16_bf16 v[128:143], v[160:163], v[164:167], v[128:143]
  ds_read_b64_tr_b16 v[188:189], v57 offset:6144
  ds_read_b64_tr_b16 v[190:191], v57 offset:6656
  s_waitcnt lgkmcnt(4)
  s_barrier
  s_add_u32 s58, s58, 1
  s_cmp_eq_u32 s58, 5
  s_cselect_b32 s59, s61, 16384
  s_cselect_b32 s58, 0, s58
  v_add_u32 v48, s59, v48
  v_add_u32 v49, s59, v49
  v_add_u32 v50, s59, v50
  v_add_u32 v51, s59, v51
  v_mfma_f32_32x32x16_bf16 v[112:127], v[168:171], v[176:179], v[112:127]
  ds_read_b128 v[144:147], v48 offset:0
  ds_read_b128 v[148:151], v48 offset:4096
  v_mfma_f32_32x32x16_bf16 v[128:143], v[172:175], v[176:179], v[128:143]
  ds_read_b64_tr_b16 v[152:153], v57 offset:8192
  ds_read_b64_tr_b16 v[154:155], v57 offset:8704
  s_waitcnt lgkmcnt(4)
  v_mfma_f32_32x32x16_bf16 v[112:127], v[180:183], v[188:191], v[112:127]
  ds_read_b128 v[156:159], v49 offset:0
  ds_read_b128 v[160:163], v49 offset:4096
  v_mfma_f32_32x32x16_bf16 v[128:143], v[184:187], v[188:191], v[128:143]
  ds_read_b64_tr_b16 v[164:165], v57 offset:10240
  ds_read_b64_tr_b16 v[166:167], v57 offset:10752
  s_waitcnt lgkmcnt(4)
  v_mfma_f32_32x32x16_bf16 v[112:127], v[144:147], v[152:155], v[112:127]
  ds_read_b128 v[168:171], v50 offset:0
  ds_read_b128 v[172:175], v50 offset:4096
  v_mfma_f32_32x32x16_bf16 v[128:143], v[148:151], v[152:155], v[128:143]
  ds_read_b64_tr_b16 v[176:177], v57 offset:12288
  ds_read_b64_tr_b16 v[178:179], v57 offset:12800
  s_waitcnt lgkmcnt(4)
  v_mfma_f32_32x32x16_bf16 v[112:127], v[156:159], v[164:167], v[112:127]
  ds_read_b128 v[180:183], v51 offset:0
  ds_read_b128 v[184:187], v51 offset:4096
  v_mfma_f32_32x32x16_bf16 v[128:143], v[160:163], v[164:167], v[128:143]
  ds_read_b64_tr_b16 v[188:189], v57 offset:14336
  ds_read_b64_tr_b16 v[190:191], v57 offset:14848
  s_waitcnt lgkmcnt(4)
  s_waitcnt vmcnt(0)
  s_barrier
  s_add_u32 s58, s58, 1
  s_cmp_eq_u32 s58, 5
  s_cselect_b32 s59, s61, 16384
  s_cselect_b32 s58, 0, s58
  v_add_u32 v48, s59, v48
  v_add_u32 v49, s59, v49
  v_add_u32 v50, s59, v50
  v_add_u32 v51, s59, v51
  s_cmp_lg_u32 s3, 0
  s_cbranch_scc1 L_qnp_26
  s_add_u32 s34, s33, 120
  s_lshl_b32 s90, s34, 8
  s_add_u32 s90, s90, 26681344
  v_mov_b32 v3, 1
  v_mov_b32 v4, 0
  s_mov_b64 exec, 1
  buffer_atomic_add v3, v4, s[24:27], s90 offen sc1
  s_mov_b64 exec, -1
L_qnp_26:
  v_mfma_f32_32x32x16_bf16 v[112:127], v[168:171], v[176:179], v[112:127]
  ds_read_b128 v[144:147], v48 offset:0
  ds_read_b128 v[148:151], v48 offset:4096
  v_mfma_f32_32x32x16_bf16 v[128:143], v[172:175], v[176:179], v[128:143]
  ds_read_b64_tr_b16 v[152:153], v57 offset:16384
  ds_read_b64_tr_b16 v[154:155], v57 offset:16896
  s_waitcnt lgkmcnt(4)
  v_mfma_f32_32x32x16_bf16 v[112:127], v[180:183], v[188:191], v[112:127]
  ds_read_b128 v[156:159], v49 offset:0
  ds_read_b128 v[160:163], v49 offset:4096
  v_mfma_f32_32x32x16_bf16 v[128:143], v[184:187], v[188:191], v[128:143]
  ds_read_b64_tr_b16 v[164:165], v57 offset:18432
  ds_read_b64_tr_b16 v[166:167], v57 offset:18944
  s_waitcnt lgkmcnt(4)
  v_mfma_f32_32x32x16_bf16 v[112:127], v[144:147], v[152:155], v[112:127]
  ds_read_b128 v[168:171], v50 offset:0
  ds_read_b128 v[172:175], v50 offset:4096
  v_mfma_f32_32x32x16_bf16 v[128:143], v[148:151], v[152:155], v[128:143]
  ds_read_b64_tr_b16 v[176:177], v57 offset:20480
  ds_read_b64_tr_b16 v[178:179], v57 offset:20992
  s_waitcnt lgkmcnt(4)
  v_mfma_f32_32x32x16_bf16 v[112:127], v[156:159], v[164:167], v[112:127]
  ds_read_b128 v[180:183], v51 offset:0
  ds_read_b128 v[184:187], v51 offset:4096
  v_mfma_f32_32x32x16_bf16 v[128:143], v[160:163], v[164:167], v[128:143]
  ds_read_b64_tr_b16 v[188:189], v57 offset:22528
  ds_read_b64_tr_b16 v[190:191], v57 offset:23040
  s_waitcnt lgkmcnt(4)
  s_barrier
  s_add_u32 s58, s58, 1
  s_cmp_eq_u32 s58, 5
  s_cselect_b32 s59, s61, 16384
  s_cselect_b32 s58, 0, s58
  v_add_u32 v48, s59, v48
  v_add_u32 v49, s59, v49
  v_add_u32 v50, s59, v50
  v_add_u32 v51, s59, v51
  v_mfma_f32_32x32x16_bf16 v[112:127], v[168:171], v[176:179], v[112:127]
  ds_read_b128 v[144:147], v48 offset:0
  ds_read_b128 v[148:151], v48 offset:4096
  v_mfma_f32_32x32x16_bf16 v[128:143], v[172:175], v[176:179], v[128:143]
  ds_read_b64_tr_b16 v[152:153], v57 offset:24576
  ds_read_b64_tr_b16 v[154:155], v57 offset:25088
  s_waitcnt lgkmcnt(4)
  v_mfma_f32_32x32x16_bf16 v[112:127], v[180:183], v[188:191], v[112:127]
  ds_read_b128 v[156:159], v49 offset:0
  ds_read_b128 v[160:163], v49 offset:4096
  v_mfma_f32_32x32x16_bf16 v[128:143], v[184:187], v[188:191], v[128:143]
  ds_read_b64_tr_b16 v[164:165], v57 offset:26624
  ds_read_b64_tr_b16 v[166:167], v57 offset:27136
  s_waitcnt lgkmcnt(4)
  v_mfma_f32_32x32x16_bf16 v[112:127], v[144:147], v[152:155], v[112:127]
  ds_read_b128 v[168:171], v50 offset:0
  ds_read_b128 v[172:175], v50 offset:4096
  v_mfma_f32_32x32x16_bf16 v[128:143], v[148:151], v[152:155], v[128:143]
  ds_read_b64_tr_b16 v[176:177], v57 offset:28672
  ds_read_b64_tr_b16 v[178:179], v57 offset:29184
  s_waitcnt lgkmcnt(4)
  v_mfma_f32_32x32x16_bf16 v[112:127], v[156:159], v[164:167], v[112:127]
  ds_read_b128 v[180:183], v51 offset:0
  ds_read_b128 v[184:187], v51 offset:4096
  v_mfma_f32_32x32x16_bf16 v[128:143], v[160:163], v[164:167], v[128:143]
  ds_read_b64_tr_b16 v[188:189], v57 offset:30720
  ds_read_b64_tr_b16 v[190:191], v57 offset:31232
  s_waitcnt lgkmcnt(4)
  s_barrier
  s_add_u32 s58, s58, 1
  s_cmp_eq_u32 s58, 5
  s_cselect_b32 s59, s61, 16384
  s_cselect_b32 s58, 0, s58
  v_add_u32 v48, s59, v48
  v_add_u32 v49, s59, v49
  v_add_u32 v50, s59, v50
  v_add_u32 v51, s59, v51
  v_mfma_f32_32x32x16_bf16 v[112:127], v[168:171], v[176:179], v[112:127]
  ds_read_b128 v[144:147], v48 offset:0
  ds_read_b128 v[148:151], v48 offset:4096
  v_mfma_f32_32x32x16_bf16 v[128:143], v[172:175], v[176:179], v[128:143]
  ds_read_b64_tr_b16 v[152:153], v57 offset:32768
  ds_read_b64_tr_b16 v[154:155], v57 offset:33280
  s_waitcnt lgkmcnt(4)
  v_mfma_f32_32x32x16_bf16 v[112:127], v[180:183], v[188:191], v[112:127]
  ds_read_b128 v[156:159], v49 offset:0
  ds_read_b128 v[160:163], v49 offset:4096
  v_mfma_f32_32x32x16_bf16 v[128:143], v[184:187], v[188:191], v[128:143]
  ds_read_b64_tr_b16 v[164:165], v57 offset:34816
  ds_read_b64_tr_b16 v[166:167], v57 offset:35328
  s_waitcnt lgkmcnt(4)
  v_mfma_f32_32x32x16_bf16 v[112:127], v[144:147], v[152:155], v[112:127]
  ds_read_b128 v[168:171], v50 offset:0
  ds_read_b128 v[172:175], v50 offset:4096
  v_mfma_f32_32x32x16_bf16 v[128:143], v[148:151], v[152:155], v[128:143]
  ds_read_b64_tr_b16 v[176:177], v57 offset:36864
  ds_read_b64_tr_b16 v[178:179], v57 offset:37376
  s_waitcnt lgkmcnt(4)
  v_mfma_f32_32x32x16_bf16 v[112:127], v[156:159], v[164:167], v[112:127]
  ds_read_b128 v[180:183], v51 offset:0
  ds_read_b128 v[184:187], v51 offset:4096
  v_mfma_f32_32x32x16_bf16 v[128:143], v[160:163], v[164:167], v[128:143]
  ds_read_b64_tr_b16 v[188:189], v57 offset:38912
  ds_read_b64_tr_b16 v[190:191], v57 offset:39424
  s_waitcnt lgkmcnt(4)
  v_mfma_f32_32x32x16_bf16 v[112:127], v[168:171], v[176:179], v[112:127]
  v_mfma_f32_32x32x16_bf16 v[128:143], v[172:175], v[176:179], v[128:143]
  s_waitcnt lgkmcnt(0)
  v_mfma_f32_32x32x16_bf16 v[112:127], v[180:183], v[188:191], v[112:127]
  v_mfma_f32_32x32x16_bf16 v[128:143], v[184:187], v[188:191], v[128:143]
  s_waitcnt vmcnt(0)
  s_lshl_b32 s35, s36, 1
  s_add_u32 s34, s35, 32
  s_lshl_b32 s35, s32, 2
  s_add_u32 s34, s34, s35
  s_mul_i32 s34, s34, s49
  s_add_u32 s52, s34, s50
  s_lshl_b32 s35, s36, 1
  s_add_u32 s34, s35, 33
  s_lshl_b32 s35, s32, 2
  s_add_u32 s34, s34, s35
  s_mul_i32 s34, s34, s49
  s_add_u32 s53, s34, s50
  v_mul_f32 v18, v193, v16
  v_mul_f32 v19, v195, v16
  v_mul_f32 v20, v197, v16
  v_mul_f32 v21, v199, v16
  v_fmac_f32 v18, v192, v112
  v_fmac_f32 v19, v194, v113
  v_fmac_f32 v20, v196, v114
  v_fmac_f32 v21, v198, v115
  v_mul_f32 v22, v201, v16
  v_mul_f32 v23, v203, v16
  v_mul_f32 v24, v205, v16
  v_mul_f32 v25, v207, v16
  v_fmac_f32 v22, v200, v116
  v_fmac_f32 v23, v202, v117
  v_fmac_f32 v24, v204, v118
  v_fmac_f32 v25, v206, v119
  v_cvt_pk_bf16_f32 v26, v18, v19
  v_cvt_pk_bf16_f32 v27, v20, v21
  v_cvt_pk_bf16_f32 v28, v22, v23
  v_cvt_pk_bf16_f32 v29, v24, v25
  buffer_store_dwordx4 v[26:29], v72, s[24:27], s52 offen offset:0 sc1
  v_mul_f32 v30, v209, v16
  v_mul_f32 v31, v211, v16
  v_mul_f32 v32, v213, v16
  v_mul_f32 v33, v215, v16
  v_fmac_f32 v30, v208, v120
  v_fmac_f32 v31, v210, v121
  v_fmac_f32 v32, v212, v122
  v_fmac_f32 v33, v214, v123
  v_mul_f32 v34, v217, v16
  v_mul_f32 v35, v219, v16
  v_mul_f32 v36, v221, v16
  v_mul_f32 v37, v223, v16
  v_fmac_f32 v34, v216, v124
  v_fmac_f32 v35, v218, v125
  v_fmac_f32 v36, v220, v126
  v_fmac_f32 v37, v222, v127
  v_cvt_pk_bf16_f32 v38, v30, v31
  v_cvt_pk_bf16_f32 v39, v32, v33
  v_cvt_pk_bf16_f32 v40, v34, v35
  v_cvt_pk_bf16_f32 v41, v36, v37
  buffer_store_dwordx4 v[38:41], v72, s[24:27], s52 offen offset:640 sc1
  v_mul_f32 v18, v225, v16
  v_mul_f32 v19, v227, v16
  v_mul_f32 v20, v229, v16
  v_mul_f32 v21, v231, v16
  v_fmac_f32 v18, v224, v128
  v_fmac_f32 v19, v226, v129
  v_fmac_f32 v20, v228, v130
  v_fmac_f32 v21, v230, v131
  v_mul_f32 v22, v233, v16
  v_mul_f32 v23, v235, v16
  v_mul_f32 v24, v237, v16
  v_mul_f32 v25, v239, v16
  v_fmac_f32 v22, v232, v132
  v_fmac_f32 v23, v234, v133
  v_fmac_f32 v24, v236, v134
  v_fmac_f32 v25, v238, v135
  v_cvt_pk_bf16_f32 v26, v18, v19
  v_cvt_pk_bf16_f32 v27, v20, v21
  v_cvt_pk_bf16_f32 v28, v22, v23
  v_cvt_pk_bf16_f32 v29, v24, v25
  buffer_store_dwordx4 v[26:29], v72, s[24:27], s53 offen offset:0 sc1
  v_mul_f32 v30, v241, v16
  v_mul_f32 v31, v243, v16
  v_mul_f32 v32, v245, v16
  v_mul_f32 v33, v247, v16
  v_fmac_f32 v30, v240, v136
  v_fmac_f32 v31, v242, v137
  v_fmac_f32 v32, v244, v138
  v_fmac_f32 v33, v246, v139
  v_mul_f32 v34, v249, v16
  v_mul_f32 v35, v251, v16
  v_mul_f32 v36, v253, v16
  v_mul_f32 v37, v255, v16
  v_fmac_f32 v34, v248, v140
  v_fmac_f32 v35, v250, v141
  v_fmac_f32 v36, v252, v142
  v_fmac_f32 v37, v254, v143
  v_cvt_pk_bf16_f32 v38, v30, v31
  v_cvt_pk_bf16_f32 v39, v32, v33
  v_cvt_pk_bf16_f32 v40, v34, v35
  v_cvt_pk_bf16_f32 v41, v36, v37
  buffer_store_dwordx4 v[38:41], v72, s[24:27], s53 offen offset:640 sc1
  s_waitcnt vmcnt(0)
  s_barrier
  s_cmp_lg_u32 s3, 0
  s_cbranch_scc1 L_qnp_27
  s_add_u32 s34, s33, 150
  s_lshl_b32 s90, s34, 8
  s_add_u32 s90, s90, 26681344
  v_mov_b32 v3, 1
  v_mov_b32 v4, 0
  s_mov_b64 exec, 1
  buffer_atomic_add v3, v4, s[24:27], s90 offen sc1
  s_mov_b64 exec, -1
L_qnp_27:
  s_branch L_p1_done
L_spare_2:
  s_waitcnt vmcnt(0)
  s_barrier
  s_cmp_lg_u32 s3, 0
  s_cbranch_scc1 L_sppub_28
  v_mov_b32 v3, 1
  s_and_b32 s90, s2, 7
  s_mov_b64 exec, 1
  s_lshl_b32 s90, s90, 5
  v_mov_b32 v4, s90
  buffer_atomic_add v3, v4, s[28:31], 0 offen sc1
  s_mov_b64 exec, -1
L_sppub_28:
  s_lshl_b32 s34, s77, 3
  s_add_u32 s34, s34, s3
  s_mul_i32 s75, s34, 3
  s_mov_b32 s88, s8
  s_mov_b32 s89, s9
  s_mov_b32 s90, 819200
  s_mov_b32 s91, 0x20000
  v_and_b32 v16, 15, v1
  v_lshrrev_b32 v17, 4, v1
  s_movk_i32 s84, 10240
  v_mul_lo_u32 v18, v17, s84
  v_lshlrev_b32 v19, 4, v16
  v_lshl_add_u32 v19, v17, 7, v19
  v_lshl_add_u32 v16, v16, 1, v18
  s_add_u32 s80, s75, 0
  s_cmp_ge_u32 s80, 320
  s_cbranch_scc1 L_p25_29
  s_mov_b32 s84, 214748365
  s_mul_hi_u32 s81, s80, s84
  s_mul_i32 s82, s81, 20
  s_sub_u32 s82, s80, s82
  s_mul_i32 s85, s82, 40960
  s_mul_i32 s84, s81, 80
  s_add_u32 s85, s85, s84
  s_add_u32 s83, s85, 0
  buffer_load_short_d16 v20, v16, s[88:91], s83 offen
  s_add_u32 s83, s83, 1280
  buffer_load_short_d16_hi v24, v16, s[88:91], s83 offen
  s_add_u32 s83, s83, 1280
  buffer_load_short_d16 v21, v16, s[88:91], s83 offen
  s_add_u32 s83, s83, 1280
  buffer_load_short_d16_hi v25, v16, s[88:91], s83 offen
  s_add_u32 s83, s83, 1280
  buffer_load_short_d16 v22, v16, s[88:91], s83 offen
  s_add_u32 s83, s83, 1280
  buffer_load_short_d16_hi v26, v16, s[88:91], s83 offen
  s_add_u32 s83, s83, 1280
  buffer_load_short_d16 v23, v16, s[88:91], s83 offen
  s_add_u32 s83, s83, 1280
  buffer_load_short_d16_hi v27, v16, s[88:91], s83 offen
  s_add_u32 s83, s85, 32
  buffer_load_short_d16 v28, v16, s[88:91], s83 offen
  s_add_u32 s83, s83, 1280
  buffer_load_short_d16_hi v32, v16, s[88:91], s83 offen
  s_add_u32 s83, s83, 1280
  buffer_load_short_d16 v29, v16, s[88:91], s83 offen
  s_add_u32 s83, s83, 1280
  buffer_load_short_d16_hi v33, v16, s[88:91], s83 offen
  s_add_u32 s83, s83, 1280
  buffer_load_short_d16 v30, v16, s[88:91], s83 offen
  s_add_u32 s83, s83, 1280
  buffer_load_short_d16_hi v34, v16, s[88:91], s83 offen
  s_add_u32 s83, s83, 1280
  buffer_load_short_d16 v31, v16, s[88:91], s83 offen
  s_add_u32 s83, s83, 1280
  buffer_load_short_d16_hi v35, v16, s[88:91], s83 offen
  s_mov_b32 exec_lo, 0x00ff00ff
  s_mov_b32 exec_hi, 0x00ff00ff
  s_add_u32 s83, s85, 64
  buffer_load_short_d16 v36, v16, s[88:91], s83 offen
  s_add_u32 s83, s83, 1280
  buffer_load_short_d16_hi v40, v16, s[88:91], s83 offen
  s_add_u32 s83, s83, 1280
  buffer_load_short_d16 v37, v16, s[88:91], s83 offen
  s_add_u32 s83, s83, 1280
  buffer_load_short_d16_hi v41, v16, s[88:91], s83 offen
  s_add_u32 s83, s83, 1280
  buffer_load_short_d16 v38, v16, s[88:91], s83 offen
  s_add_u32 s83, s83, 1280
  buffer_load_short_d16_hi v42, v16, s[88:91], s83 offen
  s_add_u32 s83, s83, 1280
  buffer_load_short_d16 v39, v16, s[88:91], s83 offen
  s_add_u32 s83, s83, 1280
  buffer_load_short_d16_hi v43, v16, s[88:91], s83 offen
  s_mov_b64 exec, -1
L_p25_29:
  s_add_u32 s80, s75, 1
  s_cmp_ge_u32 s80, 320
  s_cbranch_scc1 L_p25_30
  s_mov_b32 s84, 214748365
  s_mul_hi_u32 s81, s80, s84
  s_mul_i32 s82, s81, 20
  s_sub_u32 s82, s80, s82
  s_mul_i32 s85, s82, 40960
  s_mul_i32 s84, s81, 80
  s_add_u32 s85, s85, s84
  s_add_u32 s83, s85, 0
  buffer_load_short_d16 v44, v16, s[88:91], s83 offen
  s_add_u32 s83, s83, 1280
  buffer_load_short_d16_hi v48, v16, s[88:91], s83 offen
  s_add_u32 s83, s83, 1280
  buffer_load_short_d16 v45, v16, s[88:91], s83 offen
  s_add_u32 s83, s83, 1280
  buffer_load_short_d16_hi v49, v16, s[88:91], s83 offen
  s_add_u32 s83, s83, 1280
  buffer_load_short_d16 v46, v16, s[88:91], s83 offen
  s_add_u32 s83, s83, 1280
  buffer_load_short_d16_hi v50, v16, s[88:91], s83 offen
  s_add_u32 s83, s83, 1280
  buffer_load_short_d16 v47, v16, s[88:91], s83 offen
  s_add_u32 s83, s83, 1280
  buffer_load_short_d16_hi v51, v16, s[88:91], s83 offen
  s_add_u32 s83, s85, 32
  buffer_load_short_d16 v52, v16, s[88:91], s83 offen
  s_add_u32 s83, s83, 1280
  buffer_load_short_d16_hi v56, v16, s[88:91], s83 offen
  s_add_u32 s83, s83, 1280
  buffer_load_short_d16 v53, v16, s[88:91], s83 offen
  s_add_u32 s83, s83, 1280
  buffer_load_short_d16_hi v57, v16, s[88:91], s83 offen
  s_add_u32 s83, s83, 1280
  buffer_load_short_d16 v54, v16, s[88:91], s83 offen
  s_add_u32 s83, s83, 1280
  buffer_load_short_d16_hi v58, v16, s[88:91], s83 offen
  s_add_u32 s83, s83, 1280
  buffer_load_short_d16 v55, v16, s[88:91], s83 offen
  s_add_u32 s83, s83, 1280
  buffer_load_short_d16_hi v59, v16, s[88:91], s83 offen
  s_mov_b32 exec_lo, 0x00ff00ff
  s_mov_b32 exec_hi, 0x00ff00ff
  s_add_u32 s83, s85, 64
  buffer_load_short_d16 v60, v16, s[88:91], s83 offen
  s_add_u32 s83, s83, 1280
  buffer_load_short_d16_hi v64, v16, s[88:91], s83 offen
  s_add_u32 s83, s83, 1280
  buffer_load_short_d16 v61, v16, s[88:91], s83 offen
  s_add_u32 s83, s83, 1280
  buffer_load_short_d16_hi v65, v16, s[88:91], s83 offen
  s_add_u32 s83, s83, 1280
  buffer_load_short_d16 v62, v16, s[88:91], s83 offen
  s_add_u32 s83, s83, 1280
  buffer_load_short_d16_hi v66, v16, s[88:91], s83 offen
  s_add_u32 s83, s83, 1280
  buffer_load_short_d16 v63, v16, s[88:91], s83 offen
  s_add_u32 s83, s83, 1280
  buffer_load_short_d16_hi v67, v16, s[88:91], s83 offen
  s_mov_b64 exec, -1
L_p25_30:
  s_add_u32 s80, s75, 2
  s_cmp_ge_u32 s80, 320
  s_cbranch_scc1 L_p25_31
  s_mov_b32 s84, 214748365
  s_mul_hi_u32 s81, s80, s84
  s_mul_i32 s82, s81, 20
  s_sub_u32 s82, s80, s82
  s_mul_i32 s85, s82, 40960
  s_mul_i32 s84, s81, 80
  s_add_u32 s85, s85, s84
  s_add_u32 s83, s85, 0
  buffer_load_short_d16 v68, v16, s[88:91], s83 offen
  s_add_u32 s83, s83, 1280
  buffer_load_short_d16_hi v72, v16, s[88:91], s83 offen
  s_add_u32 s83, s83, 1280
  buffer_load_short_d16 v69, v16, s[88:91], s83 offen
  s_add_u32 s83, s83, 1280
  buffer_load_short_d16_hi v73, v16, s[88:91], s83 offen
  s_add_u32 s83, s83, 1280
  buffer_load_short_d16 v70, v16, s[88:91], s83 offen
  s_add_u32 s83, s83, 1280
  buffer_load_short_d16_hi v74, v16, s[88:91], s83 offen
  s_add_u32 s83, s83, 1280
  buffer_load_short_d16 v71, v16, s[88:91], s83 offen
  s_add_u32 s83, s83, 1280
  buffer_load_short_d16_hi v75, v16, s[88:91], s83 offen
  s_add_u32 s83, s85, 32
  buffer_load_short_d16 v76, v16, s[88:91], s83 offen
  s_add_u32 s83, s83, 1280
  buffer_load_short_d16_hi v80, v16, s[88:91], s83 offen
  s_add_u32 s83, s83, 1280
  buffer_load_short_d16 v77, v16, s[88:91], s83 offen
  s_add_u32 s83, s83, 1280
  buffer_load_short_d16_hi v81, v16, s[88:91], s83 offen
  s_add_u32 s83, s83, 1280
  buffer_load_short_d16 v78, v16, s[88:91], s83 offen
  s_add_u32 s83, s83, 1280
  buffer_load_short_d16_hi v82, v16, s[88:91], s83 offen
  s_add_u32 s83, s83, 1280
  buffer_load_short_d16 v79, v16, s[88:91], s83 offen
  s_add_u32 s83, s83, 1280
  buffer_load_short_d16_hi v83, v16, s[88:91], s83 offen
  s_mov_b32 exec_lo, 0x00ff00ff
  s_mov_b32 exec_hi, 0x00ff00ff
  s_add_u32 s83, s85, 64
  buffer_load_short_d16 v84, v16, s[88:91], s83 offen
  s_add_u32 s83, s83, 1280
  buffer_load_short_d16_hi v88, v16, s[88:91], s83 offen
  s_add_u32 s83, s83, 1280
  buffer_load_short_d16 v85, v16, s[88:91], s83 offen
  s_add_u32 s83, s83, 1280
  buffer_load_short_d16_hi v89, v16, s[88:91], s83 offen
  s_add_u32 s83, s83, 1280
  buffer_load_short_d16 v86, v16, s[88:91], s83 offen
  s_add_u32 s83, s83, 1280
  buffer_load_short_d16_hi v90, v16, s[88:91], s83 offen
  s_add_u32 s83, s83, 1280
  buffer_load_short_d16 v87, v16, s[88:91], s83 offen
  s_add_u32 s83, s83, 1280
  buffer_load_short_d16_hi v91, v16, s[88:91], s83 offen
  s_mov_b64 exec, -1
L_p25_31:
  s_waitcnt vmcnt(0)
  s_add_u32 s80, s75, 0
  s_cmp_ge_u32 s80, 320
  s_cbranch_scc1 L_p25s_32
  s_mul_i32 s83, s80, 2560
  s_add_u32 s83, s83, 19398656
  v_or_b32 v20, v20, v24
  v_or_b32 v21, v21, v25
  v_or_b32 v22, v22, v26
  v_or_b32 v23, v23, v27
  v_or_b32 v28, v28, v32
  v_or_b32 v29, v29, v33
  v_or_b32 v30, v30, v34
  v_or_b32 v31, v31, v35
  v_or_b32 v36, v36, v40
  v_or_b32 v37, v37, v41
  v_or_b32 v38, v38, v42
  v_or_b32 v39, v39, v43
  buffer_store_dwordx4 v[20:23], v2, s[24:27], s83 offen sc1
  buffer_store_dwordx4 v[28:31], v2, s[24:27], s83 offen offset:1024 sc1
  s_mov_b32 exec_lo, 0x00ff00ff
  s_mov_b32 exec_hi, 0x00ff00ff
  buffer_store_dwordx4 v[36:39], v19, s[24:27], s83 offen offset:2048 sc1
  s_mov_b64 exec, -1
L_p25s_32:
  s_add_u32 s80, s75, 1
  s_cmp_ge_u32 s80, 320
  s_cbranch_scc1 L_p25s_33
  s_mul_i32 s83, s80, 2560
  s_add_u32 s83, s83, 19398656
  v_or_b32 v44, v44, v48
  v_or_b32 v45, v45, v49
  v_or_b32 v46, v46, v50
  v_or_b32 v47, v47, v51
  v_or_b32 v52, v52, v56
  v_or_b32 v53, v53, v57
  v_or_b32 v54, v54, v58
  v_or_b32 v55, v55, v59
  v_or_b32 v60, v60, v64
  v_or_b32 v61, v61, v65
  v_or_b32 v62, v62, v66
  v_or_b32 v63, v63, v67
  buffer_store_dwordx4 v[44:47], v2, s[24:27], s83 offen sc1
  buffer_store_dwordx4 v[52:55], v2, s[24:27], s83 offen offset:1024 sc1
  s_mov_b32 exec_lo, 0x00ff00ff
  s_mov_b32 exec_hi, 0x00ff00ff
  buffer_store_dwordx4 v[60:63], v19, s[24:27], s83 offen offset:2048 sc1
  s_mov_b64 exec, -1
L_p25s_33:
  s_add_u32 s80, s75, 2
  s_cmp_ge_u32 s80, 320
  s_cbranch_scc1 L_p25s_34
  s_mul_i32 s83, s80, 2560
  s_add_u32 s83, s83, 19398656
  v_or_b32 v68, v68, v72
  v_or_b32 v69, v69, v73
  v_or_b32 v70, v70, v74
  v_or_b32 v71, v71, v75
  v_or_b32 v76, v76, v80
  v_or_b32 v77, v77, v81
  v_or_b32 v78, v78, v82
  v_or_b32 v79, v79, v83
  v_or_b32 v84, v84, v88
  v_or_b32 v85, v85, v89
  v_or_b32 v86, v86, v90
  v_or_b32 v87, v87, v91
  buffer_store_dwordx4 v[68:71], v2, s[24:27], s83 offen sc1
  buffer_store_dwordx4 v[76:79], v2, s[24:27], s83 offen offset:1024 sc1
  s_mov_b32 exec_lo, 0x00ff00ff
  s_mov_b32 exec_hi, 0x00ff00ff
  buffer_store_dwordx4 v[84:87], v19, s[24:27], s83 offen offset:2048 sc1
  s_mov_b64 exec, -1
L_p25s_34:
  s_waitcnt vmcnt(0)
  s_barrier
  s_cmp_lg_u32 s3, 0
  s_cbranch_scc1 L_spw_35
  s_mov_b32 s90, 0
L_poll_36:
  s_mov_b64 exec, 0xff
  v_lshlrev_b32 v8, 5, v1
  buffer_load_dword v9, v8, s[28:31], 0 offen sc1
  s_mov_b64 exec, -1
  s_waitcnt vmcnt(0)
  v_cmp_le_u32 vcc, 32, v9
  s_nop 2
  s_and_b32 s91, vcc_lo, 0xff
  s_cmp_eq_u32 s91, 0xff
  s_cbranch_scc1 L_polld_37
  s_sleep 2
  s_add_u32 s90, s90, 1
  s_cmp_lt_u32 s90, 0x40000
  s_cbranch_scc1 L_poll_36
L_polld_37:
  s_movk_i32 s34, 112
  s_lshl_b32 s90, s34, 8
  s_add_u32 s90, s90, 26681344
  v_mov_b32 v3, 1
  v_mov_b32 v4, 0
  s_mov_b64 exec, 1
  buffer_atomic_add v3, v4, s[24:27], s90 offen sc1
  s_mov_b64 exec, -1
L_spw_35:
  s_barrier
L_p1_done:
  s_and_b32 s34, s2, 7
  s_lshr_b32 s35, s2, 3
  s_lshl_b32 s32, s34, 2
  s_lshr_b32 s34, s35, 3
  s_add_u32 s32, s32, s34
  s_and_b32 s33, s35, 7
  s_lshl_b32 s45, s2, 3
  s_add_u32 s45, s45, s3
  s_lshl_b32 s66, s33, 2
  s_and_b32 s35, s3, 3
  s_add_u32 s66, s66, s35
  s_lshr_b32 s35, s3, 2
  s_lshl_b32 s35, s35, 5
  s_add_u32 s66, s66, s35
  v_and_b32 v3, 31, v1
  v_lshlrev_b32 v3, 3, v3
  v_mov_b32 v8, 0
  v_mov_b32 v9, 0
  s_mov_b32 s40, -1
  s_mov_b32 s41, 0
  v_and_b32 v60, 31, v1
  v_lshrrev_b32 v61, 5, v1
  v_mul_u32_u24 v62, 320, v61
  v_lshl_add_u32 v62, v60, 4, v62
  v_add_u32 v15, 1280, v62
  v_add_u32 v14, 1024, v3
  v_mov_b32 v13, v2
  s_mov_b32 s38, 0x000fffff
  s_mov_b32 s39, 0x000fffff
  v_mov_b32 v36, 0x3f803f80
  v_mov_b32 v37, 0x3f803f80
  v_mov_b32 v38, 0x3f803f80
  v_mov_b32 v39, 0x3f803f80
  v_mov_b32 v40, 0x3f803f80
  v_mov_b32 v41, 0x3f803f80
  v_mov_b32 v42, 0x3f803f80
  v_mov_b32 v43, 0x3f803f80
  v_mov_b32 v44, 0x3f803f80
  v_mov_b32 v45, 0x3f803f80
  v_mov_b32 v46, 0x3f803f80
  v_mov_b32 v47, 0x3f803f80
  v_mov_b32 v48, 0x3f803f80
  v_mov_b32 v49, 0x3f803f80
  v_mov_b32 v50, 0x3f803f80
  v_mov_b32 v51, 0x3f803f80
  s_mov_b32 s36, 0
  s_mov_b32 s37, 1
  s_cmp_ge_u32 s3, 4
  s_cbranch_scc1 L_abw_38
  s_barrier
  s_lshl_b32 s34, s32, 6
  s_add_u32 s34, s34, s66
  s_mul_i32 s34, s34, 1280
  s_add_u32 s34, s34, 0
  buffer_load_dwordx4 v[4:7], v2, s[24:27], s34 offen sc1
  s_mov_b64 exec, s[40:41]
  buffer_load_dwordx2 v[8:9], v3, s[24:27], s34 offen offset:1024 sc1
  s_mov_b64 exec, -1
  s_waitcnt vmcnt(0)
  s_barrier
  s_branch L_ago_39
L_abw_38:
  s_cmp_lg_u32 s3, 4
  s_cbranch_scc1 L_anp_40
  s_mul_i32 s34, s32, 20
  s_lshr_b32 s35, s34, 6
  s_add_u32 s34, s34, 19
  s_lshr_b32 s34, s34, 6
  v_and_b32 v16, 1, v1
  v_mov_b32 v17, s35
  v_mov_b32 v18, s34
  v_cmp_eq_u32 vcc, 1, v16
  s_nop 1
  v_cndmask_b32 v16, v17, v18, vcc
  v_lshrrev_b32 v17, 1, v1
  v_mul_u32_u24 v17, 10, v17
  v_add_u32 v16, v16, v17
  v_lshlrev_b32 v16, 8, v16
  s_mov_b32 s91, 26712064
  s_mov_b32 s90, 0
  s_mov_b64 exec, 0x3f
L_wd_41:
  buffer_load_dword v17, v16, s[24:27], s91 offen sc1
  s_waitcnt vmcnt(0)
  v_cmp_le_u32 vcc, 8, v17
  s_nop 2
  s_cmp_eq_u64 vcc, exec
  s_cbranch_scc1 L_wdd_42
  s_sleep 2
  s_add_u32 s90, s90, 1
  s_cmp_lt_u32 s90, 0x40000
  s_cbranch_scc1 L_wd_41
L_wdd_42:
  s_mov_b64 exec, -1
L_anp_40:
  s_barrier
  s_and_b32 s34, s3, 3
  s_mul_i32 s42, s32, 163840
  s_lshl_b32 s44, s34, 10
  s_add_u32 s42, s42, s44
  s_add_u32 s42, s42, 2621440
  s_mov_b32 s43, 0
L_ad4_43:
  s_mov_b32 m0, s44
  s_add_u32 s44, s44, 4096
  buffer_load_dwordx4 v2, s[24:27], s42 offen sc1 lds
  s_add_u32 s42, s42, 4096
  s_mov_b32 m0, s44
  s_add_u32 s44, s44, 4096
  buffer_load_dwordx4 v2, s[24:27], s42 offen sc1 lds
  s_add_u32 s42, s42, 4096
  s_mov_b32 m0, s44
  s_add_u32 s44, s44, 4096
  buffer_load_dwordx4 v2, s[24:27], s42 offen sc1 lds
  s_add_u32 s42, s42, 4096
  s_mov_b32 m0, s44
  s_add_u32 s44, s44, 4096
  buffer_load_dwordx4 v2, s[24:27], s42 offen sc1 lds
  s_add_u32 s42, s42, 4096
  s_add_u32 s43, s43, 1
  s_cmp_lt_u32 s43, 2
  s_cbranch_scc1 L_ad4_43
  s_waitcnt vmcnt(4)
  s_barrier
  s_mov_b32 s43, 0
L_ad4_44:
  s_mov_b32 m0, s44
  s_add_u32 s44, s44, 4096
  buffer_load_dwordx4 v2, s[24:27], s42 offen sc1 lds
  s_add_u32 s42, s42, 4096
  s_mov_b32 m0, s44
  s_add_u32 s44, s44, 4096
  buffer_load_dwordx4 v2, s[24:27], s42 offen sc1 lds
  s_add_u32 s42, s42, 4096
  s_mov_b32 m0, s44
  s_add_u32 s44, s44, 4096
  buffer_load_dwordx4 v2, s[24:27], s42 offen sc1 lds
  s_add_u32 s42, s42, 4096
  s_mov_b32 m0, s44
  s_add_u32 s44, s44, 4096
  buffer_load_dwordx4 v2, s[24:27], s42 offen sc1 lds
  s_add_u32 s42, s42, 4096
  s_add_u32 s43, s43, 1
  s_cmp_lt_u32 s43, 3
  s_cbranch_scc1 L_ad4_44
  s_waitcnt vmcnt(0)
  s_barrier
  s_mul_i32 s34, s32, 20
  s_lshr_b32 s35, s34, 6
  s_add_u32 s34, s34, 19
  s_lshr_b32 s34, s34, 6
  v_and_b32 v16, 1, v1
  v_mov_b32 v17, s35
  v_mov_b32 v18, s34
  v_cmp_eq_u32 vcc, 1, v16
  s_nop 1
  v_cndmask_b32 v16, v17, v18, vcc
  v_lshrrev_b32 v17, 1, v1
  v_mul_u32_u24 v17, 10, v17
  v_add_u32 v16, v16, v17
  v_lshlrev_b32 v16, 8, v16
  s_mov_b32 s91, 26719744
  s_mov_b32 s90, 0
  s_mov_b64 exec, 0x3f
L_wd_45:
  buffer_load_dword v17, v16, s[24:27], s91 offen sc1
  s_waitcnt vmcnt(0)
  v_cmp_le_u32 vcc, 8, v17
  s_nop 2
  s_cmp_eq_u64 vcc, exec
  s_cbranch_scc1 L_wdd_46
  s_sleep 2
  s_add_u32 s90, s90, 1
  s_cmp_lt_u32 s90, 0x40000
  s_cbranch_scc1 L_wd_45
L_wdd_46:
  s_mov_b64 exec, -1
  s_lshl_b32 s34, s32, 6
  s_add_u32 s34, s34, s66
  s_mul_i32 s34, s34, 1280
  s_add_u32 s34, s34, 0
  buffer_load_dwordx4 v[4:7], v2, s[24:27], s34 offen sc1
  s_mov_b64 exec, s[40:41]
  buffer_load_dwordx2 v[8:9], v3, s[24:27], s34 offen offset:1024 sc1
  s_mov_b64 exec, -1
  s_mov_b32 s43, 0
L_ad4_47:
  s_mov_b32 m0, s44
  s_add_u32 s44, s44, 4096
  buffer_load_dwordx4 v2, s[24:27], s42 offen sc1 lds
  s_add_u32 s42, s42, 4096
  s_mov_b32 m0, s44
  s_add_u32 s44, s44, 4096
  buffer_load_dwordx4 v2, s[24:27], s42 offen sc1 lds
  s_add_u32 s42, s42, 4096
  s_mov_b32 m0, s44
  s_add_u32 s44, s44, 4096
  buffer_load_dwordx4 v2, s[24:27], s42 offen sc1 lds
  s_add_u32 s42, s42, 4096
  s_mov_b32 m0, s44
  s_add_u32 s44, s44, 4096
  buffer_load_dwordx4 v2, s[24:27], s42 offen sc1 lds
  s_add_u32 s42, s42, 4096
  s_add_u32 s43, s43, 1
  s_cmp_lt_u32 s43, 5
  s_cbranch_scc1 L_ad4_47
  s_waitcnt vmcnt(0)
  s_barrier
  s_mov_b32 s36, 2
L_ago_39:
L_scan_48:
  v_mov_b32 v10, v13
  v_mov_b32 v11, v14
  v_mov_b32 v62, 0xff800000
  s_mov_b32 s34, 0
L_scanl_49:
  ds_read_b128 v[24:27], v10 offset:0
  ds_read_b64 v[32:33], v11 offset:0
  v_add_u32 v10, 2560, v10
  v_add_u32 v11, 2560, v11
  s_waitcnt lgkmcnt(0)
  v_mfma_f32_32x32x16_bf16 v[128:143], v[24:27], v[4:7], 0
  v_mfma_f32_32x32x8_bf16 v[128:143], v[32:33], v[8:9], v[128:143]
  s_nop 11
  v_max3_f32 v62, v128, v129, v62
  v_max3_f32 v62, v130, v131, v62
  v_max3_f32 v62, v132, v133, v62
  v_max3_f32 v62, v134, v135, v62
  v_max3_f32 v62, v136, v137, v62
  v_max3_f32 v62, v138, v139, v62
  v_max3_f32 v62, v140, v141, v62
  v_max3_f32 v62, v142, v143, v62
  s_add_u32 s34, s34, 1
  s_cmp_lt_u32 s34, s37
  s_cbranch_scc1 L_scanl_49
  v_mov_b32 v63, v62
  s_nop 1
  v_permlane32_swap_b32 v62, v63
  v_max_f32 v62, v62, v63
  v_sub_f32 v62, 0, v62
  v_mov_b32 v112, v62
  v_mov_b32 v96, 0
  v_mov_b32 v113, v62
  v_mov_b32 v97, 0
  v_mov_b32 v114, v62
  v_mov_b32 v98, 0
  v_mov_b32 v115, v62
  v_mov_b32 v99, 0
  v_mov_b32 v116, v62
  v_mov_b32 v100, 0
  v_mov_b32 v117, v62
  v_mov_b32 v101, 0
  v_mov_b32 v118, v62
  v_mov_b32 v102, 0
  v_mov_b32 v119, v62
  v_mov_b32 v103, 0
  v_mov_b32 v120, v62
  v_mov_b32 v104, 0
  v_mov_b32 v121, v62
  v_mov_b32 v105, 0
  v_mov_b32 v122, v62
  v_mov_b32 v106, 0
  v_mov_b32 v123, v62
  v_mov_b32 v107, 0
  v_mov_b32 v124, v62
  v_mov_b32 v108, 0
  v_mov_b32 v125, v62
  v_mov_b32 v109, 0
  v_mov_b32 v126, v62
  v_mov_b32 v110, 0
  v_mov_b32 v127, v62
  v_mov_b32 v111, 0
  v_mov_b32 v10, v13
  v_mov_b32 v11, v14
  v_mov_b32 v12, v15
  ds_read_b128 v[24:27], v10 offset:0
  ds_read_b64 v[32:33], v11 offset:0
  ds_read_b128 v[28:31], v10 offset:2560
  ds_read_b64 v[34:35], v11 offset:2560
  s_mov_b64 exec, s[38:39]
  ds_read_b128 v[36:39], v12 offset:0
  ds_read_b128 v[40:43], v12 offset:640
  s_mov_b64 exec, -1
  v_mov_b32 v52, 0
  v_mov_b32 v53, 0
  v_mov_b32 v54, 0
  v_mov_b32 v55, 0
  v_mov_b32 v56, 0
  v_mov_b32 v57, 0
  v_mov_b32 v58, 0
  v_mov_b32 v59, 0
  v_mov_b32 v188, 0
  v_mov_b32 v189, 0
  v_mov_b32 v190, 0
  v_mov_b32 v191, 0
  s_waitcnt lgkmcnt(4)
  v_mfma_f32_32x32x16_bf16 v[128:143], v[24:27], v[4:7], v[112:127]
  v_mfma_f32_32x32x8_bf16 v[128:143], v[32:33], v[8:9], v[128:143]
  s_mov_b32 s43, 0
L_aloop_50:
  s_lshl_b32 s35, s36, 8
  s_or_b32 s35, s35, s43
  s_waitcnt lgkmcnt(0)
  v_mfma_f32_32x32x16_bf16 v[144:159], v[28:31], v[4:7], v[112:127]
  ds_read_b128 v[24:27], v10 offset:5120
  ds_read_b64 v[32:33], v11 offset:5120
  v_cvt_pk_bf16_f32 v58, v188, v189
  v_cvt_pk_bf16_f32 v59, v190, v191
  s_nop 2
  v_exp_f32 v128, v128
  v_exp_f32 v129, v129
  v_exp_f32 v130, v130
  v_exp_f32 v131, v131
  v_mfma_f32_32x32x16_bf16 v[96:111], v[48:51], v[56:59], v[96:111]
  s_mov_b64 exec, s[38:39]
  ds_read_b128 v[44:47], v12 offset:2560
  ds_read_b128 v[48:51], v12 offset:3200
  s_mov_b64 exec, -1
  v_exp_f32 v132, v132
  v_exp_f32 v133, v133
  v_exp_f32 v134, v134
  v_exp_f32 v135, v135
  v_cvt_pk_bf16_f32 v52, v128, v129
  v_cvt_pk_bf16_f32 v53, v130, v131
  v_mfma_f32_32x32x8_bf16 v[144:159], v[34:35], v[8:9], v[144:159]
  v_cvt_pk_bf16_f32 v54, v132, v133
  v_cvt_pk_bf16_f32 v55, v134, v135
  v_exp_f32 v136, v136
  v_exp_f32 v137, v137
  v_exp_f32 v138, v138
  v_exp_f32 v139, v139
  v_mfma_f32_32x32x16_bf16 v[96:111], v[36:39], v[52:55], v[96:111]
  v_exp_f32 v140, v140
  v_exp_f32 v141, v141
  v_exp_f32 v142, v142
  v_exp_f32 v143, v143
  v_cvt_pk_bf16_f32 v56, v136, v137
  v_cvt_pk_bf16_f32 v57, v138, v139
  s_waitcnt lgkmcnt(0)
  v_mfma_f32_32x32x16_bf16 v[160:175], v[24:27], v[4:7], v[112:127]
  ds_read_b128 v[28:31], v10 offset:7680
  ds_read_b64 v[34:35], v11 offset:7680
  v_cvt_pk_bf16_f32 v58, v140, v141
  v_cvt_pk_bf16_f32 v59, v142, v143
  v_exp_f32 v144, v144
  v_exp_f32 v145, v145
  v_exp_f32 v146, v146
  v_exp_f32 v147, v147
  v_mfma_f32_32x32x16_bf16 v[96:111], v[40:43], v[56:59], v[96:111]
  s_mov_b64 exec, s[38:39]
  ds_read_b128 v[36:39], v12 offset:5120
  ds_read_b128 v[40:43], v12 offset:5760
  s_mov_b64 exec, -1
  v_exp_f32 v148, v148
  v_exp_f32 v149, v149
  v_exp_f32 v150, v150
  v_exp_f32 v151, v151
  v_cvt_pk_bf16_f32 v52, v144, v145
  v_cvt_pk_bf16_f32 v53, v146, v147
  v_mfma_f32_32x32x8_bf16 v[160:175], v[32:33], v[8:9], v[160:175]
  v_cvt_pk_bf16_f32 v54, v148, v149
  v_cvt_pk_bf16_f32 v55, v150, v151
  v_exp_f32 v152, v152
  v_exp_f32 v153, v153
  v_exp_f32 v154, v154
  v_exp_f32 v155, v155
  v_mfma_f32_32x32x16_bf16 v[96:111], v[44:47], v[52:55], v[96:111]
  v_exp_f32 v156, v156
  v_exp_f32 v157, v157
  v_exp_f32 v158, v158
  v_exp_f32 v159, v159
  v_cvt_pk_bf16_f32 v56, v152, v153
  v_cvt_pk_bf16_f32 v57, v154, v155
  s_waitcnt lgkmcnt(0)
  v_mfma_f32_32x32x16_bf16 v[176:191], v[28:31], v[4:7], v[112:127]
  ds_read_b128 v[24:27], v10 offset:10240
  ds_read_b64 v[32:33], v11 offset:10240
  v_cvt_pk_bf16_f32 v58, v156, v157
  v_cvt_pk_bf16_f32 v59, v158, v159
  v_exp_f32 v160, v160
  v_exp_f32 v161, v161
  v_exp_f32 v162, v162
  v_exp_f32 v163, v163
  v_mfma_f32_32x32x16_bf16 v[96:111], v[48:51], v[56:59], v[96:111]
  s_mov_b64 exec, s[38:39]
  ds_read_b128 v[44:47], v12 offset:7680
  ds_read_b128 v[48:51], v12 offset:8320
  s_mov_b64 exec, -1
  v_exp_f32 v164, v164
  v_exp_f32 v165, v165
  v_exp_f32 v166, v166
  v_exp_f32 v167, v167
  v_cvt_pk_bf16_f32 v52, v160, v161
  v_cvt_pk_bf16_f32 v53, v162, v163
  v_mfma_f32_32x32x8_bf16 v[176:191], v[34:35], v[8:9], v[176:191]
  v_cvt_pk_bf16_f32 v54, v164, v165
  v_cvt_pk_bf16_f32 v55, v166, v167
  v_exp_f32 v168, v168
  v_exp_f32 v169, v169
  v_exp_f32 v170, v170
  v_exp_f32 v171, v171
  v_mfma_f32_32x32x16_bf16 v[96:111], v[36:39], v[52:55], v[96:111]
  v_exp_f32 v172, v172
  v_exp_f32 v173, v173
  v_exp_f32 v174, v174
  v_exp_f32 v175, v175
  v_cvt_pk_bf16_f32 v56, v168, v169
  v_cvt_pk_bf16_f32 v57, v170, v171
  s_waitcnt lgkmcnt(0)
  v_mfma_f32_32x32x16_bf16 v[128:143], v[24:27], v[4:7], v[112:127]
  ds_read_b128 v[28:31], v10 offset:12800
  ds_read_b64 v[34:35], v11 offset:12800
  v_cvt_pk_bf16_f32 v58, v172, v173
  v_cvt_pk_bf16_f32 v59, v174, v175
  v_exp_f32 v176, v176
  v_exp_f32 v177, v177
  v_exp_f32 v178, v178
  v_exp_f32 v179, v179
  v_mfma_f32_32x32x16_bf16 v[96:111], v[40:43], v[56:59], v[96:111]
  s_mov_b64 exec, s[38:39]
  ds_read_b128 v[36:39], v12 offset:10240
  ds_read_b128 v[40:43], v12 offset:10880
  s_mov_b64 exec, -1
  v_exp_f32 v180, v180
  v_exp_f32 v181, v181
  v_exp_f32 v182, v182
  v_exp_f32 v183, v183
  v_cvt_pk_bf16_f32 v52, v176, v177
  v_cvt_pk_bf16_f32 v53, v178, v179
  v_mfma_f32_32x32x8_bf16 v[128:143], v[32:33], v[8:9], v[128:143]
  v_cvt_pk_bf16_f32 v54, v180, v181
  v_cvt_pk_bf16_f32 v55, v182, v183
  v_exp_f32 v184, v184
  v_exp_f32 v185, v185
  v_exp_f32 v186, v186
  v_exp_f32 v187, v187
  v_mfma_f32_32x32x16_bf16 v[96:111], v[44:47], v[52:55], v[96:111]
  v_exp_f32 v188, v188
  v_exp_f32 v189, v189
  v_exp_f32 v190, v190
  v_exp_f32 v191, v191
  v_cvt_pk_bf16_f32 v56, v184, v185
  v_cvt_pk_bf16_f32 v57, v186, v187
  s_cmp_gt_u32 s35, 1
  s_cbranch_scc1 L_ab_52
  s_barrier
L_ab_52:
  s_waitcnt lgkmcnt(0)
  v_mfma_f32_32x32x16_bf16 v[144:159], v[28:31], v[4:7], v[112:127]
  ds_read_b128 v[24:27], v10 offset:15360
  ds_read_b64 v[32:33], v11 offset:15360
  v_cvt_pk_bf16_f32 v58, v188, v189
  v_cvt_pk_bf16_f32 v59, v190, v191
  v_exp_f32 v128, v128
  v_exp_f32 v129, v129
  v_exp_f32 v130, v130
  v_exp_f32 v131, v131
  v_mfma_f32_32x32x16_bf16 v[96:111], v[48:51], v[56:59], v[96:111]
  s_mov_b64 exec, s[38:39]
  ds_read_b128 v[44:47], v12 offset:12800
  ds_read_b128 v[48:51], v12 offset:13440
  s_mov_b64 exec, -1
  v_exp_f32 v132, v132
  v_exp_f32 v133, v133
  v_exp_f32 v134, v134
  v_exp_f32 v135, v135
  v_cvt_pk_bf16_f32 v52, v128, v129
  v_cvt_pk_bf16_f32 v53, v130, v131
  v_mfma_f32_32x32x8_bf16 v[144:159], v[34:35], v[8:9], v[144:159]
  v_cvt_pk_bf16_f32 v54, v132, v133
  v_cvt_pk_bf16_f32 v55, v134, v135
  v_exp_f32 v136, v136
  v_exp_f32 v137, v137
  v_exp_f32 v138, v138
  v_exp_f32 v139, v139
  v_mfma_f32_32x32x16_bf16 v[96:111], v[36:39], v[52:55], v[96:111]
  v_exp_f32 v140, v140
  v_exp_f32 v141, v141
  v_exp_f32 v142, v142
  v_exp_f32 v143, v143
  v_cvt_pk_bf16_f32 v56, v136, v137
  v_cvt_pk_bf16_f32 v57, v138, v139
  s_waitcnt lgkmcnt(0)
  v_mfma_f32_32x32x16_bf16 v[160:175], v[24:27], v[4:7], v[112:127]
  ds_read_b128 v[28:31], v10 offset:17920
  ds_read_b64 v[34:35], v11 offset:17920
  v_cvt_pk_bf16_f32 v58, v140, v141
  v_cvt_pk_bf16_f32 v59, v142, v143
  v_exp_f32 v144, v144
  v_exp_f32 v145, v145
  v_exp_f32 v146, v146
  v_exp_f32 v147, v147
  v_mfma_f32_32x32x16_bf16 v[96:111], v[40:43], v[56:59], v[96:111]
  s_mov_b64 exec, s[38:39]
  ds_read_b128 v[36:39], v12 offset:15360
  ds_read_b128 v[40:43], v12 offset:16000
  s_mov_b64 exec, -1
  v_exp_f32 v148, v148
  v_exp_f32 v149, v149
  v_exp_f32 v150, v150
  v_exp_f32 v151, v151
  v_cvt_pk_bf16_f32 v52, v144, v145
  v_cvt_pk_bf16_f32 v53, v146, v147
  v_mfma_f32_32x32x8_bf16 v[160:175], v[32:33], v[8:9], v[160:175]
  v_cvt_pk_bf16_f32 v54, v148, v149
  v_cvt_pk_bf16_f32 v55, v150, v151
  v_exp_f32 v152, v152
  v_exp_f32 v153, v153
  v_exp_f32 v154, v154
  v_exp_f32 v155, v155
  v_mfma_f32_32x32x16_bf16 v[96:111], v[44:47], v[52:55], v[96:111]
  v_exp_f32 v156, v156
  v_exp_f32 v157, v157
  v_exp_f32 v158, v158
  v_exp_f32 v159, v159
  v_cvt_pk_bf16_f32 v56, v152, v153
  v_cvt_pk_bf16_f32 v57, v154, v155
  s_waitcnt lgkmcnt(0)
  v_mfma_f32_32x32x16_bf16 v[176:191], v[28:31], v[4:7], v[112:127]
  ds_read_b128 v[24:27], v10 offset:20480
  ds_read_b64 v[32:33], v11 offset:20480
  v_cvt_pk_bf16_f32 v58, v156, v157
  v_cvt_pk_bf16_f32 v59, v158, v159
  v_exp_f32 v160, v160
  v_exp_f32 v161, v161
  v_exp_f32 v162, v162
  v_exp_f32 v163, v163
  v_mfma_f32_32x32x16_bf16 v[96:111], v[48:51], v[56:59], v[96:111]
  s_mov_b64 exec, s[38:39]
  ds_read_b128 v[44:47], v12 offset:17920
  ds_read_b128 v[48:51], v12 offset:18560
  s_mov_b64 exec, -1
  v_exp_f32 v164, v164
  v_exp_f32 v165, v165
  v_exp_f32 v166, v166
  v_exp_f32 v167, v167
  v_cvt_pk_bf16_f32 v52, v160, v161
  v_cvt_pk_bf16_f32 v53, v162, v163
  v_mfma_f32_32x32x8_bf16 v[176:191], v[34:35], v[8:9], v[176:191]
  v_cvt_pk_bf16_f32 v54, v164, v165
  v_cvt_pk_bf16_f32 v55, v166, v167
  v_exp_f32 v168, v168
  v_exp_f32 v169, v169
  v_exp_f32 v170, v170
  v_exp_f32 v171, v171
  v_mfma_f32_32x32x16_bf16 v[96:111], v[36:39], v[52:55], v[96:111]
  v_exp_f32 v172, v172
  v_exp_f32 v173, v173
  v_exp_f32 v174, v174
  v_exp_f32 v175, v175
  v_cvt_pk_bf16_f32 v56, v168, v169
  v_cvt_pk_bf16_f32 v57, v170, v171
  s_waitcnt lgkmcnt(0)
  v_mfma_f32_32x32x16_bf16 v[128:143], v[24:27], v[4:7], v[112:127]
  ds_read_b128 v[28:31], v10 offset:23040
  ds_read_b64 v[34:35], v11 offset:23040
  v_cvt_pk_bf16_f32 v58, v172, v173
  v_cvt_pk_bf16_f32 v59, v174, v175
  v_exp_f32 v176, v176
  v_exp_f32 v177, v177
  v_exp_f32 v178, v178
  v_exp_f32 v179, v179
  v_mfma_f32_32x32x16_bf16 v[96:111], v[40:43], v[56:59], v[96:111]
  s_mov_b64 exec, s[38:39]
  ds_read_b128 v[36:39], v12 offset:20480
  ds_read_b128 v[40:43], v12 offset:21120
  s_mov_b64 exec, -1
  v_exp_f32 v180, v180
  v_exp_f32 v181, v181
  v_exp_f32 v182, v182
  v_exp_f32 v183, v183
  v_cvt_pk_bf16_f32 v52, v176, v177
  v_cvt_pk_bf16_f32 v53, v178, v179
  v_mfma_f32_32x32x8_bf16 v[128:143], v[32:33], v[8:9], v[128:143]
  v_cvt_pk_bf16_f32 v54, v180, v181
  v_cvt_pk_bf16_f32 v55, v182, v183
  v_exp_f32 v184, v184
  v_exp_f32 v185, v185
  v_exp_f32 v186, v186
  v_exp_f32 v187, v187
  v_mfma_f32_32x32x16_bf16 v[96:111], v[44:47], v[52:55], v[96:111]
  v_exp_f32 v188, v188
  v_exp_f32 v189, v189
  v_exp_f32 v190, v190
  v_exp_f32 v191, v191
  v_add_u32 v10, 20480, v10
  v_add_u32 v11, 20480, v11
  v_add_u32 v12, 20480, v12
  v_cvt_pk_bf16_f32 v56, v184, v185
  v_cvt_pk_bf16_f32 v57, v186, v187
  s_cmp_lg_u32 s35, 5
  s_cbranch_scc1 L_pkl_53
  s_cmp_ge_u32 s3, 4
  s_cbranch_scc1 L_npl_54
  s_lshl_b32 s45, s2, 2
  s_add_u32 s45, s45, s3
  s_mov_b32 s68, s16
  s_mov_b32 s69, s17
  s_mov_b32 s70, 1966080
  s_mov_b32 s71, 0x20000
  s_mov_b32 s72, s12
  s_mov_b32 s73, s13
  s_mov_b32 s74, 1966080
  s_mov_b32 s75, 0x20000
  s_mov_b32 s76, s14
  s_mov_b32 s77, s15
  s_mov_b32 s78, 1966080
  s_mov_b32 s79, 0x20000
  s_cmp_ge_u32 s45, 768
  s_cbranch_scc1 L_nowd_55
  s_mov_b32 s63, 89478486
  s_mul_hi_u32 s60, s45, s63
  s_mul_i32 s61, s60, 48
  s_sub_u32 s61, s45, s61
  v_and_b32 v192, 15, v1
  v_lshrrev_b32 v193, 4, v1
  s_movk_i32 s63, 10240
  v_mul_lo_u32 v193, v193, s63
  v_lshl_add_u32 v192, v192, 1, v193
  s_mul_i32 s64, s61, 40960
  s_mul_i32 s63, s60, 80
  s_add_u32 s64, s64, s63
  s_add_u32 s62, s64, 0
  buffer_load_short_d16 v194, v192, s[68:71], s62 offen
  s_add_u32 s62, s62, 1280
  buffer_load_short_d16_hi v198, v192, s[68:71], s62 offen
  s_add_u32 s62, s62, 1280
  buffer_load_short_d16 v195, v192, s[68:71], s62 offen
  s_add_u32 s62, s62, 1280
  buffer_load_short_d16_hi v199, v192, s[68:71], s62 offen
  s_add_u32 s62, s62, 1280
  buffer_load_short_d16 v196, v192, s[68:71], s62 offen
  s_add_u32 s62, s62, 1280
  buffer_load_short_d16_hi v200, v192, s[68:71], s62 offen
  s_add_u32 s62, s62, 1280
  buffer_load_short_d16 v197, v192, s[68:71], s62 offen
  s_add_u32 s62, s62, 1280
  buffer_load_short_d16_hi v201, v192, s[68:71], s62 offen
  s_add_u32 s62, s64, 32
  buffer_load_short_d16 v202, v192, s[68:71], s62 offen
  s_add_u32 s62, s62, 1280
  buffer_load_short_d16_hi v206, v192, s[68:71], s62 offen
  s_add_u32 s62, s62, 1280
  buffer_load_short_d16 v203, v192, s[68:71], s62 offen
  s_add_u32 s62, s62, 1280
  buffer_load_short_d16_hi v207, v192, s[68:71], s62 offen
  s_add_u32 s62, s62, 1280
  buffer_load_short_d16 v204, v192, s[68:71], s62 offen
  s_add_u32 s62, s62, 1280
  buffer_load_short_d16_hi v208, v192, s[68:71], s62 offen
  s_add_u32 s62, s62, 1280
  buffer_load_short_d16 v205, v192, s[68:71], s62 offen
  s_add_u32 s62, s62, 1280
  buffer_load_short_d16_hi v209, v192, s[68:71], s62 offen
  s_mov_b32 exec_lo, 0x00ff00ff
  s_mov_b32 exec_hi, 0x00ff00ff
  s_add_u32 s62, s64, 64
  buffer_load_short_d16 v210, v192, s[68:71], s62 offen
  s_add_u32 s62, s62, 1280
  buffer_load_short_d16_hi v214, v192, s[68:71], s62 offen
  s_add_u32 s62, s62, 1280
  buffer_load_short_d16 v211, v192, s[68:71], s62 offen
  s_add_u32 s62, s62, 1280
  buffer_load_short_d16_hi v215, v192, s[68:71], s62 offen
  s_add_u32 s62, s62, 1280
  buffer_load_short_d16 v212, v192, s[68:71], s62 offen
  s_add_u32 s62, s62, 1280
  buffer_load_short_d16_hi v216, v192, s[68:71], s62 offen
  s_add_u32 s62, s62, 1280
  buffer_load_short_d16 v213, v192, s[68:71], s62 offen
  s_add_u32 s62, s62, 1280
  buffer_load_short_d16_hi v217, v192, s[68:71], s62 offen
  s_mov_b64 exec, -1
L_nowd_55:
  v_and_b32 v218, 15, v1
  v_lshrrev_b32 v219, 5, v1
  s_movk_i32 s63, 24576
  v_mul_lo_u32 v219, v219, s63
  v_lshl_add_u32 v218, v218, 1, v219
  s_add_u32 s46, s45, 0
  s_cmp_ge_u32 s46, 1920
  s_cbranch_scc1 L_nogu_56
  s_mov_b32 s58, 214748365
  s_mul_hi_u32 s47, s46, s58
  s_mul_i32 s48, s47, 20
  s_sub_u32 s48, s46, s48
  s_mov_b32 s58, 1431655766
  s_mul_hi_u32 s49, s47, s58
  s_mul_i32 s50, s49, 3
  s_sub_u32 s50, s47, s50
  s_mul_i32 s59, s48, 98304
  s_lshl_b32 s57, s47, 5
  s_add_u32 s59, s59, s57
  s_mov_b32 exec_lo, 65535
  s_mov_b32 exec_hi, 65535
  s_mov_b32 s56, s59
  buffer_load_short_d16 v220, v218, s[72:75], s56 offen
  s_add_u32 s56, s56, 3072
  buffer_load_short_d16_hi v224, v218, s[72:75], s56 offen
  s_add_u32 s56, s56, 3072
  buffer_load_short_d16 v221, v218, s[72:75], s56 offen
  s_add_u32 s56, s56, 3072
  buffer_load_short_d16_hi v225, v218, s[72:75], s56 offen
  s_add_u32 s56, s56, 3072
  buffer_load_short_d16 v222, v218, s[72:75], s56 offen
  s_add_u32 s56, s56, 3072
  buffer_load_short_d16_hi v226, v218, s[72:75], s56 offen
  s_add_u32 s56, s56, 3072
  buffer_load_short_d16 v223, v218, s[72:75], s56 offen
  s_add_u32 s56, s56, 3072
  buffer_load_short_d16_hi v227, v218, s[72:75], s56 offen
  s_add_u32 s56, s56, 27648
  buffer_load_short_d16 v228, v218, s[72:75], s56 offen
  s_add_u32 s56, s56, 3072
  buffer_load_short_d16_hi v232, v218, s[72:75], s56 offen
  s_add_u32 s56, s56, 3072
  buffer_load_short_d16 v229, v218, s[72:75], s56 offen
  s_add_u32 s56, s56, 3072
  buffer_load_short_d16_hi v233, v218, s[72:75], s56 offen
  s_add_u32 s56, s56, 3072
  buffer_load_short_d16 v230, v218, s[72:75], s56 offen
  s_add_u32 s56, s56, 3072
  buffer_load_short_d16_hi v234, v218, s[72:75], s56 offen
  s_add_u32 s56, s56, 3072
  buffer_load_short_d16 v231, v218, s[72:75], s56 offen
  s_add_u32 s56, s56, 3072
  buffer_load_short_d16_hi v235, v218, s[72:75], s56 offen
  s_add_u32 s56, s56, 27648
  s_mov_b32 exec_lo, 4294901760
  s_mov_b32 exec_hi, 4294901760
  s_mov_b32 s56, s59
  buffer_load_short_d16 v220, v218, s[76:79], s56 offen
  s_add_u32 s56, s56, 3072
  buffer_load_short_d16_hi v224, v218, s[76:79], s56 offen
  s_add_u32 s56, s56, 3072
  buffer_load_short_d16 v221, v218, s[76:79], s56 offen
  s_add_u32 s56, s56, 3072
  buffer_load_short_d16_hi v225, v218, s[76:79], s56 offen
  s_add_u32 s56, s56, 3072
  buffer_load_short_d16 v222, v218, s[76:79], s56 offen
  s_add_u32 s56, s56, 3072
  buffer_load_short_d16_hi v226, v218, s[76:79], s56 offen
  s_add_u32 s56, s56, 3072
  buffer_load_short_d16 v223, v218, s[76:79], s56 offen
  s_add_u32 s56, s56, 3072
  buffer_load_short_d16_hi v227, v218, s[76:79], s56 offen
  s_add_u32 s56, s56, 27648
  buffer_load_short_d16 v228, v218, s[76:79], s56 offen
  s_add_u32 s56, s56, 3072
  buffer_load_short_d16_hi v232, v218, s[76:79], s56 offen
  s_add_u32 s56, s56, 3072
  buffer_load_short_d16 v229, v218, s[76:79], s56 offen
  s_add_u32 s56, s56, 3072
  buffer_load_short_d16_hi v233, v218, s[76:79], s56 offen
  s_add_u32 s56, s56, 3072
  buffer_load_short_d16 v230, v218, s[76:79], s56 offen
  s_add_u32 s56, s56, 3072
  buffer_load_short_d16_hi v234, v218, s[76:79], s56 offen
  s_add_u32 s56, s56, 3072
  buffer_load_short_d16 v231, v218, s[76:79], s56 offen
  s_add_u32 s56, s56, 3072
  buffer_load_short_d16_hi v235, v218, s[76:79], s56 offen
  s_add_u32 s56, s56, 27648
  s_mov_b64 exec, -1
L_nogu_56:
  s_add_u32 s51, s45, 1024
  s_cmp_ge_u32 s51, 1920
  s_cbranch_scc1 L_nogu_57
  s_mov_b32 s58, 214748365
  s_mul_hi_u32 s52, s51, s58
  s_mul_i32 s53, s52, 20
  s_sub_u32 s53, s51, s53
  s_mov_b32 s58, 1431655766
  s_mul_hi_u32 s54, s52, s58
  s_mul_i32 s55, s54, 3
  s_sub_u32 s55, s52, s55
  s_mul_i32 s59, s53, 98304
  s_lshl_b32 s57, s52, 5
  s_add_u32 s59, s59, s57
  s_mov_b32 exec_lo, 65535
  s_mov_b32 exec_hi, 65535
  s_mov_b32 s56, s59
  buffer_load_short_d16 v236, v218, s[72:75], s56 offen
  s_add_u32 s56, s56, 3072
  buffer_load_short_d16_hi v240, v218, s[72:75], s56 offen
  s_add_u32 s56, s56, 3072
  buffer_load_short_d16 v237, v218, s[72:75], s56 offen
  s_add_u32 s56, s56, 3072
  buffer_load_short_d16_hi v241, v218, s[72:75], s56 offen
  s_add_u32 s56, s56, 3072
  buffer_load_short_d16 v238, v218, s[72:75], s56 offen
  s_add_u32 s56, s56, 3072
  buffer_load_short_d16_hi v242, v218, s[72:75], s56 offen
  s_add_u32 s56, s56, 3072
  buffer_load_short_d16 v239, v218, s[72:75], s56 offen
  s_add_u32 s56, s56, 3072
  buffer_load_short_d16_hi v243, v218, s[72:75], s56 offen
  s_add_u32 s56, s56, 27648
  buffer_load_short_d16 v244, v218, s[72:75], s56 offen
  s_add_u32 s56, s56, 3072
  buffer_load_short_d16_hi v248, v218, s[72:75], s56 offen
  s_add_u32 s56, s56, 3072
  buffer_load_short_d16 v245, v218, s[72:75], s56 offen
  s_add_u32 s56, s56, 3072
  buffer_load_short_d16_hi v249, v218, s[72:75], s56 offen
  s_add_u32 s56, s56, 3072
  buffer_load_short_d16 v246, v218, s[72:75], s56 offen
  s_add_u32 s56, s56, 3072
  buffer_load_short_d16_hi v250, v218, s[72:75], s56 offen
  s_add_u32 s56, s56, 3072
  buffer_load_short_d16 v247, v218, s[72:75], s56 offen
  s_add_u32 s56, s56, 3072
  buffer_load_short_d16_hi v251, v218, s[72:75], s56 offen
  s_add_u32 s56, s56, 27648
  s_mov_b32 exec_lo, 4294901760
  s_mov_b32 exec_hi, 4294901760
  s_mov_b32 s56, s59
  buffer_load_short_d16 v236, v218, s[76:79], s56 offen
  s_add_u32 s56, s56, 3072
  buffer_load_short_d16_hi v240, v218, s[76:79], s56 offen
  s_add_u32 s56, s56, 3072
  buffer_load_short_d16 v237, v218, s[76:79], s56 offen
  s_add_u32 s56, s56, 3072
  buffer_load_short_d16_hi v241, v218, s[76:79], s56 offen
  s_add_u32 s56, s56, 3072
  buffer_load_short_d16 v238, v218, s[76:79], s56 offen
  s_add_u32 s56, s56, 3072
  buffer_load_short_d16_hi v242, v218, s[76:79], s56 offen
  s_add_u32 s56, s56, 3072
  buffer_load_short_d16 v239, v218, s[76:79], s56 offen
  s_add_u32 s56, s56, 3072
  buffer_load_short_d16_hi v243, v218, s[76:79], s56 offen
  s_add_u32 s56, s56, 27648
  buffer_load_short_d16 v244, v218, s[76:79], s56 offen
  s_add_u32 s56, s56, 3072
  buffer_load_short_d16_hi v248, v218, s[76:79], s56 offen
  s_add_u32 s56, s56, 3072
  buffer_load_short_d16 v245, v218, s[76:79], s56 offen
  s_add_u32 s56, s56, 3072
  buffer_load_short_d16_hi v249, v218, s[76:79], s56 offen
  s_add_u32 s56, s56, 3072
  buffer_load_short_d16 v246, v218, s[76:79], s56 offen
  s_add_u32 s56, s56, 3072
  buffer_load_short_d16_hi v250, v218, s[76:79], s56 offen
  s_add_u32 s56, s56, 3072
  buffer_load_short_d16 v247, v218, s[76:79], s56 offen
  s_add_u32 s56, s56, 3072
  buffer_load_short_d16_hi v251, v218, s[76:79], s56 offen
  s_add_u32 s56, s56, 27648
  s_mov_b64 exec, -1
L_nogu_57:
L_npl_54:
L_pkl_53:
  s_add_u32 s43, s43, 1
  s_cmp_lt_u32 s43, 8
  s_cbranch_scc1 L_aloop_50
  v_cvt_pk_bf16_f32 v58, v188, v189
  v_cvt_pk_bf16_f32 v59, v190, v191
  s_nop 1
  v_mfma_f32_32x32x16_bf16 v[96:111], v[48:51], v[56:59], v[96:111]
  s_waitcnt lgkmcnt(0)
  s_nop 10
  v_mov_b32 v60, v104
  v_mov_b32 v61, v104
  s_nop 1
  v_permlane32_swap_b32 v60, v61
  v_mul_f32 v62, 0, v96
  v_fmac_f32 v62, 0, v97
  v_fmac_f32 v62, 0, v98
  v_fmac_f32 v62, 0, v99
  v_fmac_f32 v62, 0, v100
  v_fmac_f32 v62, 0, v101
  v_fmac_f32 v62, 0, v102
  v_fmac_f32 v62, 0, v103
  v_fmac_f32 v62, 0, v104
  v_fmac_f32 v62, 0, v105
  v_fmac_f32 v62, 0, v106
  v_fmac_f32 v62, 0, v107
  v_cmp_u_f32 vcc, v62, v62
  s_nop 2
  s_mov_b64 s[80:81], vcc
  v_mov_b32 v63, 0x53800000
  v_cmp_nlt_f32 vcc, v61, v63
  s_nop 2
  s_or_b64 s[80:81], s[80:81], vcc
  s_cmp_eq_u32 s36, 1
  s_cbranch_scc1 L_afin_51
  s_cmp_eq_u64 s[80:81], 0
  s_cbranch_scc1 L_afin_51
  s_mov_b32 s36, 1
  s_mov_b32 s37, 64
  s_branch L_scan_48
L_afin_51:
  v_rcp_f32 v61, v61
  s_nop 0
  v_mul_f32 v96, v96, v61
  v_mul_f32 v97, v97, v61
  v_mul_f32 v98, v98, v61
  v_mul_f32 v99, v99, v61
  v_mul_f32 v100, v100, v61
  v_mul_f32 v101, v101, v61
  v_mul_f32 v102, v102, v61
  v_mul_f32 v103, v103, v61
  v_mul_f32 v104, v104, v61
  v_mul_f32 v105, v105, v61
  v_mul_f32 v106, v106, v61
  v_mul_f32 v107, v107, v61
  v_cvt_pk_bf16_f32 v52, v96, v97
  v_cvt_pk_bf16_f32 v53, v98, v99
  v_cvt_pk_bf16_f32 v54, v100, v101
  v_cvt_pk_bf16_f32 v55, v102, v103
  v_cvt_pk_bf16_f32 v56, v104, v105
  v_cvt_pk_bf16_f32 v57, v106, v107
  v_and_b32 v60, 31, v1
  v_lshrrev_b32 v61, 5, v1
  s_lshl_b32 s34, s66, 1
  v_lshrrev_b32 v62, 4, v60
  v_add_u32 v62, s34, v62
  v_mul_u32_u24 v62, 20, v62
  v_and_b32 v60, 15, v60
  s_mul_i32 s34, s32, 20
  s_add_u32 s35, s34, 0
  v_lshl_add_u32 v63, v61, 2, s35
  v_lshrrev_b32 v64, 5, v63
  v_add_u32 v64, v64, v62
  v_lshlrev_b32 v64, 6, v64
  v_bfe_u32 v65, v63, 3, 2
  v_lshl_add_u32 v64, v65, 4, v64
  v_add_u32 v64, v64, v60
  v_lshlrev_b32 v64, 4, v64
  v_and_b32 v65, 7, v63
  v_lshl_add_u32 v66, v65, 1, v64
  s_add_u32 s35, s34, 8
  v_lshl_add_u32 v63, v61, 2, s35
  v_lshrrev_b32 v64, 5, v63
  v_add_u32 v64, v64, v62
  v_lshlrev_b32 v64, 6, v64
  v_bfe_u32 v65, v63, 3, 2
  v_lshl_add_u32 v64, v65, 4, v64
  v_add_u32 v64, v64, v60
  v_lshlrev_b32 v64, 4, v64
  v_and_b32 v65, 7, v63
  v_lshl_add_u32 v67, v65, 1, v64
  s_add_u32 s35, s34, 16
  v_lshl_add_u32 v63, v61, 2, s35
  v_lshrrev_b32 v64, 5, v63
  v_add_u32 v64, v64, v62
  v_lshlrev_b32 v64, 6, v64
  v_bfe_u32 v65, v63, 3, 2
  v_lshl_add_u32 v64, v65, 4, v64
  v_add_u32 v64, v64, v60
  v_lshlrev_b32 v64, 4, v64
  v_and_b32 v65, 7, v63
  v_lshl_add_u32 v68, v65, 1, v64
  s_mov_b32 s34, 7864320
  buffer_store_dwordx2 v[52:53], v66, s[24:27], s34 offen sc1
  buffer_store_dwordx2 v[54:55], v67, s[24:27], s34 offen sc1
  s_mov_b64 exec, s[40:41]
  buffer_store_dwordx2 v[56:57], v68, s[24:27], s34 offen sc1
  s_mov_b64 exec, -1
  s_waitcnt vmcnt(0)
  s_add_u32 s34, s66, 8
  s_lshl_b32 s90, s34, 8
  s_add_u32 s90, s90, 26681344
  v_mov_b32 v60, 1
  v_mov_b32 v61, 0
  s_mov_b64 exec, 1
  buffer_atomic_add v60, v61, s[24:27], s90 offen sc1
  s_mov_b64 exec, -1
  s_cmp_ge_u32 s3, 4
  s_cbranch_scc1 L_npack_58
  s_waitcnt vmcnt(0)
  s_cmp_ge_u32 s45, 768
  s_cbranch_scc1 L_nowd2_59
  s_mul_i32 s62, s45, 2560
  s_add_u32 s62, s62, 20217856
  v_or_b32 v194, v194, v198
  v_or_b32 v195, v195, v199
  v_or_b32 v196, v196, v200
  v_or_b32 v197, v197, v201
  v_or_b32 v202, v202, v206
  v_or_b32 v203, v203, v207
  v_or_b32 v204, v204, v208
  v_or_b32 v205, v205, v209
  v_or_b32 v210, v210, v214
  v_or_b32 v211, v211, v215
  v_or_b32 v212, v212, v216
  v_or_b32 v213, v213, v217
  buffer_store_dwordx4 v[194:197], v2, s[24:27], s62 offen sc1
  buffer_store_dwordx4 v[202:205], v2, s[24:27], s62 offen offset:1024 sc1
  v_lshrrev_b32 v192, 4, v1
  v_and_b32 v193, 15, v1
  v_lshlrev_b32 v193, 4, v193
  v_lshl_add_u32 v192, v192, 7, v193
  s_mov_b32 exec_lo, 0x00ff00ff
  s_mov_b32 exec_hi, 0x00ff00ff
  buffer_store_dwordx4 v[210:213], v192, s[24:27], s62 offen offset:2048 sc1
  s_mov_b64 exec, -1
L_nowd2_59:
  s_cmp_ge_u32 s46, 1920
  s_cbranch_scc1 L_nogu2_60
  s_mul_i32 s57, s49, 40
  s_lshl_b32 s56, s48, 1
  s_add_u32 s57, s57, s56
  s_mul_i32 s57, s57, 3
  s_add_u32 s57, s57, s50
  s_lshl_b32 s57, s57, 10
  s_add_u32 s57, s57, 22183936
  v_mov_b32 v4, 0
  s_mov_b32 s58, 0x3f803f80
  v_or_b32 v220, v220, v224
  v_or_b32 v221, v221, v225
  v_or_b32 v222, v222, v226
  v_or_b32 v223, v223, v227
  buffer_store_dwordx4 v[220:223], v2, s[24:27], s57 offen sc1
  s_add_u32 s57, s57, 3072
  v_dot2c_f32_bf16 v4, s58, v220
  v_dot2c_f32_bf16 v4, s58, v221
  v_dot2c_f32_bf16 v4, s58, v222
  v_dot2c_f32_bf16 v4, s58, v223
  v_or_b32 v228, v228, v232
  v_or_b32 v229, v229, v233
  v_or_b32 v230, v230, v234
  v_or_b32 v231, v231, v235
  buffer_store_dwordx4 v[228:231], v2, s[24:27], s57 offen sc1
  s_add_u32 s57, s57, 3072
  v_dot2c_f32_bf16 v4, s58, v228
  v_dot2c_f32_bf16 v4, s58, v229
  v_dot2c_f32_bf16 v4, s58, v230
  v_dot2c_f32_bf16 v4, s58, v231
  s_nop 2
  v_mov_b32 v5, v4
  s_nop 1
  v_permlane32_swap_b32 v4, v5
  v_add_f32 v4, v4, v5
  v_and_b32 v5, 31, v1
  v_mul_u32_u24 v5, 80, v5
  s_mul_i32 s57, s47, 2560
  s_lshl_b32 s56, s48, 2
  s_add_u32 s57, s57, s56
  s_add_u32 s57, s57, 26435584
  s_mov_b32 exec_lo, -1
  s_mov_b32 exec_hi, 0
  buffer_store_dword v4, v5, s[24:27], s57 offen sc1
  s_mov_b64 exec, -1
L_nogu2_60:
  s_cmp_ge_u32 s51, 1920
  s_cbranch_scc1 L_nogu2_61
  s_mul_i32 s57, s54, 40
  s_lshl_b32 s56, s53, 1
  s_add_u32 s57, s57, s56
  s_mul_i32 s57, s57, 3
  s_add_u32 s57, s57, s55
  s_lshl_b32 s57, s57, 10
  s_add_u32 s57, s57, 22183936
  v_mov_b32 v4, 0
  s_mov_b32 s58, 0x3f803f80
  v_or_b32 v236, v236, v240
  v_or_b32 v237, v237, v241
  v_or_b32 v238, v238, v242
  v_or_b32 v239, v239, v243
  buffer_store_dwordx4 v[236:239], v2, s[24:27], s57 offen sc1
  s_add_u32 s57, s57, 3072
  v_dot2c_f32_bf16 v4, s58, v236
  v_dot2c_f32_bf16 v4, s58, v237
  v_dot2c_f32_bf16 v4, s58, v238
  v_dot2c_f32_bf16 v4, s58, v239
  v_or_b32 v244, v244, v248
  v_or_b32 v245, v245, v249
  v_or_b32 v246, v246, v250
  v_or_b32 v247, v247, v251
  buffer_store_dwordx4 v[244:247], v2, s[24:27], s57 offen sc1
  s_add_u32 s57, s57, 3072
  v_dot2c_f32_bf16 v4, s58, v244
  v_dot2c_f32_bf16 v4, s58, v245
  v_dot2c_f32_bf16 v4, s58, v246
  v_dot2c_f32_bf16 v4, s58, v247
  s_nop 2
  v_mov_b32 v5, v4
  s_nop 1
  v_permlane32_swap_b32 v4, v5
  v_add_f32 v4, v4, v5
  v_and_b32 v5, 31, v1
  v_mul_u32_u24 v5, 80, v5
  s_mul_i32 s57, s52, 2560
  s_lshl_b32 s56, s53, 2
  s_add_u32 s57, s57, s56
  s_add_u32 s57, s57, 26435584
  s_mov_b32 exec_lo, -1
  s_mov_b32 exec_hi, 0
  buffer_store_dword v4, v5, s[24:27], s57 offen sc1
  s_mov_b64 exec, -1
L_nogu2_61:
  s_waitcnt vmcnt(0)
  s_and_b32 s34, s2, 7
  s_add_u32 s34, s34, 104
  s_lshl_b32 s90, s34, 8
  s_add_u32 s90, s90, 26681344
  v_mov_b32 v4, 1
  v_mov_b32 v5, 0
  s_mov_b64 exec, 1
  buffer_atomic_add v4, v5, s[24:27], s90 offen sc1
  s_mov_b64 exec, -1
  s_and_b32 s34, s2, 7
  s_lshr_b32 s35, s2, 3
  s_lshr_b32 s32, s34, 1
  s_lshl_b32 s32, s32, 2
  s_lshr_b32 s33, s35, 3
  s_add_u32 s32, s32, s33
  s_and_b32 s33, s34, 1
  s_lshl_b32 s33, s33, 3
  s_and_b32 s35, s35, 7
  s_add_u32 s33, s33, s35
  s_lshl_b32 s45, s32, 1
  s_add_u32 s45, s45, 8
  s_lshl_b32 s91, s45, 8
  s_add_u32 s91, s91, 26681344
  v_lshlrev_b32 v16, 8, v1
  s_mov_b32 s90, 0
  s_mov_b64 exec, 0x3
L_pc_62:
  buffer_load_dword v17, v16, s[24:27], s91 offen sc1
  s_waitcnt vmcnt(0)
  v_cmp_le_u32 vcc, 32, v17
  s_nop 2
  s_cmp_eq_u64 vcc, exec
  s_cbranch_scc1 L_pcd_63
  s_sleep 2
  s_add_u32 s90, s90, 1
  s_cmp_lt_u32 s90, 0x40000
  s_cbranch_scc1 L_pc_62
L_pcd_63:
  s_mov_b64 exec, -1
  s_mov_b32 s60, s4
  s_mov_b32 s61, s5
  s_mov_b32 s62, 2621440
  s_mov_b32 s63, 0x20000
  v_and_b32 v5, 15, v1
  v_lshrrev_b32 v6, 4, v1
  s_lshl_b32 s34, s32, 6
  s_lshl_b32 s35, s3, 4
  s_add_u32 s34, s34, s35
  v_add_u32 v7, s34, v5
  s_movk_i32 s34, 1280
  v_mul_lo_u32 v4, v7, s34
  v_lshl_add_u32 v4, v6, 3, v4
  s_mul_i32 s34, s33, 80
  v_add_u32 v4, s34, v4
  buffer_load_dwordx2 v[8:9], v4, s[60:63], 0 offen offset:0
  buffer_load_dwordx2 v[10:11], v4, s[60:63], 0 offen offset:32
  buffer_load_dwordx2 v[12:13], v4, s[60:63], 0 offen offset:64
  s_lshl_b32 s58, s32, 2
  s_add_u32 s58, s58, s3
  s_mul_i32 s58, s58, 20480
  s_add_u32 s58, s58, 7864320
  buffer_load_dwordx4 v[148:151], v2, s[24:27], s58 offen offset:0 sc1
  buffer_load_dwordx4 v[152:155], v2, s[24:27], s58 offen offset:1024 sc1
  buffer_load_dwordx4 v[156:159], v2, s[24:27], s58 offen offset:2048 sc1
  buffer_load_dwordx4 v[160:163], v2, s[24:27], s58 offen offset:3072 sc1
  s_add_u32 s58, s58, 4096
  buffer_load_dwordx4 v[164:167], v2, s[24:27], s58 offen offset:0 sc1
  buffer_load_dwordx4 v[168:171], v2, s[24:27], s58 offen offset:1024 sc1
  buffer_load_dwordx4 v[172:175], v2, s[24:27], s58 offen offset:2048 sc1
  buffer_load_dwordx4 v[176:179], v2, s[24:27], s58 offen offset:3072 sc1
  s_add_u32 s58, s58, 4096
  buffer_load_dwordx4 v[180:183], v2, s[24:27], s58 offen offset:0 sc1
  buffer_load_dwordx4 v[184:187], v2, s[24:27], s58 offen offset:1024 sc1
  buffer_load_dwordx4 v[188:191], v2, s[24:27], s58 offen offset:2048 sc1
  buffer_load_dwordx4 v[192:195], v2, s[24:27], s58 offen offset:3072 sc1
  s_add_u32 s58, s58, 4096
  buffer_load_dwordx4 v[196:199], v2, s[24:27], s58 offen offset:0 sc1
  buffer_load_dwordx4 v[200:203], v2, s[24:27], s58 offen offset:1024 sc1
  buffer_load_dwordx4 v[204:207], v2, s[24:27], s58 offen offset:2048 sc1
  buffer_load_dwordx4 v[208:211], v2, s[24:27], s58 offen offset:3072 sc1
  s_add_u32 s58, s58, 4096
  buffer_load_dwordx4 v[212:215], v2, s[24:27], s58 offen offset:0 sc1
  buffer_load_dwordx4 v[216:219], v2, s[24:27], s58 offen offset:1024 sc1
  buffer_load_dwordx4 v[220:223], v2, s[24:27], s58 offen offset:2048 sc1
  buffer_load_dwordx4 v[224:227], v2, s[24:27], s58 offen offset:3072 sc1
L_npack_58:
  s_barrier
  s_and_b32 s34, s2, 7
  s_lshr_b32 s35, s2, 3
  s_lshr_b32 s32, s34, 1
  s_lshl_b32 s32, s32, 2
  s_lshr_b32 s33, s35, 3
  s_add_u32 s32, s32, s33
  s_and_b32 s33, s34, 1
  s_lshl_b32 s33, s33, 3
  s_and_b32 s35, s35, 7
  s_add_u32 s33, s33, s35
  s_cmp_lt_u32 s3, 4
  s_cbranch_scc1 L_xc_64
  s_and_b32 s34, s3, 1
  s_cmp_ge_u32 s3, 6
  s_cbranch_scc1 L_xx_65
  s_movk_i32 s45, 112
  s_lshl_b32 s91, s45, 8
  s_add_u32 s91, s91, 26681344
  v_lshlrev_b32 v8, 8, v1
  s_mov_b32 s90, 0
  s_mov_b64 exec, 0x1
L_pc_66:
  buffer_load_dword v9, v8, s[24:27], s91 offen sc1
  s_waitcnt vmcnt(0)
  v_cmp_le_u32 vcc, 16, v9
  s_nop 2
  s_cmp_eq_u64 vcc, exec
  s_cbranch_scc1 L_pcd_67
  s_sleep 2
  s_add_u32 s90, s90, 1
  s_cmp_lt_u32 s90, 0x40000
  s_cbranch_scc1 L_pc_66
L_pcd_67:
  s_mov_b64 exec, -1
  s_and_b32 s34, s3, 1
  s_mul_i32 s44, s34, 2048
  s_mul_i32 s40, s33, 51200
  s_add_u32 s40, s40, s44
  s_add_u32 s40, s40, 19398656
  s_add_u32 s44, s44, 112640
  s_add_u32 m0, s44, 0
  s_add_u32 s41, s40, 0
  buffer_load_dwordx4 v2, s[24:27], s41 offen sc1 lds
  s_add_u32 m0, s44, 1024
  s_add_u32 s41, s40, 1024
  buffer_load_dwordx4 v2, s[24:27], s41 offen sc1 lds
  s_add_u32 m0, s44, 2048
  s_add_u32 s41, s40, 2048
  buffer_load_dwordx4 v2, s[24:27], s41 offen sc1 lds
  s_add_u32 s40, s40, 5120
  s_add_u32 s44, s44, 5120
  s_add_u32 m0, s44, 0
  s_add_u32 s41, s40, 0
  buffer_load_dwordx4 v2, s[24:27], s41 offen sc1 lds
  s_add_u32 m0, s44, 1024
  s_add_u32 s41, s40, 1024
  buffer_load_dwordx4 v2, s[24:27], s41 offen sc1 lds
  s_add_u32 m0, s44, 2048
  s_add_u32 s41, s40, 2048
  buffer_load_dwordx4 v2, s[24:27], s41 offen sc1 lds
  s_add_u32 s40, s40, 5120
  s_add_u32 s44, s44, 5120
  s_add_u32 m0, s44, 0
  s_add_u32 s41, s40, 0
  buffer_load_dwordx4 v2, s[24:27], s41 offen sc1 lds
  s_add_u32 m0, s44, 1024
  s_add_u32 s41, s40, 1024
  buffer_load_dwordx4 v2, s[24:27], s41 offen sc1 lds
  s_add_u32 m0, s44, 2048
  s_add_u32 s41, s40, 2048
  buffer_load_dwordx4 v2, s[24:27], s41 offen sc1 lds
  s_add_u32 s40, s40, 5120
  s_add_u32 s44, s44, 5120
  s_barrier
  s_add_u32 m0, s44, 0
  s_add_u32 s41, s40, 0
  buffer_load_dwordx4 v2, s[24:27], s41 offen sc1 lds
  s_add_u32 m0, s44, 1024
  s_add_u32 s41, s40, 1024
  buffer_load_dwordx4 v2, s[24:27], s41 offen sc1 lds
  s_add_u32 m0, s44, 2048
  s_add_u32 s41, s40, 2048
  buffer_load_dwordx4 v2, s[24:27], s41 offen sc1 lds
  s_add_u32 s40, s40, 5120
  s_add_u32 s44, s44, 5120
  s_add_u32 m0, s44, 0
  s_add_u32 s41, s40, 0
  buffer_load_dwordx4 v2, s[24:27], s41 offen sc1 lds
  s_add_u32 m0, s44, 1024
  s_add_u32 s41, s40, 1024
  buffer_load_dwordx4 v2, s[24:27], s41 offen sc1 lds
  s_add_u32 m0, s44, 2048
  s_add_u32 s41, s40, 2048
  buffer_load_dwordx4 v2, s[24:27], s41 offen sc1 lds
  s_add_u32 s40, s40, 5120
  s_add_u32 s44, s44, 5120
  s_add_u32 m0, s44, 0
  s_add_u32 s41, s40, 0
  buffer_load_dwordx4 v2, s[24:27], s41 offen sc1 lds
  s_add_u32 m0, s44, 1024
  s_add_u32 s41, s40, 1024
  buffer_load_dwordx4 v2, s[24:27], s41 offen sc1 lds
  s_add_u32 m0, s44, 2048
  s_add_u32 s41, s40, 2048
  buffer_load_dwordx4 v2, s[24:27], s41 offen sc1 lds
  s_add_u32 s40, s40, 5120
  s_add_u32 s44, s44, 5120
  s_waitcnt vmcnt(15)
  s_barrier
  s_add_u32 m0, s44, 0
  s_add_u32 s41, s40, 0
  buffer_load_dwordx4 v2, s[24:27], s41 offen sc1 lds
  s_add_u32 m0, s44, 1024
  s_add_u32 s41, s40, 1024
  buffer_load_dwordx4 v2, s[24:27], s41 offen sc1 lds
  s_add_u32 m0, s44, 2048
  s_add_u32 s41, s40, 2048
  buffer_load_dwordx4 v2, s[24:27], s41 offen sc1 lds
  s_add_u32 s40, s40, 5120
  s_add_u32 s44, s44, 5120
  s_add_u32 m0, s44, 0
  s_add_u32 s41, s40, 0
  buffer_load_dwordx4 v2, s[24:27], s41 offen sc1 lds
  s_add_u32 m0, s44, 1024
  s_add_u32 s41, s40, 1024
  buffer_load_dwordx4 v2, s[24:27], s41 offen sc1 lds
  s_add_u32 m0, s44, 2048
  s_add_u32 s41, s40, 2048
  buffer_load_dwordx4 v2, s[24:27], s41 offen sc1 lds
  s_add_u32 s40, s40, 5120
  s_add_u32 s44, s44, 5120
  s_waitcnt vmcnt(18)
  s_barrier
  s_add_u32 m0, s44, 0
  s_add_u32 s41, s40, 0
  buffer_load_dwordx4 v2, s[24:27], s41 offen sc1 lds
  s_add_u32 m0, s44, 1024
  s_add_u32 s41, s40, 1024
  buffer_load_dwordx4 v2, s[24:27], s41 offen sc1 lds
  s_add_u32 m0, s44, 2048
  s_add_u32 s41, s40, 2048
  buffer_load_dwordx4 v2, s[24:27], s41 offen sc1 lds
  s_add_u32 s40, s40, 5120
  s_add_u32 s44, s44, 5120
  s_add_u32 m0, s44, 0
  s_add_u32 s41, s40, 0
  buffer_load_dwordx4 v2, s[24:27], s41 offen sc1 lds
  s_add_u32 m0, s44, 1024
  s_add_u32 s41, s40, 1024
  buffer_load_dwordx4 v2, s[24:27], s41 offen sc1 lds
  s_add_u32 m0, s44, 2048
  s_add_u32 s41, s40, 2048
  buffer_load_dwordx4 v2, s[24:27], s41 offen sc1 lds
  s_add_u32 s40, s40, 5120
  s_add_u32 s44, s44, 5120
  s_waitcnt vmcnt(21)
  s_barrier
  s_waitcnt vmcnt(18)
  s_barrier
  s_waitcnt vmcnt(15)
  s_barrier
  s_waitcnt vmcnt(12)
  s_barrier
  s_waitcnt vmcnt(9)
  s_barrier
  s_waitcnt vmcnt(6)
  s_barrier
  s_waitcnt vmcnt(3)
  s_barrier
  s_waitcnt vmcnt(0)
  s_barrier
  s_mov_b32 s38, 0
L_ob_68:
  s_barrier
  s_add_u32 s38, s38, 1
  s_cmp_lt_u32 s38, 14
  s_cbranch_scc1 L_ob_68
  s_branch L_p3_done
L_xx_65:
  s_cmp_lg_u32 s34, 0
  s_cbranch_scc1 L_xp7_69
  s_barrier
  s_mov_b32 s38, 0
L_ob_70:
  s_barrier
  s_add_u32 s38, s38, 1
  s_cmp_lt_u32 s38, 10
  s_cbranch_scc1 L_ob_70
  s_lshl_b32 s45, s32, 1
  s_add_u32 s45, s45, 40
  s_lshl_b32 s91, s45, 8
  s_add_u32 s91, s91, 26681344
  v_lshlrev_b32 v8, 8, v1
  s_mov_b32 s90, 0
  s_mov_b64 exec, 0x3
L_pc_71:
  buffer_load_dword v9, v8, s[24:27], s91 offen sc1
  s_waitcnt vmcnt(0)
  v_cmp_le_u32 vcc, 32, v9
  s_nop 2
  s_cmp_eq_u64 vcc, exec
  s_cbranch_scc1 L_pcd_72
  s_sleep 2
  s_add_u32 s90, s90, 1
  s_cmp_lt_u32 s90, 0x40000
  s_cbranch_scc1 L_pc_71
L_pcd_72:
  s_mov_b64 exec, -1
  s_mov_b32 s38, 0
L_ob_73:
  s_barrier
  s_add_u32 s38, s38, 1
  s_cmp_lt_u32 s38, 12
  s_cbranch_scc1 L_ob_73
  s_and_b32 s34, s2, 7
  s_lshr_b32 s34, s34, 2
  s_lshl_b32 s34, s34, 2
  s_lshr_b32 s35, s2, 6
  s_add_u32 s45, s34, s35
  s_add_u32 s45, s45, 72
  s_lshl_b32 s91, s45, 8
  s_add_u32 s91, s91, 26681344
  v_lshlrev_b32 v8, 8, v1
  s_mov_b32 s90, 0
  s_mov_b64 exec, 0x1
L_pc_74:
  buffer_load_dword v9, v8, s[24:27], s91 offen sc1
  s_waitcnt vmcnt(0)
  v_cmp_le_u32 vcc, 32, v9
  s_nop 2
  s_cmp_eq_u64 vcc, exec
  s_cbranch_scc1 L_pcd_75
  s_sleep 2
  s_add_u32 s90, s90, 1
  s_cmp_lt_u32 s90, 0x40000
  s_cbranch_scc1 L_pc_74
L_pcd_75:
  s_mov_b64 exec, -1
  s_mov_b32 s38, 0
L_ob_76:
  s_barrier
  s_add_u32 s38, s38, 1
  s_cmp_lt_u32 s38, 2
  s_cbranch_scc1 L_ob_76
  s_branch L_p3_done
L_xp7_69:
  s_and_b32 s34, s2, 7
  s_lshr_b32 s35, s2, 3
  s_and_b32 s34, s34, 3
  s_lshl_b32 s34, s34, 3
  s_and_b32 s35, s35, 7
  s_add_u32 s34, s34, s35
  s_barrier
  s_movk_i32 s45, 104
  s_lshl_b32 s91, s45, 8
  s_add_u32 s91, s91, 26681344
  v_lshlrev_b32 v8, 8, v1
  s_mov_b32 s90, 0
  s_mov_b64 exec, 0xff
L_pc_77:
  buffer_load_dword v9, v8, s[24:27], s91 offen sc1
  s_waitcnt vmcnt(0)
  v_cmp_le_u32 vcc, 128, v9
  s_nop 2
  s_cmp_eq_u64 vcc, exec
  s_cbranch_scc1 L_pcd_78
  s_sleep 2
  s_add_u32 s90, s90, 1
  s_cmp_lt_u32 s90, 0x40000
  s_cbranch_scc1 L_pc_77
L_pcd_78:
  s_mov_b64 exec, -1
  s_mul_i32 s40, s34, 122880
  s_add_u32 s40, s40, 22183936
  s_mov_b32 s44, 0
  s_mov_b32 s39, 0
L_w7_79:
  s_barrier
  s_mov_b32 m0, s44
  s_add_u32 s44, s44, 1024
  buffer_load_dwordx4 v2, s[24:27], s40 offen sc1 lds
  s_add_u32 s40, s40, 1024
  s_mov_b32 m0, s44
  s_add_u32 s44, s44, 1024
  buffer_load_dwordx4 v2, s[24:27], s40 offen sc1 lds
  s_add_u32 s40, s40, 1024
  s_mov_b32 m0, s44
  s_add_u32 s44, s44, 1024
  buffer_load_dwordx4 v2, s[24:27], s40 offen sc1 lds
  s_add_u32 s40, s40, 1024
  s_mov_b32 m0, s44
  s_add_u32 s44, s44, 1024
  buffer_load_dwordx4 v2, s[24:27], s40 offen sc1 lds
  s_add_u32 s40, s40, 1024
  s_mov_b32 m0, s44
  s_add_u32 s44, s44, 1024
  buffer_load_dwordx4 v2, s[24:27], s40 offen sc1 lds
  s_add_u32 s40, s40, 1024
  s_mov_b32 m0, s44
  s_add_u32 s44, s44, 1024
  buffer_load_dwordx4 v2, s[24:27], s40 offen sc1 lds
  s_add_u32 s40, s40, 1024
  s_add_u32 s39, s39, 1
  s_cmp_lt_u32 s39, 18
  s_cbranch_scc1 L_w7_79
  s_mov_b32 s38, 0
L_ob_80:
  s_barrier
  s_add_u32 s38, s38, 1
  s_cmp_lt_u32 s38, 6
  s_cbranch_scc1 L_ob_80
  s_branch L_p3_done
L_xc_64:
  s_mov_b32 s60, s4
  s_mov_b32 s61, s5
  s_mov_b32 s62, 2621440
  s_mov_b32 s63, 0x20000
  v_lshrrev_b32 v5, 4, v1
  v_and_b32 v6, 7, v1
  v_lshlrev_b32 v6, 4, v6
  v_lshl_add_u32 v5, v5, 7, v6
  v_add_u32 v80, 112640, v2
  v_add_u32 v84, 114688, v5
  v_and_b32 v5, 15, v1
  v_lshrrev_b32 v6, 4, v1
  s_lshl_b32 s34, s32, 6
  s_lshl_b32 s35, s3, 4
  s_add_u32 s34, s34, s35
  s_add_u32 s34, s34, 0
  v_add_u32 v7, s34, v5
  s_movk_i32 s34, 1280
  v_mul_lo_u32 v4, v7, s34
  v_lshl_add_u32 v4, v6, 3, v4
  s_mul_i32 s34, s33, 80
  v_add_u32 v4, s34, v4
  s_mul_i32 s34, s33, 40
  s_add_u32 s34, s34, 0
  v_lshl_add_u32 v14, v6, 2, s34
  v_lshrrev_b32 v15, 5, v7
  v_mul_u32_u24 v15, 40, v15
  v_lshrrev_b32 v16, 4, v14
  v_add_u32 v15, v15, v16
  v_lshlrev_b32 v15, 6, v15
  v_bfe_u32 v16, v14, 3, 1
  v_lshl_add_u32 v15, v16, 5, v15
  v_and_b32 v16, 31, v7
  v_add_u32 v15, v15, v16
  v_lshlrev_b32 v15, 4, v15
  v_and_b32 v16, 7, v14
  v_lshl_add_u32 v15, v16, 1, v15
  v_add_u32 v88, 10485760, v15
  s_mul_i32 s34, s33, 40
  s_add_u32 s34, s34, 16
  v_lshl_add_u32 v14, v6, 2, s34
  v_lshrrev_b32 v15, 5, v7
  v_mul_u32_u24 v15, 40, v15
  v_lshrrev_b32 v16, 4, v14
  v_add_u32 v15, v15, v16
  v_lshlrev_b32 v15, 6, v15
  v_bfe_u32 v16, v14, 3, 1
  v_lshl_add_u32 v15, v16, 5, v15
  v_and_b32 v16, 31, v7
  v_add_u32 v15, v15, v16
  v_lshlrev_b32 v15, 4, v15
  v_and_b32 v16, 7, v14
  v_lshl_add_u32 v15, v16, 1, v15
  v_add_u32 v89, 10485760, v15
  s_mul_i32 s34, s33, 40
  s_add_u32 s34, s34, 32
  v_lshl_add_u32 v14, v6, 2, s34
  v_lshrrev_b32 v15, 5, v7
  v_mul_u32_u24 v15, 40, v15
  v_lshrrev_b32 v16, 4, v14
  v_add_u32 v15, v15, v16
  v_lshlrev_b32 v15, 6, v15
  v_bfe_u32 v16, v14, 3, 1
  v_lshl_add_u32 v15, v16, 5, v15
  v_and_b32 v16, 31, v7
  v_add_u32 v15, v15, v16
  v_lshlrev_b32 v15, 4, v15
  v_and_b32 v16, 7, v14
  v_lshl_add_u32 v15, v16, 1, v15
  v_add_u32 v90, 10485760, v15
  v_lshlrev_b32 v15, 7, v7
  s_lshl_b32 s34, s33, 3
  s_add_u32 s34, s34, 26730496
  v_add_u32 v91, s34, v15
  v_and_b32 v5, 15, v1
  v_lshrrev_b32 v6, 4, v1
  s_lshl_b32 s34, s32, 6
  s_lshl_b32 s35, s3, 4
  s_add_u32 s34, s34, s35
  s_add_u32 s34, s34, 1024
  v_add_u32 v7, s34, v5
  s_movk_i32 s34, 1280
  v_mul_lo_u32 v102, v7, s34
  v_lshl_add_u32 v102, v6, 3, v102
  s_mul_i32 s34, s33, 80
  v_add_u32 v102, s34, v102
  s_mul_i32 s34, s33, 40
  s_add_u32 s34, s34, 0
  v_lshl_add_u32 v14, v6, 2, s34
  v_lshrrev_b32 v15, 5, v7
  v_mul_u32_u24 v15, 40, v15
  v_lshrrev_b32 v16, 4, v14
  v_add_u32 v15, v15, v16
  v_lshlrev_b32 v15, 6, v15
  v_bfe_u32 v16, v14, 3, 1
  v_lshl_add_u32 v15, v16, 5, v15
  v_and_b32 v16, 31, v7
  v_add_u32 v15, v15, v16
  v_lshlrev_b32 v15, 4, v15
  v_and_b32 v16, 7, v14
  v_lshl_add_u32 v15, v16, 1, v15
  v_add_u32 v104, 10485760, v15
  s_mul_i32 s34, s33, 40
  s_add_u32 s34, s34, 16
  v_lshl_add_u32 v14, v6, 2, s34
  v_lshrrev_b32 v15, 5, v7
  v_mul_u32_u24 v15, 40, v15
  v_lshrrev_b32 v16, 4, v14
  v_add_u32 v15, v15, v16
  v_lshlrev_b32 v15, 6, v15
  v_bfe_u32 v16, v14, 3, 1
  v_lshl_add_u32 v15, v16, 5, v15
  v_and_b32 v16, 31, v7
  v_add_u32 v15, v15, v16
  v_lshlrev_b32 v15, 4, v15
  v_and_b32 v16, 7, v14
  v_lshl_add_u32 v15, v16, 1, v15
  v_add_u32 v105, 10485760, v15
  s_mul_i32 s34, s33, 40
  s_add_u32 s34, s34, 32
  v_lshl_add_u32 v14, v6, 2, s34
  v_lshrrev_b32 v15, 5, v7
  v_mul_u32_u24 v15, 40, v15
  v_lshrrev_b32 v16, 4, v14
  v_add_u32 v15, v15, v16
  v_lshlrev_b32 v15, 6, v15
  v_bfe_u32 v16, v14, 3, 1
  v_lshl_add_u32 v15, v16, 5, v15
  v_and_b32 v16, 31, v7
  v_add_u32 v15, v15, v16
  v_lshlrev_b32 v15, 4, v15
  v_and_b32 v16, 7, v14
  v_lshl_add_u32 v15, v16, 1, v15
  v_add_u32 v106, 10485760, v15
  v_lshlrev_b32 v15, 7, v7
  s_lshl_b32 s34, s33, 3
  s_add_u32 s34, s34, 26730496
  v_add_u32 v107, s34, v15
  s_barrier
  s_mov_b32 s52, 0
L_xh_81:
  v_mov_b32 v68, 0
  v_mov_b32 v69, 0
  v_mov_b32 v70, 0
  v_mov_b32 v71, 0
  v_mov_b32 v72, 0
  v_mov_b32 v73, 0
  v_mov_b32 v74, 0
  v_mov_b32 v75, 0
  v_mov_b32 v76, 0
  v_mov_b32 v77, 0
  v_mov_b32 v78, 0
  v_mov_b32 v79, 0
  s_barrier
  ds_read_b128 v[20:23], v80 offset:0
  ds_read_b128 v[24:27], v80 offset:1024
  ds_read_b128 v[28:31], v84 offset:0
  ds_read_b128 v[32:35], v80 offset:2560
  ds_read_b128 v[36:39], v80 offset:3584
  ds_read_b128 v[40:43], v84 offset:2560
  s_waitcnt lgkmcnt(3)
  s_barrier
  s_waitcnt vmcnt(19)
  v_mfma_f32_16x16x32_bf16 v[68:71], v[20:23], v[148:151], v[68:71]
  ds_read_b128 v[44:47], v80 offset:5120
  v_mfma_f32_16x16x32_bf16 v[72:75], v[24:27], v[148:151], v[72:75]
  ds_read_b128 v[48:51], v80 offset:6144
  v_mfma_f32_16x16x32_bf16 v[76:79], v[28:31], v[148:151], v[76:79]
  ds_read_b128 v[52:55], v84 offset:5120
  s_waitcnt lgkmcnt(3)
  s_waitcnt vmcnt(18)
  v_mfma_f32_16x16x32_bf16 v[68:71], v[32:35], v[152:155], v[68:71]
  ds_read_b128 v[56:59], v80 offset:7680
  v_mfma_f32_16x16x32_bf16 v[72:75], v[36:39], v[152:155], v[72:75]
  ds_read_b128 v[60:63], v80 offset:8704
  v_mfma_f32_16x16x32_bf16 v[76:79], v[40:43], v[152:155], v[76:79]
  ds_read_b128 v[64:67], v84 offset:7680
  s_waitcnt lgkmcnt(3)
  s_barrier
  s_waitcnt vmcnt(17)
  v_mfma_f32_16x16x32_bf16 v[68:71], v[44:47], v[156:159], v[68:71]
  ds_read_b128 v[20:23], v80 offset:10240
  v_mfma_f32_16x16x32_bf16 v[72:75], v[48:51], v[156:159], v[72:75]
  ds_read_b128 v[24:27], v80 offset:11264
  v_mfma_f32_16x16x32_bf16 v[76:79], v[52:55], v[156:159], v[76:79]
  ds_read_b128 v[28:31], v84 offset:10240
  s_waitcnt lgkmcnt(3)
  s_waitcnt vmcnt(16)
  v_mfma_f32_16x16x32_bf16 v[68:71], v[56:59], v[160:163], v[68:71]
  ds_read_b128 v[32:35], v80 offset:12800
  v_mfma_f32_16x16x32_bf16 v[72:75], v[60:63], v[160:163], v[72:75]
  ds_read_b128 v[36:39], v80 offset:13824
  v_mfma_f32_16x16x32_bf16 v[76:79], v[64:67], v[160:163], v[76:79]
  ds_read_b128 v[40:43], v84 offset:12800
  s_waitcnt lgkmcnt(3)
  s_barrier
  s_waitcnt vmcnt(15)
  v_mfma_f32_16x16x32_bf16 v[68:71], v[20:23], v[164:167], v[68:71]
  ds_read_b128 v[44:47], v80 offset:15360
  v_mfma_f32_16x16x32_bf16 v[72:75], v[24:27], v[164:167], v[72:75]
  ds_read_b128 v[48:51], v80 offset:16384
  v_mfma_f32_16x16x32_bf16 v[76:79], v[28:31], v[164:167], v[76:79]
  ds_read_b128 v[52:55], v84 offset:15360
  s_waitcnt lgkmcnt(3)
  s_waitcnt vmcnt(14)
  v_mfma_f32_16x16x32_bf16 v[68:71], v[32:35], v[168:171], v[68:71]
  ds_read_b128 v[56:59], v80 offset:17920
  v_mfma_f32_16x16x32_bf16 v[72:75], v[36:39], v[168:171], v[72:75]
  ds_read_b128 v[60:63], v80 offset:18944
  v_mfma_f32_16x16x32_bf16 v[76:79], v[40:43], v[168:171], v[76:79]
  ds_read_b128 v[64:67], v84 offset:17920
  s_waitcnt lgkmcnt(3)
  s_barrier
  s_waitcnt vmcnt(13)
  v_mfma_f32_16x16x32_bf16 v[68:71], v[44:47], v[172:175], v[68:71]
  ds_read_b128 v[20:23], v80 offset:20480
  v_mfma_f32_16x16x32_bf16 v[72:75], v[48:51], v[172:175], v[72:75]
  ds_read_b128 v[24:27], v80 offset:21504
  v_mfma_f32_16x16x32_bf16 v[76:79], v[52:55], v[172:175], v[76:79]
  ds_read_b128 v[28:31], v84 offset:20480
  s_waitcnt lgkmcnt(3)
  s_waitcnt vmcnt(12)
  v_mfma_f32_16x16x32_bf16 v[68:71], v[56:59], v[176:179], v[68:71]
  ds_read_b128 v[32:35], v80 offset:23040
  v_mfma_f32_16x16x32_bf16 v[72:75], v[60:63], v[176:179], v[72:75]
  ds_read_b128 v[36:39], v80 offset:24064
  v_mfma_f32_16x16x32_bf16 v[76:79], v[64:67], v[176:179], v[76:79]
  ds_read_b128 v[40:43], v84 offset:23040
  s_waitcnt lgkmcnt(3)
  s_barrier
  s_waitcnt vmcnt(11)
  v_mfma_f32_16x16x32_bf16 v[68:71], v[20:23], v[180:183], v[68:71]
  ds_read_b128 v[44:47], v80 offset:25600
  v_mfma_f32_16x16x32_bf16 v[72:75], v[24:27], v[180:183], v[72:75]
  ds_read_b128 v[48:51], v80 offset:26624
  v_mfma_f32_16x16x32_bf16 v[76:79], v[28:31], v[180:183], v[76:79]
  ds_read_b128 v[52:55], v84 offset:25600
  s_waitcnt lgkmcnt(3)
  s_waitcnt vmcnt(10)
  v_mfma_f32_16x16x32_bf16 v[68:71], v[32:35], v[184:187], v[68:71]
  ds_read_b128 v[56:59], v80 offset:28160
  v_mfma_f32_16x16x32_bf16 v[72:75], v[36:39], v[184:187], v[72:75]
  ds_read_b128 v[60:63], v80 offset:29184
  v_mfma_f32_16x16x32_bf16 v[76:79], v[40:43], v[184:187], v[76:79]
  ds_read_b128 v[64:67], v84 offset:28160
  s_waitcnt lgkmcnt(3)
  s_barrier
  s_waitcnt vmcnt(9)
  v_mfma_f32_16x16x32_bf16 v[68:71], v[44:47], v[188:191], v[68:71]
  ds_read_b128 v[20:23], v80 offset:30720
  v_mfma_f32_16x16x32_bf16 v[72:75], v[48:51], v[188:191], v[72:75]
  ds_read_b128 v[24:27], v80 offset:31744
  v_mfma_f32_16x16x32_bf16 v[76:79], v[52:55], v[188:191], v[76:79]
  ds_read_b128 v[28:31], v84 offset:30720
  s_waitcnt lgkmcnt(3)
  s_waitcnt vmcnt(8)
  v_mfma_f32_16x16x32_bf16 v[68:71], v[56:59], v[192:195], v[68:71]
  ds_read_b128 v[32:35], v80 offset:33280
  v_mfma_f32_16x16x32_bf16 v[72:75], v[60:63], v[192:195], v[72:75]
  ds_read_b128 v[36:39], v80 offset:34304
  v_mfma_f32_16x16x32_bf16 v[76:79], v[64:67], v[192:195], v[76:79]
  ds_read_b128 v[40:43], v84 offset:33280
  s_waitcnt lgkmcnt(3)
  s_barrier
  s_waitcnt vmcnt(7)
  v_mfma_f32_16x16x32_bf16 v[68:71], v[20:23], v[196:199], v[68:71]
  ds_read_b128 v[44:47], v80 offset:35840
  v_mfma_f32_16x16x32_bf16 v[72:75], v[24:27], v[196:199], v[72:75]
  ds_read_b128 v[48:51], v80 offset:36864
  v_mfma_f32_16x16x32_bf16 v[76:79], v[28:31], v[196:199], v[76:79]
  ds_read_b128 v[52:55], v84 offset:35840
  s_waitcnt lgkmcnt(3)
  s_waitcnt vmcnt(6)
  v_mfma_f32_16x16x32_bf16 v[68:71], v[32:35], v[200:203], v[68:71]
  ds_read_b128 v[56:59], v80 offset:38400
  v_mfma_f32_16x16x32_bf16 v[72:75], v[36:39], v[200:203], v[72:75]
  ds_read_b128 v[60:63], v80 offset:39424
  v_mfma_f32_16x16x32_bf16 v[76:79], v[40:43], v[200:203], v[76:79]
  ds_read_b128 v[64:67], v84 offset:38400
  s_waitcnt lgkmcnt(3)
  s_barrier
  s_waitcnt vmcnt(5)
  v_mfma_f32_16x16x32_bf16 v[68:71], v[44:47], v[204:207], v[68:71]
  ds_read_b128 v[20:23], v80 offset:40960
  v_mfma_f32_16x16x32_bf16 v[72:75], v[48:51], v[204:207], v[72:75]
  ds_read_b128 v[24:27], v80 offset:41984
  v_mfma_f32_16x16x32_bf16 v[76:79], v[52:55], v[204:207], v[76:79]
  ds_read_b128 v[28:31], v84 offset:40960
  s_waitcnt lgkmcnt(3)
  s_waitcnt vmcnt(4)
  v_mfma_f32_16x16x32_bf16 v[68:71], v[56:59], v[208:211], v[68:71]
  ds_read_b128 v[32:35], v80 offset:43520
  v_mfma_f32_16x16x32_bf16 v[72:75], v[60:63], v[208:211], v[72:75]
  ds_read_b128 v[36:39], v80 offset:44544
  v_mfma_f32_16x16x32_bf16 v[76:79], v[64:67], v[208:211], v[76:79]
  ds_read_b128 v[40:43], v84 offset:43520
  s_waitcnt lgkmcnt(3)
  s_barrier
  s_waitcnt vmcnt(3)
  v_mfma_f32_16x16x32_bf16 v[68:71], v[20:23], v[212:215], v[68:71]
  ds_read_b128 v[44:47], v80 offset:46080
  v_mfma_f32_16x16x32_bf16 v[72:75], v[24:27], v[212:215], v[72:75]
  ds_read_b128 v[48:51], v80 offset:47104
  v_mfma_f32_16x16x32_bf16 v[76:79], v[28:31], v[212:215], v[76:79]
  ds_read_b128 v[52:55], v84 offset:46080
  s_waitcnt lgkmcnt(3)
  s_waitcnt vmcnt(2)
  v_mfma_f32_16x16x32_bf16 v[68:71], v[32:35], v[216:219], v[68:71]
  ds_read_b128 v[56:59], v80 offset:48640
  v_mfma_f32_16x16x32_bf16 v[72:75], v[36:39], v[216:219], v[72:75]
  ds_read_b128 v[60:63], v80 offset:49664
  v_mfma_f32_16x16x32_bf16 v[76:79], v[40:43], v[216:219], v[76:79]
  ds_read_b128 v[64:67], v84 offset:48640
  s_waitcnt lgkmcnt(3)
  s_waitcnt vmcnt(1)
  v_mfma_f32_16x16x32_bf16 v[68:71], v[44:47], v[220:223], v[68:71]
  v_mfma_f32_16x16x32_bf16 v[72:75], v[48:51], v[220:223], v[72:75]
  v_mfma_f32_16x16x32_bf16 v[76:79], v[52:55], v[220:223], v[76:79]
  s_waitcnt lgkmcnt(0)
  s_waitcnt vmcnt(0)
  v_mfma_f32_16x16x32_bf16 v[68:71], v[56:59], v[224:227], v[68:71]
  v_mfma_f32_16x16x32_bf16 v[72:75], v[60:63], v[224:227], v[72:75]
  v_mfma_f32_16x16x32_bf16 v[76:79], v[64:67], v[224:227], v[76:79]
  v_mov_b32 v6, 0
  v_mov_b32 v7, 0
  v_lshlrev_b32 v20, 16, v8
  v_and_b32 v21, 0xffff0000, v8
  v_lshlrev_b32 v22, 16, v9
  v_and_b32 v23, 0xffff0000, v9
  v_add_f32 v20, v20, v68
  v_add_f32 v21, v21, v69
  v_add_f32 v22, v22, v70
  v_add_f32 v23, v23, v71
  v_cvt_pk_bf16_f32 v24, v20, v21
  v_cvt_pk_bf16_f32 v25, v22, v23
  buffer_store_dwordx2 v[24:25], v88, s[24:27], 0 offen sc1
  v_add_f32 v6, v6, v20
  v_fmac_f32 v7, v20, v20
  v_add_f32 v6, v6, v21
  v_fmac_f32 v7, v21, v21
  v_add_f32 v6, v6, v22
  v_fmac_f32 v7, v22, v22
  v_add_f32 v6, v6, v23
  v_fmac_f32 v7, v23, v23
  v_lshlrev_b32 v28, 16, v10
  v_and_b32 v29, 0xffff0000, v10
  v_lshlrev_b32 v30, 16, v11
  v_and_b32 v31, 0xffff0000, v11
  v_add_f32 v28, v28, v72
  v_add_f32 v29, v29, v73
  v_add_f32 v30, v30, v74
  v_add_f32 v31, v31, v75
  v_cvt_pk_bf16_f32 v32, v28, v29
  v_cvt_pk_bf16_f32 v33, v30, v31
  buffer_store_dwordx2 v[32:33], v89, s[24:27], 0 offen sc1
  v_add_f32 v6, v6, v28
  v_fmac_f32 v7, v28, v28
  v_add_f32 v6, v6, v29
  v_fmac_f32 v7, v29, v29
  v_add_f32 v6, v6, v30
  v_fmac_f32 v7, v30, v30
  v_add_f32 v6, v6, v31
  v_fmac_f32 v7, v31, v31
  v_lshlrev_b32 v36, 16, v12
  v_and_b32 v37, 0xffff0000, v12
  v_lshlrev_b32 v38, 16, v13
  v_and_b32 v39, 0xffff0000, v13
  v_add_f32 v36, v36, v76
  v_add_f32 v37, v37, v77
  v_add_f32 v38, v38, v78
  v_add_f32 v39, v39, v79
  v_cvt_pk_bf16_f32 v40, v36, v37
  v_cvt_pk_bf16_f32 v41, v38, v39
  s_mov_b32 exec_lo, -1
  s_mov_b32 exec_hi, 0
  buffer_store_dwordx2 v[40:41], v90, s[24:27], 0 offen sc1
  v_add_f32 v6, v6, v36
  v_fmac_f32 v7, v36, v36
  v_add_f32 v6, v6, v37
  v_fmac_f32 v7, v37, v37
  v_add_f32 v6, v6, v38
  v_fmac_f32 v7, v38, v38
  v_add_f32 v6, v6, v39
  v_fmac_f32 v7, v39, v39
  s_mov_b64 exec, -1
  v_mov_b32 v5, v6
  s_nop 1
  v_permlane32_swap_b32 v6, v5
  v_add_f32 v6, v6, v5
  v_mov_b32 v5, v6
  s_nop 1
  v_permlane16_swap_b32 v6, v5
  v_add_f32 v6, v6, v5
  v_mov_b32 v5, v7
  s_nop 1
  v_permlane32_swap_b32 v7, v5
  v_add_f32 v7, v7, v5
  v_mov_b32 v5, v7
  s_nop 1
  v_permlane16_swap_b32 v7, v5
  v_add_f32 v7, v7, v5
  s_mov_b64 exec, 0xffff
  buffer_store_dwordx2 v[6:7], v91, s[24:27], 0 offen sc1
  s_mov_b64 exec, -1
  s_barrier
  s_cmp_lg_u32 s52, 0
  s_cbranch_scc1 L_xh1_82
  s_lshl_b32 s58, s32, 2
  s_add_u32 s58, s58, s3
  s_add_u32 s58, s58, 64
  s_mul_i32 s58, s58, 20480
  s_add_u32 s58, s58, 7864320
  buffer_load_dwordx2 v[96:97], v102, s[60:63], 0 offen offset:0
  buffer_load_dwordx2 v[98:99], v102, s[60:63], 0 offen offset:32
  buffer_load_dwordx2 v[100:101], v102, s[60:63], 0 offen offset:64
  buffer_load_dwordx4 v[148:151], v2, s[24:27], s58 offen offset:0 sc1
  buffer_load_dwordx4 v[152:155], v2, s[24:27], s58 offen offset:1024 sc1
  buffer_load_dwordx4 v[156:159], v2, s[24:27], s58 offen offset:2048 sc1
  buffer_load_dwordx4 v[160:163], v2, s[24:27], s58 offen offset:3072 sc1
  s_add_u32 s58, s58, 4096
  buffer_load_dwordx4 v[164:167], v2, s[24:27], s58 offen offset:0 sc1
  buffer_load_dwordx4 v[168:171], v2, s[24:27], s58 offen offset:1024 sc1
  buffer_load_dwordx4 v[172:175], v2, s[24:27], s58 offen offset:2048 sc1
  buffer_load_dwordx4 v[176:179], v2, s[24:27], s58 offen offset:3072 sc1
  s_add_u32 s58, s58, 4096
  buffer_load_dwordx4 v[180:183], v2, s[24:27], s58 offen offset:0 sc1
  buffer_load_dwordx4 v[184:187], v2, s[24:27], s58 offen offset:1024 sc1
  buffer_load_dwordx4 v[188:191], v2, s[24:27], s58 offen offset:2048 sc1
  buffer_load_dwordx4 v[192:195], v2, s[24:27], s58 offen offset:3072 sc1
  s_add_u32 s58, s58, 4096
  buffer_load_dwordx4 v[196:199], v2, s[24:27], s58 offen offset:0 sc1
  buffer_load_dwordx4 v[200:203], v2, s[24:27], s58 offen offset:1024 sc1
  buffer_load_dwordx4 v[204:207], v2, s[24:27], s58 offen offset:2048 sc1
  buffer_load_dwordx4 v[208:211], v2, s[24:27], s58 offen offset:3072 sc1
  s_add_u32 s58, s58, 4096
  buffer_load_dwordx4 v[212:215], v2, s[24:27], s58 offen offset:0 sc1
  buffer_load_dwordx4 v[216:219], v2, s[24:27], s58 offen offset:1024 sc1
  buffer_load_dwordx4 v[220:223], v2, s[24:27], s58 offen offset:2048 sc1
  buffer_load_dwordx4 v[224:227], v2, s[24:27], s58 offen offset:3072 sc1
  s_waitcnt vmcnt(23)
  s_branch L_xh2_83
L_xh1_82:
  s_and_b32 s70, s2, 7
  s_lshr_b32 s71, s2, 3
  s_lshr_b32 s72, s70, 2
  s_lshl_b32 s72, s72, 2
  s_lshr_b32 s73, s71, 3
  s_add_u32 s72, s72, s73
  s_and_b32 s70, s70, 3
  s_lshl_b32 s70, s70, 3
  s_and_b32 s71, s71, 7
  s_add_u32 s70, s70, s71
  s_lshl_b32 s73, s72, 2
  s_add_u32 s73, s73, s3
  v_and_b32 v14, 31, v1
  v_lshrrev_b32 v15, 5, v1
  s_min_u32 s71, s3, 2
  s_mul_i32 s70, s70, 3
  s_add_u32 s70, s70, s71
  s_mul_i32 s70, s70, 2560
  s_add_u32 s70, s70, 26435584
  v_mul_u32_u24 v16, 80, v14
  v_mul_u32_u24 v17, 40, v15
  v_add_u32 v16, v16, v17
  buffer_load_dwordx4 v[244:247], v16, s[24:27], s70 offen sc1
  buffer_load_dwordx4 v[248:251], v16, s[24:27], s70 offen offset:16 sc1
  buffer_load_dwordx2 v[252:253], v16, s[24:27], s70 offen offset:32 sc1
  v_lshlrev_b32 v16, 7, v14
  v_lshl_add_u32 v16, v15, 6, v16
  s_lshl_b32 s70, s73, 12
  s_add_u32 s70, s70, 26730496
  buffer_load_dwordx4 v[228:231], v16, s[24:27], s70 offen offset:0 sc1
  buffer_load_dwordx4 v[232:235], v16, s[24:27], s70 offen offset:16 sc1
  buffer_load_dwordx4 v[236:239], v16, s[24:27], s70 offen offset:32 sc1
  buffer_load_dwordx4 v[240:243], v16, s[24:27], s70 offen offset:48 sc1
  s_mul_i32 s58, s73, 40960
  s_add_u32 s58, s58, 10485760
  buffer_load_dwordx4 v[148:151], v2, s[24:27], s58 offen offset:0 sc1
  buffer_load_dwordx4 v[152:155], v2, s[24:27], s58 offen offset:1024 sc1
  buffer_load_dwordx4 v[156:159], v2, s[24:27], s58 offen offset:2048 sc1
  buffer_load_dwordx4 v[160:163], v2, s[24:27], s58 offen offset:3072 sc1
  s_add_u32 s58, s58, 4096
  buffer_load_dwordx4 v[164:167], v2, s[24:27], s58 offen offset:0 sc1
  buffer_load_dwordx4 v[168:171], v2, s[24:27], s58 offen offset:1024 sc1
  buffer_load_dwordx4 v[172:175], v2, s[24:27], s58 offen offset:2048 sc1
  buffer_load_dwordx4 v[176:179], v2, s[24:27], s58 offen offset:3072 sc1
  s_add_u32 s58, s58, 4096
  buffer_load_dwordx4 v[180:183], v2, s[24:27], s58 offen offset:0 sc1
  buffer_load_dwordx4 v[184:187], v2, s[24:27], s58 offen offset:1024 sc1
  buffer_load_dwordx4 v[188:191], v2, s[24:27], s58 offen offset:2048 sc1
  buffer_load_dwordx4 v[192:195], v2, s[24:27], s58 offen offset:3072 sc1
  s_add_u32 s58, s58, 4096
  buffer_load_dwordx4 v[196:199], v2, s[24:27], s58 offen offset:0 sc1
  buffer_load_dwordx4 v[200:203], v2, s[24:27], s58 offen offset:1024 sc1
  buffer_load_dwordx4 v[204:207], v2, s[24:27], s58 offen offset:2048 sc1
  buffer_load_dwordx4 v[208:211], v2, s[24:27], s58 offen offset:3072 sc1
  s_add_u32 s58, s58, 4096
  buffer_load_dwordx4 v[212:215], v2, s[24:27], s58 offen offset:0 sc1
  buffer_load_dwordx4 v[216:219], v2, s[24:27], s58 offen offset:1024 sc1
  buffer_load_dwordx4 v[220:223], v2, s[24:27], s58 offen offset:2048 sc1
  buffer_load_dwordx4 v[224:227], v2, s[24:27], s58 offen offset:3072 sc1
  s_waitcnt vmcnt(27)
L_xh2_83:
  s_barrier
  s_cmp_lg_u32 s3, 0
  s_cbranch_scc1 L_xnp_84
  s_lshr_b32 s34, s32, 1
  s_lshl_b32 s35, s52, 3
  s_add_u32 s34, s34, s35
  s_add_u32 s34, s34, 72
  s_lshl_b32 s90, s34, 8
  s_add_u32 s90, s90, 26681344
  v_mov_b32 v20, 1
  v_mov_b32 v21, 0
  s_mov_b64 exec, 1
  buffer_atomic_add v20, v21, s[24:27], s90 offen sc1
  s_mov_b64 exec, -1
L_xnp_84:
  s_add_u32 s52, s52, 1
  s_cmp_ge_u32 s52, 2
  s_cbranch_scc1 L_p3_done
  s_waitcnt vmcnt(20)
  v_mov_b32 v8, v96
  v_mov_b32 v9, v97
  v_mov_b32 v10, v98
  v_mov_b32 v11, v99
  v_mov_b32 v12, v100
  v_mov_b32 v13, v101
  v_mov_b32 v4, v102
  v_mov_b32 v88, v104
  v_mov_b32 v89, v105
  v_mov_b32 v90, v106
  v_mov_b32 v91, v107
  s_branch L_xh_81
L_p3_done:
  s_and_b32 s34, s2, 7
  s_lshr_b32 s35, s2, 3
  s_lshr_b32 s32, s34, 2
  s_lshl_b32 s32, s32, 2
  s_lshr_b32 s33, s35, 3
  s_add_u32 s32, s32, s33
  s_and_b32 s33, s34, 3
  s_lshl_b32 s33, s33, 3
  s_and_b32 s35, s35, 7
  s_add_u32 s33, s33, s35
  s_cmp_lt_u32 s3, 4
  s_cbranch_scc1 L_gc_85
  s_and_b32 s34, s3, 1
  s_cmp_ge_u32 s3, 6
  s_cbranch_scc1 L_gx_86
  s_mul_i32 s44, s34, 6144
  s_add_u32 s44, s44, 110592
  s_mul_i32 s40, s33, 122880
  s_add_u32 s40, s40, s44
  s_add_u32 s40, s40, 22183936
  s_mov_b32 m0, s44
  s_add_u32 s44, s44, 1024
  buffer_load_dwordx4 v2, s[24:27], s40 offen sc1 lds
  s_add_u32 s40, s40, 1024
  s_mov_b32 m0, s44
  s_add_u32 s44, s44, 1024
  buffer_load_dwordx4 v2, s[24:27], s40 offen sc1 lds
  s_add_u32 s40, s40, 1024
  s_mov_b32 m0, s44
  s_add_u32 s44, s44, 1024
  buffer_load_dwordx4 v2, s[24:27], s40 offen sc1 lds
  s_add_u32 s40, s40, 1024
  s_mov_b32 m0, s44
  s_add_u32 s44, s44, 1024
  buffer_load_dwordx4 v2, s[24:27], s40 offen sc1 lds
  s_add_u32 s40, s40, 1024
  s_mov_b32 m0, s44
  s_add_u32 s44, s44, 1024
  buffer_load_dwordx4 v2, s[24:27], s40 offen sc1 lds
  s_add_u32 s40, s40, 1024
  s_mov_b32 m0, s44
  s_add_u32 s44, s44, 1024
  buffer_load_dwordx4 v2, s[24:27], s40 offen sc1 lds
  s_add_u32 s40, s40, 1024
  s_barrier
  s_barrier
  s_waitcnt vmcnt(0)
  s_mov_b32 s38, 0
L_ob_87:
  s_barrier
  s_add_u32 s38, s38, 1
  s_cmp_lt_u32 s38, 7
  s_cbranch_scc1 L_ob_87
  s_branch L_p4_done
L_gx_86:
  s_cmp_lg_u32 s34, 0
  s_cbranch_scc1 L_gp7_88
  s_mov_b32 s38, 0
L_ob_89:
  s_barrier
  s_add_u32 s38, s38, 1
  s_cmp_lt_u32 s38, 2
  s_cbranch_scc1 L_ob_89
  s_add_u32 s45, s32, 80
  s_lshl_b32 s91, s45, 8
  s_add_u32 s91, s91, 26681344
  v_lshlrev_b32 v8, 8, v1
  s_mov_b32 s90, 0
  s_mov_b64 exec, 0x1
L_pc_90:
  buffer_load_dword v9, v8, s[24:27], s91 offen sc1
  s_waitcnt vmcnt(0)
  v_cmp_le_u32 vcc, 32, v9
  s_nop 2
  s_cmp_eq_u64 vcc, exec
  s_cbranch_scc1 L_pcd_91
  s_sleep 2
  s_add_u32 s90, s90, 1
  s_cmp_lt_u32 s90, 0x40000
  s_cbranch_scc1 L_pc_90
L_pcd_91:
  s_mov_b64 exec, -1
  s_mov_b32 s38, 0
L_ob_92:
  s_barrier
  s_add_u32 s38, s38, 1
  s_cmp_lt_u32 s38, 4
  s_cbranch_scc1 L_ob_92
  s_and_b32 s34, s2, 7
  s_lshr_b32 s34, s34, 1
  s_lshl_b32 s34, s34, 2
  s_lshr_b32 s35, s2, 6
  s_add_u32 s34, s34, s35
  s_lshr_b32 s45, s34, 1
  s_add_u32 s45, s45, 88
  s_lshl_b32 s91, s45, 8
  s_add_u32 s91, s91, 26681344
  v_lshlrev_b32 v8, 8, v1
  s_mov_b32 s90, 0
  s_mov_b64 exec, 0x1
L_pc_93:
  buffer_load_dword v9, v8, s[24:27], s91 offen sc1
  s_waitcnt vmcnt(0)
  v_cmp_le_u32 vcc, 32, v9
  s_nop 2
  s_cmp_eq_u64 vcc, exec
  s_cbranch_scc1 L_pcd_94
  s_sleep 2
  s_add_u32 s90, s90, 1
  s_cmp_lt_u32 s90, 0x40000
  s_cbranch_scc1 L_pc_93
L_pcd_94:
  s_mov_b64 exec, -1
  s_mov_b32 s38, 0
L_ob_95:
  s_barrier
  s_add_u32 s38, s38, 1
  s_cmp_lt_u32 s38, 3
  s_cbranch_scc1 L_ob_95
  s_branch L_p4_done
L_gp7_88:
  s_waitcnt vmcnt(0)
  s_barrier
  s_and_b32 s34, s2, 7
  s_lshr_b32 s35, s2, 3
  s_and_b32 s34, s34, 1
  s_lshl_b32 s34, s34, 3
  s_and_b32 s35, s35, 7
  s_add_u32 s34, s34, s35
  s_mul_i32 s40, s34, 122880
  s_add_u32 s40, s40, 20217856
  s_mov_b32 s44, 123904
  s_barrier
  s_barrier
  s_barrier
  s_mov_b32 s38, 0
L_dq_96:
  s_mov_b32 m0, s44
  s_add_u32 s44, s44, 1024
  buffer_load_dwordx4 v2, s[24:27], s40 offen sc1 lds
  s_add_u32 s40, s40, 1024
  s_mov_b32 m0, s44
  s_add_u32 s44, s44, 1024
  buffer_load_dwordx4 v2, s[24:27], s40 offen sc1 lds
  s_add_u32 s40, s40, 1024
  s_mov_b32 m0, s44
  s_add_u32 s44, s44, 1024
  buffer_load_dwordx4 v2, s[24:27], s40 offen sc1 lds
  s_add_u32 s40, s40, 1024
  s_mov_b32 m0, s44
  s_add_u32 s44, s44, 1024
  buffer_load_dwordx4 v2, s[24:27], s40 offen sc1 lds
  s_add_u32 s40, s40, 1024
  s_add_u32 s38, s38, 1
  s_cmp_lt_u32 s38, 8
  s_cbranch_scc1 L_dq_96
  s_mov_b32 m0, s44
  s_add_u32 s44, s44, 1024
  buffer_load_dwordx4 v2, s[24:27], s40 offen sc1 lds
  s_add_u32 s40, s40, 1024
  s_mov_b32 m0, s44
  s_add_u32 s44, s44, 1024
  buffer_load_dwordx4 v2, s[24:27], s40 offen sc1 lds
  s_add_u32 s40, s40, 1024
  s_mov_b32 m0, s44
  s_add_u32 s44, s44, 1024
  buffer_load_dwordx4 v2, s[24:27], s40 offen sc1 lds
  s_add_u32 s40, s40, 1024
  s_mov_b32 s38, 0
L_ob_97:
  s_barrier
  s_add_u32 s38, s38, 1
  s_cmp_lt_u32 s38, 4
  s_cbranch_scc1 L_ob_97
  s_waitcnt vmcnt(0)
  s_barrier
  s_branch L_p4_done
L_gc_85:
  v_lshrrev_b32 v3, 5, v1
  v_and_b32 v7, 31, v1
  v_mov_b32 v10, v2
  v_add_u32 v11, 61440, v2
  s_mov_b32 s36, s73
  s_barrier
  s_mov_b32 s52, 0
L_gh_98:
  s_lshl_b32 s34, s36, 1
  v_lshrrev_b32 v5, 4, v7
  v_add_u32 v5, s34, v5
  v_mul_u32_u24 v5, 49152, v5
  v_and_b32 v13, 15, v7
  v_lshl_add_u32 v5, v13, 4, v5
  v_lshl_add_u32 v5, v3, 3, v5
  v_add_u32 v8, 13107200, v5
  v_mov_b32 v64, 0
  v_mov_b32 v65, 0
  v_mov_b32 v66, 0
  v_mov_b32 v67, 0
  v_mov_b32 v68, 0
  v_mov_b32 v69, 0
  v_mov_b32 v70, 0
  v_mov_b32 v71, 0
  v_mov_b32 v72, 0
  v_mov_b32 v73, 0
  v_mov_b32 v74, 0
  v_mov_b32 v75, 0
  v_mov_b32 v76, 0
  v_mov_b32 v77, 0
  v_mov_b32 v78, 0
  v_mov_b32 v79, 0
  v_mov_b32 v80, 0
  v_mov_b32 v81, 0
  v_mov_b32 v82, 0
  v_mov_b32 v83, 0
  v_mov_b32 v84, 0
  v_mov_b32 v85, 0
  v_mov_b32 v86, 0
  v_mov_b32 v87, 0
  v_mov_b32 v88, 0
  v_mov_b32 v89, 0
  v_mov_b32 v90, 0
  v_mov_b32 v91, 0
  v_mov_b32 v92, 0
  v_mov_b32 v93, 0
  v_mov_b32 v94, 0
  v_mov_b32 v95, 0
  v_mov_b32 v96, 0
  v_mov_b32 v97, 0
  v_mov_b32 v98, 0
  v_mov_b32 v99, 0
  v_mov_b32 v100, 0
  v_mov_b32 v101, 0
  v_mov_b32 v102, 0
  v_mov_b32 v103, 0
  v_mov_b32 v104, 0
  v_mov_b32 v105, 0
  v_mov_b32 v106, 0
  v_mov_b32 v107, 0
  v_mov_b32 v108, 0
  v_mov_b32 v109, 0
  v_mov_b32 v110, 0
  v_mov_b32 v111, 0
  ds_read_b128 v[112:115], v10 offset:0
  ds_read_b128 v[116:119], v10 offset:1024
  ds_read_b128 v[120:123], v10 offset:2048
  ds_read_b128 v[124:127], v10 offset:3072
  ds_read_b128 v[128:131], v10 offset:4096
  ds_read_b128 v[132:135], v10 offset:5120
  s_waitcnt lgkmcnt(3)
  s_waitcnt vmcnt(19)
  v_mfma_f32_32x32x16_bf16 v[64:79], v[112:115], v[148:151], v[64:79]
  ds_read_b128 v[136:139], v10 offset:6144
  v_mfma_f32_32x32x16_bf16 v[80:95], v[116:119], v[148:151], v[80:95]
  ds_read_b128 v[140:143], v10 offset:7168
  v_mfma_f32_32x32x16_bf16 v[96:111], v[120:123], v[148:151], v[96:111]
  ds_read_b128 v[144:147], v10 offset:8192
  s_add_u32 s58, s58, 4096
  buffer_load_dwordx4 v[148:151], v2, s[24:27], s58 offen offset:0 sc1
  s_waitcnt lgkmcnt(3)
  s_waitcnt vmcnt(19)
  v_mfma_f32_32x32x16_bf16 v[64:79], v[124:127], v[152:155], v[64:79]
  ds_read_b128 v[112:115], v10 offset:9216
  v_mfma_f32_32x32x16_bf16 v[80:95], v[128:131], v[152:155], v[80:95]
  ds_read_b128 v[116:119], v10 offset:10240
  v_mfma_f32_32x32x16_bf16 v[96:111], v[132:135], v[152:155], v[96:111]
  ds_read_b128 v[120:123], v10 offset:11264
  buffer_load_dwordx4 v[152:155], v2, s[24:27], s58 offen offset:1024 sc1
  s_waitcnt lgkmcnt(3)
  s_waitcnt vmcnt(19)
  v_mfma_f32_32x32x16_bf16 v[64:79], v[136:139], v[156:159], v[64:79]
  ds_read_b128 v[124:127], v10 offset:12288
  v_mfma_f32_32x32x16_bf16 v[80:95], v[140:143], v[156:159], v[80:95]
  ds_read_b128 v[128:131], v10 offset:13312
  v_mfma_f32_32x32x16_bf16 v[96:111], v[144:147], v[156:159], v[96:111]
  ds_read_b128 v[132:135], v10 offset:14336
  buffer_load_dwordx4 v[156:159], v2, s[24:27], s58 offen offset:2048 sc1
  s_waitcnt lgkmcnt(3)
  s_waitcnt vmcnt(19)
  v_mfma_f32_32x32x16_bf16 v[64:79], v[112:115], v[160:163], v[64:79]
  ds_read_b128 v[136:139], v10 offset:15360
  v_mfma_f32_32x32x16_bf16 v[80:95], v[116:119], v[160:163], v[80:95]
  ds_read_b128 v[140:143], v10 offset:16384
  v_mfma_f32_32x32x16_bf16 v[96:111], v[120:123], v[160:163], v[96:111]
  ds_read_b128 v[144:147], v10 offset:17408
  buffer_load_dwordx4 v[160:163], v2, s[24:27], s58 offen offset:3072 sc1
  s_waitcnt lgkmcnt(3)
  s_waitcnt vmcnt(19)
  v_mfma_f32_32x32x16_bf16 v[64:79], v[124:127], v[164:167], v[64:79]
  ds_read_b128 v[112:115], v10 offset:18432
  v_mfma_f32_32x32x16_bf16 v[80:95], v[128:131], v[164:167], v[80:95]
  ds_read_b128 v[116:119], v10 offset:19456
  v_mfma_f32_32x32x16_bf16 v[96:111], v[132:135], v[164:167], v[96:111]
  ds_read_b128 v[120:123], v10 offset:20480
  s_add_u32 s58, s58, 4096
  buffer_load_dwordx4 v[164:167], v2, s[24:27], s58 offen offset:0 sc1
  s_waitcnt lgkmcnt(3)
  s_waitcnt vmcnt(19)
  v_mfma_f32_32x32x16_bf16 v[64:79], v[136:139], v[168:171], v[64:79]
  ds_read_b128 v[124:127], v10 offset:21504
  v_mfma_f32_32x32x16_bf16 v[80:95], v[140:143], v[168:171], v[80:95]
  ds_read_b128 v[128:131], v10 offset:22528
  v_mfma_f32_32x32x16_bf16 v[96:111], v[144:147], v[168:171], v[96:111]
  ds_read_b128 v[132:135], v10 offset:23552
  buffer_load_dwordx4 v[168:171], v2, s[24:27], s58 offen offset:1024 sc1
  s_waitcnt lgkmcnt(3)
  s_waitcnt vmcnt(19)
  v_mfma_f32_32x32x16_bf16 v[64:79], v[112:115], v[172:175], v[64:79]
  ds_read_b128 v[136:139], v10 offset:24576
  v_mfma_f32_32x32x16_bf16 v[80:95], v[116:119], v[172:175], v[80:95]
  ds_read_b128 v[140:143], v10 offset:25600
  v_mfma_f32_32x32x16_bf16 v[96:111], v[120:123], v[172:175], v[96:111]
  ds_read_b128 v[144:147], v10 offset:26624
  buffer_load_dwordx4 v[172:175], v2, s[24:27], s58 offen offset:2048 sc1
  s_waitcnt lgkmcnt(3)
  s_waitcnt vmcnt(19)
  v_mfma_f32_32x32x16_bf16 v[64:79], v[124:127], v[176:179], v[64:79]
  ds_read_b128 v[112:115], v10 offset:27648
  v_mfma_f32_32x32x16_bf16 v[80:95], v[128:131], v[176:179], v[80:95]
  ds_read_b128 v[116:119], v10 offset:28672
  v_mfma_f32_32x32x16_bf16 v[96:111], v[132:135], v[176:179], v[96:111]
  ds_read_b128 v[120:123], v10 offset:29696
  buffer_load_dwordx4 v[176:179], v2, s[24:27], s58 offen offset:3072 sc1
  s_waitcnt lgkmcnt(3)
  s_waitcnt vmcnt(19)
  v_mfma_f32_32x32x16_bf16 v[64:79], v[136:139], v[180:183], v[64:79]
  ds_read_b128 v[124:127], v10 offset:30720
  v_mfma_f32_32x32x16_bf16 v[80:95], v[140:143], v[180:183], v[80:95]
  ds_read_b128 v[128:131], v10 offset:31744
  v_mfma_f32_32x32x16_bf16 v[96:111], v[144:147], v[180:183], v[96:111]
  ds_read_b128 v[132:135], v10 offset:32768
  s_add_u32 s58, s58, 4096
  buffer_load_dwordx4 v[180:183], v2, s[24:27], s58 offen offset:0 sc1
  s_waitcnt lgkmcnt(3)
  s_waitcnt vmcnt(19)
  v_mfma_f32_32x32x16_bf16 v[64:79], v[112:115], v[184:187], v[64:79]
  ds_read_b128 v[136:139], v10 offset:33792
  v_mfma_f32_32x32x16_bf16 v[80:95], v[116:119], v[184:187], v[80:95]
  ds_read_b128 v[140:143], v10 offset:34816
  v_mfma_f32_32x32x16_bf16 v[96:111], v[120:123], v[184:187], v[96:111]
  ds_read_b128 v[144:147], v10 offset:35840
  buffer_load_dwordx4 v[184:187], v2, s[24:27], s58 offen offset:1024 sc1
  s_waitcnt lgkmcnt(3)
  s_waitcnt vmcnt(19)
  v_mfma_f32_32x32x16_bf16 v[64:79], v[124:127], v[188:191], v[64:79]
  ds_read_b128 v[112:115], v10 offset:36864
  v_mfma_f32_32x32x16_bf16 v[80:95], v[128:131], v[188:191], v[80:95]
  ds_read_b128 v[116:119], v10 offset:37888
  v_mfma_f32_32x32x16_bf16 v[96:111], v[132:135], v[188:191], v[96:111]
  ds_read_b128 v[120:123], v10 offset:38912
  buffer_load_dwordx4 v[188:191], v2, s[24:27], s58 offen offset:2048 sc1
  s_waitcnt lgkmcnt(3)
  s_waitcnt vmcnt(19)
  v_mfma_f32_32x32x16_bf16 v[64:79], v[136:139], v[192:195], v[64:79]
  ds_read_b128 v[124:127], v10 offset:39936
  v_mfma_f32_32x32x16_bf16 v[80:95], v[140:143], v[192:195], v[80:95]
  ds_read_b128 v[128:131], v10 offset:40960
  v_mfma_f32_32x32x16_bf16 v[96:111], v[144:147], v[192:195], v[96:111]
  ds_read_b128 v[132:135], v10 offset:41984
  buffer_load_dwordx4 v[192:195], v2, s[24:27], s58 offen offset:3072 sc1
  s_waitcnt lgkmcnt(3)
  s_waitcnt vmcnt(19)
  v_mfma_f32_32x32x16_bf16 v[64:79], v[112:115], v[196:199], v[64:79]
  ds_read_b128 v[136:139], v10 offset:43008
  v_mfma_f32_32x32x16_bf16 v[80:95], v[116:119], v[196:199], v[80:95]
  ds_read_b128 v[140:143], v10 offset:44032
  v_mfma_f32_32x32x16_bf16 v[96:111], v[120:123], v[196:199], v[96:111]
  ds_read_b128 v[144:147], v10 offset:45056
  s_add_u32 s58, s58, 4096
  buffer_load_dwordx4 v[196:199], v2, s[24:27], s58 offen offset:0 sc1
  s_waitcnt lgkmcnt(3)
  s_waitcnt vmcnt(19)
  v_mfma_f32_32x32x16_bf16 v[64:79], v[124:127], v[200:203], v[64:79]
  ds_read_b128 v[112:115], v10 offset:46080
  v_mfma_f32_32x32x16_bf16 v[80:95], v[128:131], v[200:203], v[80:95]
  ds_read_b128 v[116:119], v10 offset:47104
  v_mfma_f32_32x32x16_bf16 v[96:111], v[132:135], v[200:203], v[96:111]
  ds_read_b128 v[120:123], v10 offset:48128
  buffer_load_dwordx4 v[200:203], v2, s[24:27], s58 offen offset:1024 sc1
  s_waitcnt lgkmcnt(3)
  s_waitcnt vmcnt(19)
  v_mfma_f32_32x32x16_bf16 v[64:79], v[136:139], v[204:207], v[64:79]
  ds_read_b128 v[124:127], v10 offset:49152
  v_mfma_f32_32x32x16_bf16 v[80:95], v[140:143], v[204:207], v[80:95]
  ds_read_b128 v[128:131], v10 offset:50176
  v_mfma_f32_32x32x16_bf16 v[96:111], v[144:147], v[204:207], v[96:111]
  ds_read_b128 v[132:135], v10 offset:51200
  buffer_load_dwordx4 v[204:207], v2, s[24:27], s58 offen offset:2048 sc1
  s_waitcnt lgkmcnt(3)
  s_waitcnt vmcnt(19)
  v_mfma_f32_32x32x16_bf16 v[64:79], v[112:115], v[208:211], v[64:79]
  ds_read_b128 v[136:139], v10 offset:52224
  v_mfma_f32_32x32x16_bf16 v[80:95], v[116:119], v[208:211], v[80:95]
  ds_read_b128 v[140:143], v10 offset:53248
  v_mfma_f32_32x32x16_bf16 v[96:111], v[120:123], v[208:211], v[96:111]
  ds_read_b128 v[144:147], v10 offset:54272
  buffer_load_dwordx4 v[208:211], v2, s[24:27], s58 offen offset:3072 sc1
  s_waitcnt lgkmcnt(3)
  s_waitcnt vmcnt(19)
  v_mfma_f32_32x32x16_bf16 v[64:79], v[124:127], v[212:215], v[64:79]
  ds_read_b128 v[112:115], v10 offset:55296
  v_mfma_f32_32x32x16_bf16 v[80:95], v[128:131], v[212:215], v[80:95]
  ds_read_b128 v[116:119], v10 offset:56320
  v_mfma_f32_32x32x16_bf16 v[96:111], v[132:135], v[212:215], v[96:111]
  ds_read_b128 v[120:123], v10 offset:57344
  s_add_u32 s58, s58, 4096
  buffer_load_dwordx4 v[212:215], v2, s[24:27], s58 offen offset:0 sc1
  s_waitcnt lgkmcnt(3)
  s_waitcnt vmcnt(19)
  v_mfma_f32_32x32x16_bf16 v[64:79], v[136:139], v[216:219], v[64:79]
  ds_read_b128 v[124:127], v10 offset:58368
  v_mfma_f32_32x32x16_bf16 v[80:95], v[140:143], v[216:219], v[80:95]
  ds_read_b128 v[128:131], v10 offset:59392
  v_mfma_f32_32x32x16_bf16 v[96:111], v[144:147], v[216:219], v[96:111]
  ds_read_b128 v[132:135], v10 offset:60416
  buffer_load_dwordx4 v[216:219], v2, s[24:27], s58 offen offset:1024 sc1
  s_waitcnt lgkmcnt(3)
  s_waitcnt vmcnt(19)
  v_mfma_f32_32x32x16_bf16 v[64:79], v[112:115], v[220:223], v[64:79]
  ds_read_b128 v[136:139], v11 offset:0
  v_mfma_f32_32x32x16_bf16 v[80:95], v[116:119], v[220:223], v[80:95]
  ds_read_b128 v[140:143], v11 offset:1024
  v_mfma_f32_32x32x16_bf16 v[96:111], v[120:123], v[220:223], v[96:111]
  ds_read_b128 v[144:147], v11 offset:2048
  buffer_load_dwordx4 v[220:223], v2, s[24:27], s58 offen offset:2048 sc1
  s_waitcnt lgkmcnt(3)
  s_waitcnt vmcnt(19)
  v_mfma_f32_32x32x16_bf16 v[64:79], v[124:127], v[224:227], v[64:79]
  ds_read_b128 v[112:115], v11 offset:3072
  v_mfma_f32_32x32x16_bf16 v[80:95], v[128:131], v[224:227], v[80:95]
  ds_read_b128 v[116:119], v11 offset:4096
  v_mfma_f32_32x32x16_bf16 v[96:111], v[132:135], v[224:227], v[96:111]
  ds_read_b128 v[120:123], v11 offset:5120
  buffer_load_dwordx4 v[224:227], v2, s[24:27], s58 offen offset:3072 sc1
  s_cmp_lg_u32 s52, 0
  s_cbranch_scc1 L_gmid_99
  s_cmp_ge_u32 s3, 3
  s_cbranch_scc1 L_gmid_99
  v_add_f32 v244, v244, v245
  v_add_f32 v244, v244, v246
  v_add_f32 v244, v244, v247
  v_add_f32 v244, v244, v248
  v_add_f32 v244, v244, v249
  v_add_f32 v244, v244, v250
  v_add_f32 v244, v244, v251
  v_add_f32 v244, v244, v252
  v_add_f32 v244, v244, v253
  v_mov_b32 v5, v244
  s_nop 1
  v_permlane32_swap_b32 v244, v5
  v_add_f32 v244, v244, v5
  s_lshl_b32 s34, s3, 7
  s_add_u32 s34, s34, 122880
  v_lshl_add_u32 v5, v7, 2, s34
  ds_write_b32 v5, v244
L_gmid_99:
  s_waitcnt lgkmcnt(0)
  s_barrier
  s_waitcnt lgkmcnt(3)
  s_waitcnt vmcnt(19)
  v_mfma_f32_32x32x16_bf16 v[64:79], v[136:139], v[148:151], v[64:79]
  ds_read_b128 v[124:127], v11 offset:6144
  v_mfma_f32_32x32x16_bf16 v[80:95], v[140:143], v[148:151], v[80:95]
  ds_read_b128 v[128:131], v11 offset:7168
  v_mfma_f32_32x32x16_bf16 v[96:111], v[144:147], v[148:151], v[96:111]
  ds_read_b128 v[132:135], v11 offset:8192
  s_waitcnt lgkmcnt(3)
  s_waitcnt vmcnt(18)
  v_mfma_f32_32x32x16_bf16 v[64:79], v[112:115], v[152:155], v[64:79]
  ds_read_b128 v[136:139], v11 offset:9216
  v_mfma_f32_32x32x16_bf16 v[80:95], v[116:119], v[152:155], v[80:95]
  ds_read_b128 v[140:143], v11 offset:10240
  v_mfma_f32_32x32x16_bf16 v[96:111], v[120:123], v[152:155], v[96:111]
  ds_read_b128 v[144:147], v11 offset:11264
  s_waitcnt lgkmcnt(3)
  s_waitcnt vmcnt(17)
  v_mfma_f32_32x32x16_bf16 v[64:79], v[124:127], v[156:159], v[64:79]
  ds_read_b128 v[112:115], v11 offset:12288
  v_mfma_f32_32x32x16_bf16 v[80:95], v[128:131], v[156:159], v[80:95]
  ds_read_b128 v[116:119], v11 offset:13312
  v_mfma_f32_32x32x16_bf16 v[96:111], v[132:135], v[156:159], v[96:111]
  ds_read_b128 v[120:123], v11 offset:14336
  s_waitcnt lgkmcnt(3)
  s_waitcnt vmcnt(16)
  v_mfma_f32_32x32x16_bf16 v[64:79], v[136:139], v[160:163], v[64:79]
  ds_read_b128 v[124:127], v11 offset:15360
  v_mfma_f32_32x32x16_bf16 v[80:95], v[140:143], v[160:163], v[80:95]
  ds_read_b128 v[128:131], v11 offset:16384
  v_mfma_f32_32x32x16_bf16 v[96:111], v[144:147], v[160:163], v[96:111]
  ds_read_b128 v[132:135], v11 offset:17408
  s_waitcnt lgkmcnt(3)
  s_waitcnt vmcnt(15)
  v_mfma_f32_32x32x16_bf16 v[64:79], v[112:115], v[164:167], v[64:79]
  ds_read_b128 v[136:139], v11 offset:18432
  v_mfma_f32_32x32x16_bf16 v[80:95], v[116:119], v[164:167], v[80:95]
  ds_read_b128 v[140:143], v11 offset:19456
  v_mfma_f32_32x32x16_bf16 v[96:111], v[120:123], v[164:167], v[96:111]
  ds_read_b128 v[144:147], v11 offset:20480
  s_waitcnt lgkmcnt(3)
  s_waitcnt vmcnt(14)
  v_mfma_f32_32x32x16_bf16 v[64:79], v[124:127], v[168:171], v[64:79]
  ds_read_b128 v[112:115], v11 offset:21504
  v_mfma_f32_32x32x16_bf16 v[80:95], v[128:131], v[168:171], v[80:95]
  ds_read_b128 v[116:119], v11 offset:22528
  v_mfma_f32_32x32x16_bf16 v[96:111], v[132:135], v[168:171], v[96:111]
  ds_read_b128 v[120:123], v11 offset:23552
  s_waitcnt lgkmcnt(3)
  s_waitcnt vmcnt(13)
  v_mfma_f32_32x32x16_bf16 v[64:79], v[136:139], v[172:175], v[64:79]
  ds_read_b128 v[124:127], v11 offset:24576
  v_mfma_f32_32x32x16_bf16 v[80:95], v[140:143], v[172:175], v[80:95]
  ds_read_b128 v[128:131], v11 offset:25600
  v_mfma_f32_32x32x16_bf16 v[96:111], v[144:147], v[172:175], v[96:111]
  ds_read_b128 v[132:135], v11 offset:26624
  s_waitcnt lgkmcnt(3)
  s_waitcnt vmcnt(12)
  v_mfma_f32_32x32x16_bf16 v[64:79], v[112:115], v[176:179], v[64:79]
  ds_read_b128 v[136:139], v11 offset:27648
  v_mfma_f32_32x32x16_bf16 v[80:95], v[116:119], v[176:179], v[80:95]
  ds_read_b128 v[140:143], v11 offset:28672
  v_mfma_f32_32x32x16_bf16 v[96:111], v[120:123], v[176:179], v[96:111]
  ds_read_b128 v[144:147], v11 offset:29696
  s_waitcnt lgkmcnt(3)
  s_waitcnt vmcnt(11)
  v_mfma_f32_32x32x16_bf16 v[64:79], v[124:127], v[180:183], v[64:79]
  ds_read_b128 v[112:115], v11 offset:30720
  v_mfma_f32_32x32x16_bf16 v[80:95], v[128:131], v[180:183], v[80:95]
  ds_read_b128 v[116:119], v11 offset:31744
  v_mfma_f32_32x32x16_bf16 v[96:111], v[132:135], v[180:183], v[96:111]
  ds_read_b128 v[120:123], v11 offset:32768
  s_waitcnt lgkmcnt(3)
  s_waitcnt vmcnt(10)
  v_mfma_f32_32x32x16_bf16 v[64:79], v[136:139], v[184:187], v[64:79]
  ds_read_b128 v[124:127], v11 offset:33792
  v_mfma_f32_32x32x16_bf16 v[80:95], v[140:143], v[184:187], v[80:95]
  ds_read_b128 v[128:131], v11 offset:34816
  v_mfma_f32_32x32x16_bf16 v[96:111], v[144:147], v[184:187], v[96:111]
  ds_read_b128 v[132:135], v11 offset:35840
  s_waitcnt lgkmcnt(3)
  s_waitcnt vmcnt(9)
  v_mfma_f32_32x32x16_bf16 v[64:79], v[112:115], v[188:191], v[64:79]
  ds_read_b128 v[136:139], v11 offset:36864
  v_mfma_f32_32x32x16_bf16 v[80:95], v[116:119], v[188:191], v[80:95]
  ds_read_b128 v[140:143], v11 offset:37888
  v_mfma_f32_32x32x16_bf16 v[96:111], v[120:123], v[188:191], v[96:111]
  ds_read_b128 v[144:147], v11 offset:38912
  s_waitcnt lgkmcnt(3)
  s_waitcnt vmcnt(8)
  v_mfma_f32_32x32x16_bf16 v[64:79], v[124:127], v[192:195], v[64:79]
  ds_read_b128 v[112:115], v11 offset:39936
  v_mfma_f32_32x32x16_bf16 v[80:95], v[128:131], v[192:195], v[80:95]
  ds_read_b128 v[116:119], v11 offset:40960
  v_mfma_f32_32x32x16_bf16 v[96:111], v[132:135], v[192:195], v[96:111]
  ds_read_b128 v[120:123], v11 offset:41984
  s_waitcnt lgkmcnt(3)
  s_waitcnt vmcnt(7)
  v_mfma_f32_32x32x16_bf16 v[64:79], v[136:139], v[196:199], v[64:79]
  ds_read_b128 v[124:127], v11 offset:43008
  v_mfma_f32_32x32x16_bf16 v[80:95], v[140:143], v[196:199], v[80:95]
  ds_read_b128 v[128:131], v11 offset:44032
  v_mfma_f32_32x32x16_bf16 v[96:111], v[144:147], v[196:199], v[96:111]
  ds_read_b128 v[132:135], v11 offset:45056
  s_waitcnt lgkmcnt(3)
  s_waitcnt vmcnt(0)
  v_add_f32 v228, v228, v230
  v_add_f32 v229, v229, v231
  v_add_f32 v228, v228, v232
  v_add_f32 v229, v229, v233
  v_add_f32 v228, v228, v234
  v_add_f32 v229, v229, v235
  v_add_f32 v228, v228, v236
  v_add_f32 v229, v229, v237
  v_add_f32 v228, v228, v238
  v_add_f32 v229, v229, v239
  v_add_f32 v228, v228, v240
  v_add_f32 v229, v229, v241
  v_add_f32 v228, v228, v242
  v_add_f32 v229, v229, v243
  v_mov_b32 v5, v228
  s_nop 1
  v_permlane32_swap_b32 v228, v5
  v_add_f32 v228, v228, v5
  v_mov_b32 v5, v229
  s_nop 1
  v_permlane32_swap_b32 v229, v5
  v_add_f32 v229, v229, v5
  v_mul_f32 v5, 0x3acccccd, v228
  v_mul_f32 v13, 0x3acccccd, v229
  v_fma_f32 v13, -v5, v5, v13
  v_max_f32 v13, 0, v13
  v_add_f32 v13, 0x3727c5ac, v13
  v_rsq_f32 v4, v13
  s_nop 0
  v_mul_f32 v6, v5, v4
  v_sub_f32 v6, 0, v6
  s_barrier
  s_cmp_lg_u32 s52, 0
  s_cbranch_scc1 L_grb_100
  s_lshl_b32 s58, s32, 2
  s_add_u32 s58, s58, s3
  s_add_u32 s58, s58, 32
  s_mov_b32 s36, s58
  s_mul_i32 s58, s58, 40960
  s_add_u32 s58, s58, 10485760
  v_lshlrev_b32 v5, 7, v7
  v_lshl_add_u32 v5, v3, 6, v5
  s_lshl_b32 s34, s36, 12
  s_add_u32 s34, s34, 26730496
  buffer_load_dwordx4 v[228:231], v5, s[24:27], s34 offen offset:0 sc1
  buffer_load_dwordx4 v[232:235], v5, s[24:27], s34 offen offset:16 sc1
  buffer_load_dwordx4 v[236:239], v5, s[24:27], s34 offen offset:32 sc1
  buffer_load_dwordx4 v[240:243], v5, s[24:27], s34 offen offset:48 sc1
  s_branch L_grb2_101
L_grb_100:
  s_and_b32 s34, s2, 7
  s_lshr_b32 s34, s34, 1
  s_lshl_b32 s34, s34, 2
  s_lshr_b32 s35, s2, 6
  s_add_u32 s34, s34, s35
  s_lshl_b32 s58, s34, 2
  s_add_u32 s58, s58, s3
  s_mul_i32 s58, s58, 49152
  s_add_u32 s58, s58, 13107200
L_grb2_101:
  v_mfma_f32_32x32x16_bf16 v[64:79], v[112:115], v[200:203], v[64:79]
  ds_read_b128 v[136:139], v11 offset:46080
  v_mfma_f32_32x32x16_bf16 v[80:95], v[116:119], v[200:203], v[80:95]
  ds_read_b128 v[140:143], v11 offset:47104
  v_mfma_f32_32x32x16_bf16 v[96:111], v[120:123], v[200:203], v[96:111]
  ds_read_b128 v[144:147], v11 offset:48128
  buffer_load_dwordx4 v[148:151], v2, s[24:27], s58 offen offset:0 sc1
  buffer_load_dwordx4 v[152:155], v2, s[24:27], s58 offen offset:1024 sc1
  buffer_load_dwordx4 v[156:159], v2, s[24:27], s58 offen offset:2048 sc1
  s_waitcnt lgkmcnt(3)
  s_barrier
  v_mfma_f32_32x32x16_bf16 v[64:79], v[124:127], v[204:207], v[64:79]
  ds_read_b128 v[112:115], v11 offset:49152
  v_mfma_f32_32x32x16_bf16 v[80:95], v[128:131], v[204:207], v[80:95]
  ds_read_b128 v[116:119], v11 offset:50176
  v_mfma_f32_32x32x16_bf16 v[96:111], v[132:135], v[204:207], v[96:111]
  ds_read_b128 v[120:123], v11 offset:51200
  buffer_load_dwordx4 v[160:163], v2, s[24:27], s58 offen offset:3072 sc1
  s_add_u32 s58, s58, 4096
  buffer_load_dwordx4 v[164:167], v2, s[24:27], s58 offen offset:0 sc1
  buffer_load_dwordx4 v[168:171], v2, s[24:27], s58 offen offset:1024 sc1
  s_waitcnt lgkmcnt(3)
  v_mfma_f32_32x32x16_bf16 v[64:79], v[136:139], v[208:211], v[64:79]
  ds_read_b128 v[124:127], v11 offset:52224
  v_mfma_f32_32x32x16_bf16 v[80:95], v[140:143], v[208:211], v[80:95]
  ds_read_b128 v[128:131], v11 offset:53248
  v_mfma_f32_32x32x16_bf16 v[96:111], v[144:147], v[208:211], v[96:111]
  ds_read_b128 v[132:135], v11 offset:54272
  buffer_load_dwordx4 v[172:175], v2, s[24:27], s58 offen offset:2048 sc1
  buffer_load_dwordx4 v[176:179], v2, s[24:27], s58 offen offset:3072 sc1
  s_add_u32 s58, s58, 4096
  buffer_load_dwordx4 v[180:183], v2, s[24:27], s58 offen offset:0 sc1
  s_waitcnt lgkmcnt(3)
  v_mfma_f32_32x32x16_bf16 v[64:79], v[112:115], v[212:215], v[64:79]
  ds_read_b128 v[136:139], v11 offset:55296
  v_mfma_f32_32x32x16_bf16 v[80:95], v[116:119], v[212:215], v[80:95]
  ds_read_b128 v[140:143], v11 offset:56320
  v_mfma_f32_32x32x16_bf16 v[96:111], v[120:123], v[212:215], v[96:111]
  ds_read_b128 v[144:147], v11 offset:57344
  buffer_load_dwordx4 v[184:187], v2, s[24:27], s58 offen offset:1024 sc1
  buffer_load_dwordx4 v[188:191], v2, s[24:27], s58 offen offset:2048 sc1
  buffer_load_dwordx4 v[192:195], v2, s[24:27], s58 offen offset:3072 sc1
  s_waitcnt lgkmcnt(3)
  v_mfma_f32_32x32x16_bf16 v[64:79], v[124:127], v[216:219], v[64:79]
  ds_read_b128 v[112:115], v11 offset:58368
  v_mfma_f32_32x32x16_bf16 v[80:95], v[128:131], v[216:219], v[80:95]
  ds_read_b128 v[116:119], v11 offset:59392
  v_mfma_f32_32x32x16_bf16 v[96:111], v[132:135], v[216:219], v[96:111]
  ds_read_b128 v[120:123], v11 offset:60416
  s_add_u32 s58, s58, 4096
  buffer_load_dwordx4 v[196:199], v2, s[24:27], s58 offen offset:0 sc1
  buffer_load_dwordx4 v[200:203], v2, s[24:27], s58 offen offset:1024 sc1
  buffer_load_dwordx4 v[204:207], v2, s[24:27], s58 offen offset:2048 sc1
  s_waitcnt lgkmcnt(3)
  v_mfma_f32_32x32x16_bf16 v[64:79], v[136:139], v[220:223], v[64:79]
  v_mfma_f32_32x32x16_bf16 v[80:95], v[140:143], v[220:223], v[80:95]
  v_mfma_f32_32x32x16_bf16 v[96:111], v[144:147], v[220:223], v[96:111]
  buffer_load_dwordx4 v[208:211], v2, s[24:27], s58 offen offset:3072 sc1
  s_add_u32 s58, s58, 4096
  buffer_load_dwordx4 v[212:215], v2, s[24:27], s58 offen offset:0 sc1
  buffer_load_dwordx4 v[216:219], v2, s[24:27], s58 offen offset:1024 sc1
  s_waitcnt lgkmcnt(0)
  v_mfma_f32_32x32x16_bf16 v[64:79], v[112:115], v[224:227], v[64:79]
  v_mfma_f32_32x32x16_bf16 v[80:95], v[116:119], v[224:227], v[80:95]
  v_mfma_f32_32x32x16_bf16 v[96:111], v[120:123], v[224:227], v[96:111]
  buffer_load_dwordx4 v[220:223], v2, s[24:27], s58 offen offset:2048 sc1
  buffer_load_dwordx4 v[224:227], v2, s[24:27], s58 offen offset:3072 sc1
  s_cmp_lg_u32 s52, 0
  s_cbranch_scc1 L_gb1_102
  v_lshlrev_b32 v5, 4, v3
  v_add_u32 v5, 122880, v5
  ds_read_b128 v[16:19], v5 offset:0
  ds_read_b128 v[20:23], v5 offset:32
  ds_read_b128 v[24:27], v5 offset:64
  ds_read_b128 v[28:31], v5 offset:96
  ds_read_b128 v[32:35], v5 offset:128
  ds_read_b128 v[36:39], v5 offset:160
  ds_read_b128 v[40:43], v5 offset:192
  ds_read_b128 v[44:47], v5 offset:224
  ds_read_b128 v[48:51], v5 offset:256
  ds_read_b128 v[52:55], v5 offset:288
  ds_read_b128 v[56:59], v5 offset:320
  ds_read_b128 v[60:63], v5 offset:352
  s_waitcnt lgkmcnt(0)
L_gb1_102:
  v_mov_b32 v244, 0xc0135761
  v_mov_b32 v245, 0xc0135761
  v_mov_b32 v246, 0xbdd2d3e8
  v_mov_b32 v247, 0xbdd2d3e8
  v_mov_b32 v248, 1.0
  v_mov_b32 v249, 1.0
  s_mul_i32 s34, s33, 3
  s_add_u32 s34, s34, 0
  s_lshl_b32 s57, s34, 9
  v_pk_mul_f32 v[112:113], v[16:17], v[6:7] op_sel_hi:[1,0]
  v_pk_mul_f32 v[114:115], v[18:19], v[6:7] op_sel_hi:[1,0]
  v_pk_mul_f32 v[116:117], v[24:25], v[6:7] op_sel_hi:[1,0]
  v_pk_mul_f32 v[118:119], v[26:27], v[6:7] op_sel_hi:[1,0]
  v_pk_fma_f32 v[112:113], v[64:65], v[4:5], v[112:113] op_sel_hi:[1,0,1]
  v_pk_fma_f32 v[114:115], v[66:67], v[4:5], v[114:115] op_sel_hi:[1,0,1]
  v_pk_fma_f32 v[116:117], v[72:73], v[4:5], v[116:117] op_sel_hi:[1,0,1]
  v_pk_fma_f32 v[118:119], v[74:75], v[4:5], v[118:119] op_sel_hi:[1,0,1]
  v_pk_mul_f32 v[120:121], v[112:113], v[112:113]
  v_pk_mul_f32 v[122:123], v[114:115], v[114:115]
  v_pk_fma_f32 v[120:121], v[120:121], v[246:247], v[244:245]
  v_pk_fma_f32 v[122:123], v[122:123], v[246:247], v[244:245]
  v_pk_mul_f32 v[120:121], v[120:121], v[112:113]
  v_pk_mul_f32 v[122:123], v[122:123], v[114:115]
  v_exp_f32 v120, v120
  v_exp_f32 v121, v121
  v_exp_f32 v122, v122
  v_exp_f32 v123, v123
  v_pk_mul_f32 v[124:125], v[112:113], v[116:117]
  v_pk_mul_f32 v[126:127], v[114:115], v[118:119]
  v_pk_add_f32 v[120:121], v[120:121], v[248:249]
  v_pk_add_f32 v[122:123], v[122:123], v[248:249]
  v_rcp_f32 v120, v120
  v_rcp_f32 v121, v121
  v_rcp_f32 v122, v122
  v_rcp_f32 v123, v123
  v_pk_mul_f32 v[124:125], v[124:125], v[120:121]
  v_pk_mul_f32 v[126:127], v[126:127], v[122:123]
  v_cvt_pk_bf16_f32 v128, v124, v125
  v_cvt_pk_bf16_f32 v129, v126, v127
  buffer_store_dwordx2 v[128:129], v8, s[24:27], s57 offen offset:0 sc1
  v_pk_mul_f32 v[130:131], v[20:21], v[6:7] op_sel_hi:[1,0]
  v_pk_mul_f32 v[132:133], v[22:23], v[6:7] op_sel_hi:[1,0]
  v_pk_mul_f32 v[134:135], v[28:29], v[6:7] op_sel_hi:[1,0]
  v_pk_mul_f32 v[136:137], v[30:31], v[6:7] op_sel_hi:[1,0]
  v_pk_fma_f32 v[130:131], v[68:69], v[4:5], v[130:131] op_sel_hi:[1,0,1]
  v_pk_fma_f32 v[132:133], v[70:71], v[4:5], v[132:133] op_sel_hi:[1,0,1]
  v_pk_fma_f32 v[134:135], v[76:77], v[4:5], v[134:135] op_sel_hi:[1,0,1]
  v_pk_fma_f32 v[136:137], v[78:79], v[4:5], v[136:137] op_sel_hi:[1,0,1]
  v_pk_mul_f32 v[138:139], v[130:131], v[130:131]
  v_pk_mul_f32 v[140:141], v[132:133], v[132:133]
  v_pk_fma_f32 v[138:139], v[138:139], v[246:247], v[244:245]
  v_pk_fma_f32 v[140:141], v[140:141], v[246:247], v[244:245]
  v_pk_mul_f32 v[138:139], v[138:139], v[130:131]
  v_pk_mul_f32 v[140:141], v[140:141], v[132:133]
  v_exp_f32 v138, v138
  v_exp_f32 v139, v139
  v_exp_f32 v140, v140
  v_exp_f32 v141, v141
  v_pk_mul_f32 v[142:143], v[130:131], v[134:135]
  v_pk_mul_f32 v[144:145], v[132:133], v[136:137]
  v_pk_add_f32 v[138:139], v[138:139], v[248:249]
  v_pk_add_f32 v[140:141], v[140:141], v[248:249]
  v_rcp_f32 v138, v138
  v_rcp_f32 v139, v139
  v_rcp_f32 v140, v140
  v_rcp_f32 v141, v141
  v_pk_mul_f32 v[142:143], v[142:143], v[138:139]
  v_pk_mul_f32 v[144:145], v[144:145], v[140:141]
  v_cvt_pk_bf16_f32 v146, v142, v143
  v_cvt_pk_bf16_f32 v147, v144, v145
  buffer_store_dwordx2 v[146:147], v8, s[24:27], s57 offen offset:256 sc1
  s_mul_i32 s34, s33, 3
  s_add_u32 s34, s34, 1
  s_lshl_b32 s57, s34, 9
  v_pk_mul_f32 v[112:113], v[32:33], v[6:7] op_sel_hi:[1,0]
  v_pk_mul_f32 v[114:115], v[34:35], v[6:7] op_sel_hi:[1,0]
  v_pk_mul_f32 v[116:117], v[40:41], v[6:7] op_sel_hi:[1,0]
  v_pk_mul_f32 v[118:119], v[42:43], v[6:7] op_sel_hi:[1,0]
  v_pk_fma_f32 v[112:113], v[80:81], v[4:5], v[112:113] op_sel_hi:[1,0,1]
  v_pk_fma_f32 v[114:115], v[82:83], v[4:5], v[114:115] op_sel_hi:[1,0,1]
  v_pk_fma_f32 v[116:117], v[88:89], v[4:5], v[116:117] op_sel_hi:[1,0,1]
  v_pk_fma_f32 v[118:119], v[90:91], v[4:5], v[118:119] op_sel_hi:[1,0,1]
  v_pk_mul_f32 v[120:121], v[112:113], v[112:113]
  v_pk_mul_f32 v[122:123], v[114:115], v[114:115]
  v_pk_fma_f32 v[120:121], v[120:121], v[246:247], v[244:245]
  v_pk_fma_f32 v[122:123], v[122:123], v[246:247], v[244:245]
  v_pk_mul_f32 v[120:121], v[120:121], v[112:113]
  v_pk_mul_f32 v[122:123], v[122:123], v[114:115]
  v_exp_f32 v120, v120
  v_exp_f32 v121, v121
  v_exp_f32 v122, v122
  v_exp_f32 v123, v123
  v_pk_mul_f32 v[124:125], v[112:113], v[116:117]
  v_pk_mul_f32 v[126:127], v[114:115], v[118:119]
  v_pk_add_f32 v[120:121], v[120:121], v[248:249]
  v_pk_add_f32 v[122:123], v[122:123], v[248:249]
  v_rcp_f32 v120, v120
  v_rcp_f32 v121, v121
  v_rcp_f32 v122, v122
  v_rcp_f32 v123, v123
  v_pk_mul_f32 v[124:125], v[124:125], v[120:121]
  v_pk_mul_f32 v[126:127], v[126:127], v[122:123]
  v_cvt_pk_bf16_f32 v128, v124, v125
  v_cvt_pk_bf16_f32 v129, v126, v127
  buffer_store_dwordx2 v[128:129], v8, s[24:27], s57 offen offset:0 sc1
  v_pk_mul_f32 v[130:131], v[36:37], v[6:7] op_sel_hi:[1,0]
  v_pk_mul_f32 v[132:133], v[38:39], v[6:7] op_sel_hi:[1,0]
  v_pk_mul_f32 v[134:135], v[44:45], v[6:7] op_sel_hi:[1,0]
  v_pk_mul_f32 v[136:137], v[46:47], v[6:7] op_sel_hi:[1,0]
  v_pk_fma_f32 v[130:131], v[84:85], v[4:5], v[130:131] op_sel_hi:[1,0,1]
  v_pk_fma_f32 v[132:133], v[86:87], v[4:5], v[132:133] op_sel_hi:[1,0,1]
  v_pk_fma_f32 v[134:135], v[92:93], v[4:5], v[134:135] op_sel_hi:[1,0,1]
  v_pk_fma_f32 v[136:137], v[94:95], v[4:5], v[136:137] op_sel_hi:[1,0,1]
  v_pk_mul_f32 v[138:139], v[130:131], v[130:131]
  v_pk_mul_f32 v[140:141], v[132:133], v[132:133]
  v_pk_fma_f32 v[138:139], v[138:139], v[246:247], v[244:245]
  v_pk_fma_f32 v[140:141], v[140:141], v[246:247], v[244:245]
  v_pk_mul_f32 v[138:139], v[138:139], v[130:131]
  v_pk_mul_f32 v[140:141], v[140:141], v[132:133]
  v_exp_f32 v138, v138
  v_exp_f32 v139, v139
  v_exp_f32 v140, v140
  v_exp_f32 v141, v141
  v_pk_mul_f32 v[142:143], v[130:131], v[134:135]
  v_pk_mul_f32 v[144:145], v[132:133], v[136:137]
  v_pk_add_f32 v[138:139], v[138:139], v[248:249]
  v_pk_add_f32 v[140:141], v[140:141], v[248:249]
  v_rcp_f32 v138, v138
  v_rcp_f32 v139, v139
  v_rcp_f32 v140, v140
  v_rcp_f32 v141, v141
  v_pk_mul_f32 v[142:143], v[142:143], v[138:139]
  v_pk_mul_f32 v[144:145], v[144:145], v[140:141]
  v_cvt_pk_bf16_f32 v146, v142, v143
  v_cvt_pk_bf16_f32 v147, v144, v145
  buffer_store_dwordx2 v[146:147], v8, s[24:27], s57 offen offset:256 sc1
  s_mul_i32 s34, s33, 3
  s_add_u32 s34, s34, 2
  s_lshl_b32 s57, s34, 9
  v_pk_mul_f32 v[112:113], v[48:49], v[6:7] op_sel_hi:[1,0]
  v_pk_mul_f32 v[114:115], v[50:51], v[6:7] op_sel_hi:[1,0]
  v_pk_mul_f32 v[116:117], v[56:57], v[6:7] op_sel_hi:[1,0]
  v_pk_mul_f32 v[118:119], v[58:59], v[6:7] op_sel_hi:[1,0]
  v_pk_fma_f32 v[112:113], v[96:97], v[4:5], v[112:113] op_sel_hi:[1,0,1]
  v_pk_fma_f32 v[114:115], v[98:99], v[4:5], v[114:115] op_sel_hi:[1,0,1]
  v_pk_fma_f32 v[116:117], v[104:105], v[4:5], v[116:117] op_sel_hi:[1,0,1]
  v_pk_fma_f32 v[118:119], v[106:107], v[4:5], v[118:119] op_sel_hi:[1,0,1]
  v_pk_mul_f32 v[120:121], v[112:113], v[112:113]
  v_pk_mul_f32 v[122:123], v[114:115], v[114:115]
  v_pk_fma_f32 v[120:121], v[120:121], v[246:247], v[244:245]
  v_pk_fma_f32 v[122:123], v[122:123], v[246:247], v[244:245]
  v_pk_mul_f32 v[120:121], v[120:121], v[112:113]
  v_pk_mul_f32 v[122:123], v[122:123], v[114:115]
  v_exp_f32 v120, v120
  v_exp_f32 v121, v121
  v_exp_f32 v122, v122
  v_exp_f32 v123, v123
  v_pk_mul_f32 v[124:125], v[112:113], v[116:117]
  v_pk_mul_f32 v[126:127], v[114:115], v[118:119]
  v_pk_add_f32 v[120:121], v[120:121], v[248:249]
  v_pk_add_f32 v[122:123], v[122:123], v[248:249]
  v_rcp_f32 v120, v120
  v_rcp_f32 v121, v121
  v_rcp_f32 v122, v122
  v_rcp_f32 v123, v123
  v_pk_mul_f32 v[124:125], v[124:125], v[120:121]
  v_pk_mul_f32 v[126:127], v[126:127], v[122:123]
  v_cvt_pk_bf16_f32 v128, v124, v125
  v_cvt_pk_bf16_f32 v129, v126, v127
  buffer_store_dwordx2 v[128:129], v8, s[24:27], s57 offen offset:0 sc1
  v_pk_mul_f32 v[130:131], v[52:53], v[6:7] op_sel_hi:[1,0]
  v_pk_mul_f32 v[132:133], v[54:55], v[6:7] op_sel_hi:[1,0]
  v_pk_mul_f32 v[134:135], v[60:61], v[6:7] op_sel_hi:[1,0]
  v_pk_mul_f32 v[136:137], v[62:63], v[6:7] op_sel_hi:[1,0]
  v_pk_fma_f32 v[130:131], v[100:101], v[4:5], v[130:131] op_sel_hi:[1,0,1]
  v_pk_fma_f32 v[132:133], v[102:103], v[4:5], v[132:133] op_sel_hi:[1,0,1]
  v_pk_fma_f32 v[134:135], v[108:109], v[4:5], v[134:135] op_sel_hi:[1,0,1]
  v_pk_fma_f32 v[136:137], v[110:111], v[4:5], v[136:137] op_sel_hi:[1,0,1]
  v_pk_mul_f32 v[138:139], v[130:131], v[130:131]
  v_pk_mul_f32 v[140:141], v[132:133], v[132:133]
  v_pk_fma_f32 v[138:139], v[138:139], v[246:247], v[244:245]
  v_pk_fma_f32 v[140:141], v[140:141], v[246:247], v[244:245]
  v_pk_mul_f32 v[138:139], v[138:139], v[130:131]
  v_pk_mul_f32 v[140:141], v[140:141], v[132:133]
  v_exp_f32 v138, v138
  v_exp_f32 v139, v139
  v_exp_f32 v140, v140
  v_exp_f32 v141, v141
  v_pk_mul_f32 v[142:143], v[130:131], v[134:135]
  v_pk_mul_f32 v[144:145], v[132:133], v[136:137]
  v_pk_add_f32 v[138:139], v[138:139], v[248:249]
  v_pk_add_f32 v[140:141], v[140:141], v[248:249]
  v_rcp_f32 v138, v138
  v_rcp_f32 v139, v139
  v_rcp_f32 v140, v140
  v_rcp_f32 v141, v141
  v_pk_mul_f32 v[142:143], v[142:143], v[138:139]
  v_pk_mul_f32 v[144:145], v[144:145], v[140:141]
  v_cvt_pk_bf16_f32 v146, v142, v143
  v_cvt_pk_bf16_f32 v147, v144, v145
  buffer_store_dwordx2 v[146:147], v8, s[24:27], s57 offen offset:256 sc1
  s_waitcnt vmcnt(0)
  s_barrier
  s_cmp_lg_u32 s3, 0
  s_cbranch_scc1 L_gnp_103
  s_lshl_b32 s34, s52, 3
  s_add_u32 s34, s34, s32
  s_add_u32 s34, s34, 88
  s_lshl_b32 s90, s34, 8
  s_add_u32 s90, s90, 26681344
  v_mov_b32 v112, 1
  v_mov_b32 v113, 0
  s_mov_b64 exec, 1
  buffer_atomic_add v112, v113, s[24:27], s90 offen sc1
  s_mov_b64 exec, -1
L_gnp_103:
  s_add_u32 s52, s52, 1
  s_cmp_lt_u32 s52, 2
  s_cbranch_scc1 L_gh_98
L_p4_done:
  s_and_b32 s34, s2, 7
  s_lshr_b32 s35, s2, 3
  s_lshr_b32 s32, s34, 1
  s_lshl_b32 s32, s32, 2
  s_lshr_b32 s33, s35, 3
  s_add_u32 s32, s32, s33
  s_and_b32 s33, s34, 1
  s_lshl_b32 s33, s33, 3
  s_and_b32 s35, s35, 7
  s_add_u32 s33, s33, s35
  s_cmp_lt_u32 s3, 4
  s_cbranch_scc1 L_xc_104
  s_and_b32 s34, s3, 1
  s_cmp_ge_u32 s3, 6
  s_cbranch_scc1 L_xx_105
  s_mul_i32 s44, s34, 2048
  s_mul_i32 s40, s33, 122880
  s_add_u32 s40, s40, s44
  s_add_u32 s40, s40, 20253696
  s_add_u32 m0, s44, 0
  s_add_u32 s41, s40, 0
  buffer_load_dwordx4 v2, s[24:27], s41 offen sc1 lds
  s_add_u32 m0, s44, 1024
  s_add_u32 s41, s40, 1024
  buffer_load_dwordx4 v2, s[24:27], s41 offen sc1 lds
  s_add_u32 m0, s44, 2048
  s_add_u32 s41, s40, 2048
  buffer_load_dwordx4 v2, s[24:27], s41 offen sc1 lds
  s_add_u32 s40, s40, 5120
  s_add_u32 s44, s44, 5120
  s_add_u32 m0, s44, 0
  s_add_u32 s41, s40, 0
  buffer_load_dwordx4 v2, s[24:27], s41 offen sc1 lds
  s_add_u32 m0, s44, 1024
  s_add_u32 s41, s40, 1024
  buffer_load_dwordx4 v2, s[24:27], s41 offen sc1 lds
  s_add_u32 m0, s44, 2048
  s_add_u32 s41, s40, 2048
  buffer_load_dwordx4 v2, s[24:27], s41 offen sc1 lds
  s_add_u32 s40, s40, 5120
  s_add_u32 s44, s44, 5120
  s_add_u32 m0, s44, 0
  s_add_u32 s41, s40, 0
  buffer_load_dwordx4 v2, s[24:27], s41 offen sc1 lds
  s_add_u32 m0, s44, 1024
  s_add_u32 s41, s40, 1024
  buffer_load_dwordx4 v2, s[24:27], s41 offen sc1 lds
  s_add_u32 m0, s44, 2048
  s_add_u32 s41, s40, 2048
  buffer_load_dwordx4 v2, s[24:27], s41 offen sc1 lds
  s_add_u32 s40, s40, 5120
  s_add_u32 s44, s44, 5120
  s_barrier
  s_add_u32 m0, s44, 0
  s_add_u32 s41, s40, 0
  buffer_load_dwordx4 v2, s[24:27], s41 offen sc1 lds
  s_add_u32 m0, s44, 1024
  s_add_u32 s41, s40, 1024
  buffer_load_dwordx4 v2, s[24:27], s41 offen sc1 lds
  s_add_u32 m0, s44, 2048
  s_add_u32 s41, s40, 2048
  buffer_load_dwordx4 v2, s[24:27], s41 offen sc1 lds
  s_add_u32 s40, s40, 5120
  s_add_u32 s44, s44, 5120
  s_add_u32 m0, s44, 0
  s_add_u32 s41, s40, 0
  buffer_load_dwordx4 v2, s[24:27], s41 offen sc1 lds
  s_add_u32 m0, s44, 1024
  s_add_u32 s41, s40, 1024
  buffer_load_dwordx4 v2, s[24:27], s41 offen sc1 lds
  s_add_u32 m0, s44, 2048
  s_add_u32 s41, s40, 2048
  buffer_load_dwordx4 v2, s[24:27], s41 offen sc1 lds
  s_add_u32 s40, s40, 5120
  s_add_u32 s44, s44, 5120
  s_add_u32 m0, s44, 0
  s_add_u32 s41, s40, 0
  buffer_load_dwordx4 v2, s[24:27], s41 offen sc1 lds
  s_add_u32 m0, s44, 1024
  s_add_u32 s41, s40, 1024
  buffer_load_dwordx4 v2, s[24:27], s41 offen sc1 lds
  s_add_u32 m0, s44, 2048
  s_add_u32 s41, s40, 2048
  buffer_load_dwordx4 v2, s[24:27], s41 offen sc1 lds
  s_add_u32 s40, s40, 5120
  s_add_u32 s44, s44, 5120
  s_waitcnt vmcnt(15)
  s_barrier
  s_add_u32 m0, s44, 0
  s_add_u32 s41, s40, 0
  buffer_load_dwordx4 v2, s[24:27], s41 offen sc1 lds
  s_add_u32 m0, s44, 1024
  s_add_u32 s41, s40, 1024
  buffer_load_dwordx4 v2, s[24:27], s41 offen sc1 lds
  s_add_u32 m0, s44, 2048
  s_add_u32 s41, s40, 2048
  buffer_load_dwordx4 v2, s[24:27], s41 offen sc1 lds
  s_add_u32 s40, s40, 5120
  s_add_u32 s44, s44, 5120
  s_add_u32 m0, s44, 0
  s_add_u32 s41, s40, 0
  buffer_load_dwordx4 v2, s[24:27], s41 offen sc1 lds
  s_add_u32 m0, s44, 1024
  s_add_u32 s41, s40, 1024
  buffer_load_dwordx4 v2, s[24:27], s41 offen sc1 lds
  s_add_u32 m0, s44, 2048
  s_add_u32 s41, s40, 2048
  buffer_load_dwordx4 v2, s[24:27], s41 offen sc1 lds
  s_add_u32 s40, s40, 5120
  s_add_u32 s44, s44, 5120
  s_waitcnt vmcnt(18)
  s_barrier
  s_add_u32 m0, s44, 0
  s_add_u32 s41, s40, 0
  buffer_load_dwordx4 v2, s[24:27], s41 offen sc1 lds
  s_add_u32 m0, s44, 1024
  s_add_u32 s41, s40, 1024
  buffer_load_dwordx4 v2, s[24:27], s41 offen sc1 lds
  s_add_u32 m0, s44, 2048
  s_add_u32 s41, s40, 2048
  buffer_load_dwordx4 v2, s[24:27], s41 offen sc1 lds
  s_add_u32 s40, s40, 5120
  s_add_u32 s44, s44, 5120
  s_add_u32 m0, s44, 0
  s_add_u32 s41, s40, 0
  buffer_load_dwordx4 v2, s[24:27], s41 offen sc1 lds
  s_add_u32 m0, s44, 1024
  s_add_u32 s41, s40, 1024
  buffer_load_dwordx4 v2, s[24:27], s41 offen sc1 lds
  s_add_u32 m0, s44, 2048
  s_add_u32 s41, s40, 2048
  buffer_load_dwordx4 v2, s[24:27], s41 offen sc1 lds
  s_add_u32 s40, s40, 5120
  s_add_u32 s44, s44, 5120
  s_waitcnt vmcnt(21)
  s_barrier
  s_add_u32 m0, s44, 0
  s_add_u32 s41, s40, 0
  buffer_load_dwordx4 v2, s[24:27], s41 offen sc1 lds
  s_add_u32 m0, s44, 1024
  s_add_u32 s41, s40, 1024
  buffer_load_dwordx4 v2, s[24:27], s41 offen sc1 lds
  s_add_u32 m0, s44, 2048
  s_add_u32 s41, s40, 2048
  buffer_load_dwordx4 v2, s[24:27], s41 offen sc1 lds
  s_add_u32 s40, s40, 5120
  s_add_u32 s44, s44, 5120
  s_add_u32 m0, s44, 0
  s_add_u32 s41, s40, 0
  buffer_load_dwordx4 v2, s[24:27], s41 offen sc1 lds
  s_add_u32 m0, s44, 1024
  s_add_u32 s41, s40, 1024
  buffer_load_dwordx4 v2, s[24:27], s41 offen sc1 lds
  s_add_u32 m0, s44, 2048
  s_add_u32 s41, s40, 2048
  buffer_load_dwordx4 v2, s[24:27], s41 offen sc1 lds
  s_add_u32 s40, s40, 5120
  s_add_u32 s44, s44, 5120
  s_waitcnt vmcnt(24)
  s_barrier
  s_add_u32 m0, s44, 0
  s_add_u32 s41, s40, 0
  buffer_load_dwordx4 v2, s[24:27], s41 offen sc1 lds
  s_add_u32 m0, s44, 1024
  s_add_u32 s41, s40, 1024
  buffer_load_dwordx4 v2, s[24:27], s41 offen sc1 lds
  s_add_u32 m0, s44, 2048
  s_add_u32 s41, s40, 2048
  buffer_load_dwordx4 v2, s[24:27], s41 offen sc1 lds
  s_add_u32 s40, s40, 5120
  s_add_u32 s44, s44, 5120
  s_add_u32 m0, s44, 0
  s_add_u32 s41, s40, 0
  buffer_load_dwordx4 v2, s[24:27], s41 offen sc1 lds
  s_add_u32 m0, s44, 1024
  s_add_u32 s41, s40, 1024
  buffer_load_dwordx4 v2, s[24:27], s41 offen sc1 lds
  s_add_u32 m0, s44, 2048
  s_add_u32 s41, s40, 2048
  buffer_load_dwordx4 v2, s[24:27], s41 offen sc1 lds
  s_add_u32 s40, s40, 5120
  s_add_u32 s44, s44, 5120
  s_waitcnt vmcnt(27)
  s_barrier
  s_add_u32 m0, s44, 0
  s_add_u32 s41, s40, 0
  buffer_load_dwordx4 v2, s[24:27], s41 offen sc1 lds
  s_add_u32 m0, s44, 1024
  s_add_u32 s41, s40, 1024
  buffer_load_dwordx4 v2, s[24:27], s41 offen sc1 lds
  s_add_u32 m0, s44, 2048
  s_add_u32 s41, s40, 2048
  buffer_load_dwordx4 v2, s[24:27], s41 offen sc1 lds
  s_add_u32 s40, s40, 5120
  s_add_u32 s44, s44, 5120
  s_add_u32 m0, s44, 0
  s_add_u32 s41, s40, 0
  buffer_load_dwordx4 v2, s[24:27], s41 offen sc1 lds
  s_add_u32 m0, s44, 1024
  s_add_u32 s41, s40, 1024
  buffer_load_dwordx4 v2, s[24:27], s41 offen sc1 lds
  s_add_u32 m0, s44, 2048
  s_add_u32 s41, s40, 2048
  buffer_load_dwordx4 v2, s[24:27], s41 offen sc1 lds
  s_add_u32 s40, s40, 5120
  s_add_u32 s44, s44, 5120
  s_waitcnt vmcnt(30)
  s_barrier
  s_add_u32 m0, s44, 0
  s_add_u32 s41, s40, 0
  buffer_load_dwordx4 v2, s[24:27], s41 offen sc1 lds
  s_add_u32 m0, s44, 1024
  s_add_u32 s41, s40, 1024
  buffer_load_dwordx4 v2, s[24:27], s41 offen sc1 lds
  s_add_u32 m0, s44, 2048
  s_add_u32 s41, s40, 2048
  buffer_load_dwordx4 v2, s[24:27], s41 offen sc1 lds
  s_add_u32 s40, s40, 5120
  s_add_u32 s44, s44, 5120
  s_waitcnt vmcnt(30)
  s_barrier
  s_waitcnt vmcnt(27)
  s_barrier
  s_waitcnt vmcnt(24)
  s_barrier
  s_waitcnt vmcnt(21)
  s_barrier
  s_waitcnt vmcnt(18)
  s_barrier
  s_waitcnt vmcnt(15)
  s_barrier
  s_waitcnt vmcnt(12)
  s_barrier
  s_barrier
  s_waitcnt vmcnt(9)
  s_barrier
  s_waitcnt vmcnt(6)
  s_barrier
  s_waitcnt vmcnt(3)
  s_barrier
  s_waitcnt vmcnt(0)
  s_barrier
  s_mov_b32 s38, 0
L_ob_106:
  s_barrier
  s_add_u32 s38, s38, 1
  s_cmp_lt_u32 s38, 17
  s_cbranch_scc1 L_ob_106
  s_branch L_p5_done
L_xx_105:
  s_cmp_lg_u32 s34, 0
  s_cbranch_scc1 L_xp7_107
  s_barrier
  s_mov_b32 s38, 0
L_ob_108:
  s_barrier
  s_add_u32 s38, s38, 1
  s_cmp_lt_u32 s38, 13
  s_cbranch_scc1 L_ob_108
  s_lshr_b32 s45, s32, 1
  s_add_u32 s45, s45, 96
  s_lshl_b32 s91, s45, 8
  s_add_u32 s91, s91, 26681344
  v_lshlrev_b32 v8, 8, v1
  s_mov_b32 s90, 0
  s_mov_b64 exec, 0x1
L_pc_109:
  buffer_load_dword v9, v8, s[24:27], s91 offen sc1
  s_waitcnt vmcnt(0)
  v_cmp_le_u32 vcc, 32, v9
  s_nop 2
  s_cmp_eq_u64 vcc, exec
  s_cbranch_scc1 L_pcd_110
  s_sleep 2
  s_add_u32 s90, s90, 1
  s_cmp_lt_u32 s90, 0x40000
  s_cbranch_scc1 L_pc_109
L_pcd_110:
  s_mov_b64 exec, -1
  s_mov_b32 s38, 0
L_ob_111:
  s_barrier
  s_add_u32 s38, s38, 1
  s_cmp_lt_u32 s38, 22
  s_cbranch_scc1 L_ob_111
  s_branch L_p5_done
L_xp7_107:
  s_mov_b32 s38, 0
L_ob_112:
  s_barrier
  s_add_u32 s38, s38, 1
  s_cmp_lt_u32 s38, 36
  s_cbranch_scc1 L_ob_112
  s_branch L_p5_done
L_xc_104:
  s_mov_b32 s60, s18
  s_mov_b32 s61, s19
  s_mov_b32 s62, 2621440
  s_mov_b32 s63, 0x20000
  v_lshrrev_b32 v5, 4, v1
  v_and_b32 v6, 7, v1
  v_lshlrev_b32 v6, 4, v6
  v_lshl_add_u32 v5, v5, 7, v6
  v_add_u32 v80, 123904, v2
  v_add_u32 v84, 125952, v5
  v_add_u32 v81, 0, v2
  v_add_u32 v85, 2048, v5
  v_add_u32 v82, 61440, v2
  v_add_u32 v86, 63488, v5
  v_and_b32 v5, 15, v1
  v_lshrrev_b32 v6, 4, v1
  s_lshl_b32 s34, s32, 6
  s_lshl_b32 s35, s3, 4
  s_add_u32 s34, s34, s35
  s_add_u32 s34, s34, 0
  v_add_u32 v7, s34, v5
  s_movk_i32 s34, 1280
  v_mul_lo_u32 v4, v7, s34
  v_lshl_add_u32 v4, v6, 3, v4
  s_mul_i32 s34, s33, 80
  v_add_u32 v4, s34, v4
  s_mul_i32 s34, s33, 40
  s_add_u32 s34, s34, 0
  v_lshl_add_u32 v14, v6, 2, s34
  v_lshrrev_b32 v15, 5, v7
  v_mul_u32_u24 v15, 40, v15
  v_lshrrev_b32 v16, 4, v14
  v_add_u32 v15, v15, v16
  v_lshlrev_b32 v15, 6, v15
  v_bfe_u32 v16, v14, 3, 1
  v_lshl_add_u32 v15, v16, 5, v15
  v_and_b32 v16, 31, v7
  v_add_u32 v15, v15, v16
  v_lshlrev_b32 v15, 4, v15
  v_and_b32 v16, 7, v14
  v_lshl_add_u32 v15, v16, 1, v15
  v_add_u32 v88, 10485760, v15
  s_mul_i32 s34, s33, 40
  s_add_u32 s34, s34, 16
  v_lshl_add_u32 v14, v6, 2, s34
  v_lshrrev_b32 v15, 5, v7
  v_mul_u32_u24 v15, 40, v15
  v_lshrrev_b32 v16, 4, v14
  v_add_u32 v15, v15, v16
  v_lshlrev_b32 v15, 6, v15
  v_bfe_u32 v16, v14, 3, 1
  v_lshl_add_u32 v15, v16, 5, v15
  v_and_b32 v16, 31, v7
  v_add_u32 v15, v15, v16
  v_lshlrev_b32 v15, 4, v15
  v_and_b32 v16, 7, v14
  v_lshl_add_u32 v15, v16, 1, v15
  v_add_u32 v89, 10485760, v15
  s_mul_i32 s34, s33, 40
  s_add_u32 s34, s34, 32
  v_lshl_add_u32 v14, v6, 2, s34
  v_lshrrev_b32 v15, 5, v7
  v_mul_u32_u24 v15, 40, v15
  v_lshrrev_b32 v16, 4, v14
  v_add_u32 v15, v15, v16
  v_lshlrev_b32 v15, 6, v15
  v_bfe_u32 v16, v14, 3, 1
  v_lshl_add_u32 v15, v16, 5, v15
  v_and_b32 v16, 31, v7
  v_add_u32 v15, v15, v16
  v_lshlrev_b32 v15, 4, v15
  v_and_b32 v16, 7, v14
  v_lshl_add_u32 v15, v16, 1, v15
  v_add_u32 v90, 10485760, v15
  v_and_b32 v5, 15, v1
  v_lshrrev_b32 v6, 4, v1
  s_lshl_b32 s34, s32, 6
  s_lshl_b32 s35, s3, 4
  s_add_u32 s34, s34, s35
  s_add_u32 s34, s34, 1024
  v_add_u32 v7, s34, v5
  s_movk_i32 s34, 1280
  v_mul_lo_u32 v102, v7, s34
  v_lshl_add_u32 v102, v6, 3, v102
  s_mul_i32 s34, s33, 80
  v_add_u32 v102, s34, v102
  s_mul_i32 s34, s33, 40
  s_add_u32 s34, s34, 0
  v_lshl_add_u32 v14, v6, 2, s34
  v_lshrrev_b32 v15, 5, v7
  v_mul_u32_u24 v15, 40, v15
  v_lshrrev_b32 v16, 4, v14
  v_add_u32 v15, v15, v16
  v_lshlrev_b32 v15, 6, v15
  v_bfe_u32 v16, v14, 3, 1
  v_lshl_add_u32 v15, v16, 5, v15
  v_and_b32 v16, 31, v7
  v_add_u32 v15, v15, v16
  v_lshlrev_b32 v15, 4, v15
  v_and_b32 v16, 7, v14
  v_lshl_add_u32 v15, v16, 1, v15
  v_add_u32 v104, 10485760, v15
  s_mul_i32 s34, s33, 40
  s_add_u32 s34, s34, 16
  v_lshl_add_u32 v14, v6, 2, s34
  v_lshrrev_b32 v15, 5, v7
  v_mul_u32_u24 v15, 40, v15
  v_lshrrev_b32 v16, 4, v14
  v_add_u32 v15, v15, v16
  v_lshlrev_b32 v15, 6, v15
  v_bfe_u32 v16, v14, 3, 1
  v_lshl_add_u32 v15, v16, 5, v15
  v_and_b32 v16, 31, v7
  v_add_u32 v15, v15, v16
  v_lshlrev_b32 v15, 4, v15
  v_and_b32 v16, 7, v14
  v_lshl_add_u32 v15, v16, 1, v15
  v_add_u32 v105, 10485760, v15
  s_mul_i32 s34, s33, 40
  s_add_u32 s34, s34, 32
  v_lshl_add_u32 v14, v6, 2, s34
  v_lshrrev_b32 v15, 5, v7
  v_mul_u32_u24 v15, 40, v15
  v_lshrrev_b32 v16, 4, v14
  v_add_u32 v15, v15, v16
  v_lshlrev_b32 v15, 6, v15
  v_bfe_u32 v16, v14, 3, 1
  v_lshl_add_u32 v15, v16, 5, v15
  v_and_b32 v16, 31, v7
  v_add_u32 v15, v15, v16
  v_lshlrev_b32 v15, 4, v15
  v_and_b32 v16, 7, v14
  v_lshl_add_u32 v15, v16, 1, v15
  v_add_u32 v106, 10485760, v15
  buffer_load_dwordx2 v[8:9], v88, s[24:27], 0 offen sc1
  buffer_load_dwordx2 v[10:11], v89, s[24:27], 0 offen sc1
  buffer_load_dwordx2 v[12:13], v90, s[24:27], 0 offen sc1
  s_add_u32 s58, s58, 4096
  buffer_load_dwordx4 v[228:231], v2, s[24:27], s58 offen offset:0 sc1
  buffer_load_dwordx4 v[232:235], v2, s[24:27], s58 offen offset:1024 sc1
  buffer_load_dwordx4 v[236:239], v2, s[24:27], s58 offen offset:2048 sc1
  buffer_load_dwordx4 v[240:243], v2, s[24:27], s58 offen offset:3072 sc1
  s_barrier
  s_mov_b32 s52, 0
L_xh_113:
  v_mov_b32 v68, 0
  v_mov_b32 v69, 0
  v_mov_b32 v70, 0
  v_mov_b32 v71, 0
  v_mov_b32 v72, 0
  v_mov_b32 v73, 0
  v_mov_b32 v74, 0
  v_mov_b32 v75, 0
  v_mov_b32 v76, 0
  v_mov_b32 v77, 0
  v_mov_b32 v78, 0
  v_mov_b32 v79, 0
  ds_read_b128 v[20:23], v80 offset:0
  ds_read_b128 v[24:27], v80 offset:1024
  ds_read_b128 v[28:31], v84 offset:0
  ds_read_b128 v[32:35], v80 offset:2560
  ds_read_b128 v[36:39], v80 offset:3584
  ds_read_b128 v[40:43], v84 offset:2560
  s_waitcnt lgkmcnt(3)
  s_waitcnt vmcnt(23)
  v_mfma_f32_16x16x32_bf16 v[68:71], v[20:23], v[148:151], v[68:71]
  ds_read_b128 v[44:47], v80 offset:5120
  v_mfma_f32_16x16x32_bf16 v[72:75], v[24:27], v[148:151], v[72:75]
  ds_read_b128 v[48:51], v80 offset:6144
  v_mfma_f32_16x16x32_bf16 v[76:79], v[28:31], v[148:151], v[76:79]
  ds_read_b128 v[52:55], v84 offset:5120
  s_add_u32 s58, s58, 4096
  buffer_load_dwordx4 v[148:151], v2, s[24:27], s58 offen offset:0 sc1
  s_waitcnt lgkmcnt(3)
  s_waitcnt vmcnt(23)
  v_mfma_f32_16x16x32_bf16 v[68:71], v[32:35], v[152:155], v[68:71]
  ds_read_b128 v[56:59], v80 offset:7680
  v_mfma_f32_16x16x32_bf16 v[72:75], v[36:39], v[152:155], v[72:75]
  ds_read_b128 v[60:63], v80 offset:8704
  v_mfma_f32_16x16x32_bf16 v[76:79], v[40:43], v[152:155], v[76:79]
  ds_read_b128 v[64:67], v84 offset:7680
  buffer_load_dwordx4 v[152:155], v2, s[24:27], s58 offen offset:1024 sc1
  s_waitcnt lgkmcnt(3)
  s_waitcnt vmcnt(23)
  v_mfma_f32_16x16x32_bf16 v[68:71], v[44:47], v[156:159], v[68:71]
  ds_read_b128 v[20:23], v80 offset:10240
  v_mfma_f32_16x16x32_bf16 v[72:75], v[48:51], v[156:159], v[72:75]
  ds_read_b128 v[24:27], v80 offset:11264
  v_mfma_f32_16x16x32_bf16 v[76:79], v[52:55], v[156:159], v[76:79]
  ds_read_b128 v[28:31], v84 offset:10240
  buffer_load_dwordx4 v[156:159], v2, s[24:27], s58 offen offset:2048 sc1
  s_waitcnt lgkmcnt(3)
  s_waitcnt vmcnt(23)
  v_mfma_f32_16x16x32_bf16 v[68:71], v[56:59], v[160:163], v[68:71]
  ds_read_b128 v[32:35], v80 offset:12800
  v_mfma_f32_16x16x32_bf16 v[72:75], v[60:63], v[160:163], v[72:75]
  ds_read_b128 v[36:39], v80 offset:13824
  v_mfma_f32_16x16x32_bf16 v[76:79], v[64:67], v[160:163], v[76:79]
  ds_read_b128 v[40:43], v84 offset:12800
  buffer_load_dwordx4 v[160:163], v2, s[24:27], s58 offen offset:3072 sc1
  s_waitcnt lgkmcnt(3)
  s_waitcnt vmcnt(23)
  v_mfma_f32_16x16x32_bf16 v[68:71], v[20:23], v[164:167], v[68:71]
  ds_read_b128 v[44:47], v80 offset:15360
  v_mfma_f32_16x16x32_bf16 v[72:75], v[24:27], v[164:167], v[72:75]
  ds_read_b128 v[48:51], v80 offset:16384
  v_mfma_f32_16x16x32_bf16 v[76:79], v[28:31], v[164:167], v[76:79]
  ds_read_b128 v[52:55], v84 offset:15360
  s_add_u32 s58, s58, 4096
  buffer_load_dwordx4 v[164:167], v2, s[24:27], s58 offen offset:0 sc1
  s_waitcnt lgkmcnt(3)
  s_waitcnt vmcnt(23)
  v_mfma_f32_16x16x32_bf16 v[68:71], v[32:35], v[168:171], v[68:71]
  ds_read_b128 v[56:59], v80 offset:17920
  v_mfma_f32_16x16x32_bf16 v[72:75], v[36:39], v[168:171], v[72:75]
  ds_read_b128 v[60:63], v80 offset:18944
  v_mfma_f32_16x16x32_bf16 v[76:79], v[40:43], v[168:171], v[76:79]
  ds_read_b128 v[64:67], v84 offset:17920
  buffer_load_dwordx4 v[168:171], v2, s[24:27], s58 offen offset:1024 sc1
  s_waitcnt lgkmcnt(3)
  s_waitcnt vmcnt(23)
  v_mfma_f32_16x16x32_bf16 v[68:71], v[44:47], v[172:175], v[68:71]
  ds_read_b128 v[20:23], v80 offset:20480
  v_mfma_f32_16x16x32_bf16 v[72:75], v[48:51], v[172:175], v[72:75]
  ds_read_b128 v[24:27], v80 offset:21504
  v_mfma_f32_16x16x32_bf16 v[76:79], v[52:55], v[172:175], v[76:79]
  ds_read_b128 v[28:31], v84 offset:20480
  buffer_load_dwordx4 v[172:175], v2, s[24:27], s58 offen offset:2048 sc1
  s_waitcnt lgkmcnt(3)
  s_waitcnt vmcnt(23)
  v_mfma_f32_16x16x32_bf16 v[68:71], v[56:59], v[176:179], v[68:71]
  ds_read_b128 v[32:35], v80 offset:23040
  v_mfma_f32_16x16x32_bf16 v[72:75], v[60:63], v[176:179], v[72:75]
  ds_read_b128 v[36:39], v80 offset:24064
  v_mfma_f32_16x16x32_bf16 v[76:79], v[64:67], v[176:179], v[76:79]
  ds_read_b128 v[40:43], v84 offset:23040
  buffer_load_dwordx4 v[176:179], v2, s[24:27], s58 offen offset:3072 sc1
  s_waitcnt lgkmcnt(3)
  s_waitcnt vmcnt(23)
  v_mfma_f32_16x16x32_bf16 v[68:71], v[20:23], v[180:183], v[68:71]
  ds_read_b128 v[44:47], v80 offset:25600
  v_mfma_f32_16x16x32_bf16 v[72:75], v[24:27], v[180:183], v[72:75]
  ds_read_b128 v[48:51], v80 offset:26624
  v_mfma_f32_16x16x32_bf16 v[76:79], v[28:31], v[180:183], v[76:79]
  ds_read_b128 v[52:55], v84 offset:25600
  s_add_u32 s58, s58, 4096
  buffer_load_dwordx4 v[180:183], v2, s[24:27], s58 offen offset:0 sc1
  s_waitcnt lgkmcnt(3)
  s_waitcnt vmcnt(23)
  v_mfma_f32_16x16x32_bf16 v[68:71], v[32:35], v[184:187], v[68:71]
  ds_read_b128 v[56:59], v80 offset:28160
  v_mfma_f32_16x16x32_bf16 v[72:75], v[36:39], v[184:187], v[72:75]
  ds_read_b128 v[60:63], v80 offset:29184
  v_mfma_f32_16x16x32_bf16 v[76:79], v[40:43], v[184:187], v[76:79]
  ds_read_b128 v[64:67], v84 offset:28160
  buffer_load_dwordx4 v[184:187], v2, s[24:27], s58 offen offset:1024 sc1
  s_waitcnt lgkmcnt(3)
  s_waitcnt vmcnt(23)
  v_mfma_f32_16x16x32_bf16 v[68:71], v[44:47], v[188:191], v[68:71]
  ds_read_b128 v[20:23], v80 offset:30720
  v_mfma_f32_16x16x32_bf16 v[72:75], v[48:51], v[188:191], v[72:75]
  ds_read_b128 v[24:27], v80 offset:31744
  v_mfma_f32_16x16x32_bf16 v[76:79], v[52:55], v[188:191], v[76:79]
  ds_read_b128 v[28:31], v84 offset:30720
  buffer_load_dwordx4 v[188:191], v2, s[24:27], s58 offen offset:2048 sc1
  s_waitcnt lgkmcnt(3)
  s_waitcnt vmcnt(23)
  v_mfma_f32_16x16x32_bf16 v[68:71], v[56:59], v[192:195], v[68:71]
  ds_read_b128 v[32:35], v80 offset:33280
  v_mfma_f32_16x16x32_bf16 v[72:75], v[60:63], v[192:195], v[72:75]
  ds_read_b128 v[36:39], v80 offset:34304
  v_mfma_f32_16x16x32_bf16 v[76:79], v[64:67], v[192:195], v[76:79]
  ds_read_b128 v[40:43], v84 offset:33280
  buffer_load_dwordx4 v[192:195], v2, s[24:27], s58 offen offset:3072 sc1
  s_waitcnt lgkmcnt(3)
  s_barrier
  s_waitcnt vmcnt(23)
  v_mfma_f32_16x16x32_bf16 v[68:71], v[20:23], v[196:199], v[68:71]
  ds_read_b128 v[44:47], v81 offset:0
  v_mfma_f32_16x16x32_bf16 v[72:75], v[24:27], v[196:199], v[72:75]
  ds_read_b128 v[48:51], v81 offset:1024
  v_mfma_f32_16x16x32_bf16 v[76:79], v[28:31], v[196:199], v[76:79]
  ds_read_b128 v[52:55], v85 offset:0
  s_add_u32 s58, s58, 4096
  buffer_load_dwordx4 v[196:199], v2, s[24:27], s58 offen offset:0 sc1
  s_waitcnt lgkmcnt(3)
  s_waitcnt vmcnt(23)
  v_mfma_f32_16x16x32_bf16 v[68:71], v[32:35], v[200:203], v[68:71]
  ds_read_b128 v[56:59], v81 offset:2560
  v_mfma_f32_16x16x32_bf16 v[72:75], v[36:39], v[200:203], v[72:75]
  ds_read_b128 v[60:63], v81 offset:3584
  v_mfma_f32_16x16x32_bf16 v[76:79], v[40:43], v[200:203], v[76:79]
  ds_read_b128 v[64:67], v85 offset:2560
  buffer_load_dwordx4 v[200:203], v2, s[24:27], s58 offen offset:1024 sc1
  s_waitcnt lgkmcnt(3)
  s_barrier
  s_waitcnt vmcnt(23)
  v_mfma_f32_16x16x32_bf16 v[68:71], v[44:47], v[204:207], v[68:71]
  ds_read_b128 v[20:23], v81 offset:5120
  v_mfma_f32_16x16x32_bf16 v[72:75], v[48:51], v[204:207], v[72:75]
  ds_read_b128 v[24:27], v81 offset:6144
  v_mfma_f32_16x16x32_bf16 v[76:79], v[52:55], v[204:207], v[76:79]
  ds_read_b128 v[28:31], v85 offset:5120
  buffer_load_dwordx4 v[204:207], v2, s[24:27], s58 offen offset:2048 sc1
  s_waitcnt lgkmcnt(3)
  s_waitcnt vmcnt(23)
  v_mfma_f32_16x16x32_bf16 v[68:71], v[56:59], v[208:211], v[68:71]
  ds_read_b128 v[32:35], v81 offset:7680
  v_mfma_f32_16x16x32_bf16 v[72:75], v[60:63], v[208:211], v[72:75]
  ds_read_b128 v[36:39], v81 offset:8704
  v_mfma_f32_16x16x32_bf16 v[76:79], v[64:67], v[208:211], v[76:79]
  ds_read_b128 v[40:43], v85 offset:7680
  buffer_load_dwordx4 v[208:211], v2, s[24:27], s58 offen offset:3072 sc1
  s_waitcnt lgkmcnt(3)
  s_barrier
  s_waitcnt vmcnt(23)
  v_mfma_f32_16x16x32_bf16 v[68:71], v[20:23], v[212:215], v[68:71]
  ds_read_b128 v[44:47], v81 offset:10240
  v_mfma_f32_16x16x32_bf16 v[72:75], v[24:27], v[212:215], v[72:75]
  ds_read_b128 v[48:51], v81 offset:11264
  v_mfma_f32_16x16x32_bf16 v[76:79], v[28:31], v[212:215], v[76:79]
  ds_read_b128 v[52:55], v85 offset:10240
  s_add_u32 s58, s58, 4096
  buffer_load_dwordx4 v[212:215], v2, s[24:27], s58 offen offset:0 sc1
  s_waitcnt lgkmcnt(3)
  s_waitcnt vmcnt(23)
  v_mfma_f32_16x16x32_bf16 v[68:71], v[32:35], v[216:219], v[68:71]
  ds_read_b128 v[56:59], v81 offset:12800
  v_mfma_f32_16x16x32_bf16 v[72:75], v[36:39], v[216:219], v[72:75]
  ds_read_b128 v[60:63], v81 offset:13824
  v_mfma_f32_16x16x32_bf16 v[76:79], v[40:43], v[216:219], v[76:79]
  ds_read_b128 v[64:67], v85 offset:12800
  buffer_load_dwordx4 v[216:219], v2, s[24:27], s58 offen offset:1024 sc1
  s_waitcnt lgkmcnt(3)
  s_barrier
  s_waitcnt vmcnt(23)
  v_mfma_f32_16x16x32_bf16 v[68:71], v[44:47], v[220:223], v[68:71]
  ds_read_b128 v[20:23], v81 offset:15360
  v_mfma_f32_16x16x32_bf16 v[72:75], v[48:51], v[220:223], v[72:75]
  ds_read_b128 v[24:27], v81 offset:16384
  v_mfma_f32_16x16x32_bf16 v[76:79], v[52:55], v[220:223], v[76:79]
  ds_read_b128 v[28:31], v85 offset:15360
  buffer_load_dwordx4 v[220:223], v2, s[24:27], s58 offen offset:2048 sc1
  s_waitcnt lgkmcnt(3)
  s_waitcnt vmcnt(23)
  v_mfma_f32_16x16x32_bf16 v[68:71], v[56:59], v[224:227], v[68:71]
  ds_read_b128 v[32:35], v81 offset:17920
  v_mfma_f32_16x16x32_bf16 v[72:75], v[60:63], v[224:227], v[72:75]
  ds_read_b128 v[36:39], v81 offset:18944
  v_mfma_f32_16x16x32_bf16 v[76:79], v[64:67], v[224:227], v[76:79]
  ds_read_b128 v[40:43], v85 offset:17920
  buffer_load_dwordx4 v[224:227], v2, s[24:27], s58 offen offset:3072 sc1
  s_waitcnt lgkmcnt(3)
  s_barrier
  s_waitcnt vmcnt(23)
  v_mfma_f32_16x16x32_bf16 v[68:71], v[20:23], v[228:231], v[68:71]
  ds_read_b128 v[44:47], v81 offset:20480
  v_mfma_f32_16x16x32_bf16 v[72:75], v[24:27], v[228:231], v[72:75]
  ds_read_b128 v[48:51], v81 offset:21504
  v_mfma_f32_16x16x32_bf16 v[76:79], v[28:31], v[228:231], v[76:79]
  ds_read_b128 v[52:55], v85 offset:20480
  s_add_u32 s58, s58, 4096
  buffer_load_dwordx4 v[228:231], v2, s[24:27], s58 offen offset:0 sc1
  s_waitcnt lgkmcnt(3)
  s_waitcnt vmcnt(23)
  v_mfma_f32_16x16x32_bf16 v[68:71], v[32:35], v[232:235], v[68:71]
  ds_read_b128 v[56:59], v81 offset:23040
  v_mfma_f32_16x16x32_bf16 v[72:75], v[36:39], v[232:235], v[72:75]
  ds_read_b128 v[60:63], v81 offset:24064
  v_mfma_f32_16x16x32_bf16 v[76:79], v[40:43], v[232:235], v[76:79]
  ds_read_b128 v[64:67], v85 offset:23040
  buffer_load_dwordx4 v[232:235], v2, s[24:27], s58 offen offset:1024 sc1
  s_waitcnt lgkmcnt(3)
  s_barrier
  s_waitcnt vmcnt(23)
  v_mfma_f32_16x16x32_bf16 v[68:71], v[44:47], v[236:239], v[68:71]
  ds_read_b128 v[20:23], v81 offset:25600
  v_mfma_f32_16x16x32_bf16 v[72:75], v[48:51], v[236:239], v[72:75]
  ds_read_b128 v[24:27], v81 offset:26624
  v_mfma_f32_16x16x32_bf16 v[76:79], v[52:55], v[236:239], v[76:79]
  ds_read_b128 v[28:31], v85 offset:25600
  buffer_load_dwordx4 v[236:239], v2, s[24:27], s58 offen offset:2048 sc1
  s_waitcnt lgkmcnt(3)
  s_waitcnt vmcnt(23)
  v_mfma_f32_16x16x32_bf16 v[68:71], v[56:59], v[240:243], v[68:71]
  ds_read_b128 v[32:35], v81 offset:28160
  v_mfma_f32_16x16x32_bf16 v[72:75], v[60:63], v[240:243], v[72:75]
  ds_read_b128 v[36:39], v81 offset:29184
  v_mfma_f32_16x16x32_bf16 v[76:79], v[64:67], v[240:243], v[76:79]
  ds_read_b128 v[40:43], v85 offset:28160
  buffer_load_dwordx4 v[240:243], v2, s[24:27], s58 offen offset:3072 sc1
  s_waitcnt lgkmcnt(3)
  s_barrier
  s_waitcnt vmcnt(23)
  v_mfma_f32_16x16x32_bf16 v[68:71], v[20:23], v[148:151], v[68:71]
  ds_read_b128 v[44:47], v81 offset:30720
  v_mfma_f32_16x16x32_bf16 v[72:75], v[24:27], v[148:151], v[72:75]
  ds_read_b128 v[48:51], v81 offset:31744
  v_mfma_f32_16x16x32_bf16 v[76:79], v[28:31], v[148:151], v[76:79]
  ds_read_b128 v[52:55], v85 offset:30720
  s_waitcnt lgkmcnt(3)
  s_waitcnt vmcnt(22)
  v_mfma_f32_16x16x32_bf16 v[68:71], v[32:35], v[152:155], v[68:71]
  ds_read_b128 v[56:59], v81 offset:33280
  v_mfma_f32_16x16x32_bf16 v[72:75], v[36:39], v[152:155], v[72:75]
  ds_read_b128 v[60:63], v81 offset:34304
  v_mfma_f32_16x16x32_bf16 v[76:79], v[40:43], v[152:155], v[76:79]
  ds_read_b128 v[64:67], v85 offset:33280
  s_waitcnt lgkmcnt(3)
  s_barrier
  s_waitcnt vmcnt(21)
  v_mfma_f32_16x16x32_bf16 v[68:71], v[44:47], v[156:159], v[68:71]
  ds_read_b128 v[20:23], v81 offset:35840
  v_mfma_f32_16x16x32_bf16 v[72:75], v[48:51], v[156:159], v[72:75]
  ds_read_b128 v[24:27], v81 offset:36864
  v_mfma_f32_16x16x32_bf16 v[76:79], v[52:55], v[156:159], v[76:79]
  ds_read_b128 v[28:31], v85 offset:35840
  s_waitcnt lgkmcnt(3)
  s_waitcnt vmcnt(20)
  v_mfma_f32_16x16x32_bf16 v[68:71], v[56:59], v[160:163], v[68:71]
  ds_read_b128 v[32:35], v81 offset:38400
  v_mfma_f32_16x16x32_bf16 v[72:75], v[60:63], v[160:163], v[72:75]
  ds_read_b128 v[36:39], v81 offset:39424
  v_mfma_f32_16x16x32_bf16 v[76:79], v[64:67], v[160:163], v[76:79]
  ds_read_b128 v[40:43], v85 offset:38400
  s_waitcnt lgkmcnt(3)
  s_barrier
  s_waitcnt vmcnt(19)
  v_mfma_f32_16x16x32_bf16 v[68:71], v[20:23], v[164:167], v[68:71]
  ds_read_b128 v[44:47], v81 offset:40960
  v_mfma_f32_16x16x32_bf16 v[72:75], v[24:27], v[164:167], v[72:75]
  ds_read_b128 v[48:51], v81 offset:41984
  v_mfma_f32_16x16x32_bf16 v[76:79], v[28:31], v[164:167], v[76:79]
  ds_read_b128 v[52:55], v85 offset:40960
  s_waitcnt lgkmcnt(3)
  s_waitcnt vmcnt(18)
  v_mfma_f32_16x16x32_bf16 v[68:71], v[32:35], v[168:171], v[68:71]
  ds_read_b128 v[56:59], v81 offset:43520
  v_mfma_f32_16x16x32_bf16 v[72:75], v[36:39], v[168:171], v[72:75]
  ds_read_b128 v[60:63], v81 offset:44544
  v_mfma_f32_16x16x32_bf16 v[76:79], v[40:43], v[168:171], v[76:79]
  ds_read_b128 v[64:67], v85 offset:43520
  s_waitcnt lgkmcnt(3)
  s_barrier
  s_waitcnt vmcnt(17)
  v_mfma_f32_16x16x32_bf16 v[68:71], v[44:47], v[172:175], v[68:71]
  ds_read_b128 v[20:23], v81 offset:46080
  v_mfma_f32_16x16x32_bf16 v[72:75], v[48:51], v[172:175], v[72:75]
  ds_read_b128 v[24:27], v81 offset:47104
  v_mfma_f32_16x16x32_bf16 v[76:79], v[52:55], v[172:175], v[76:79]
  ds_read_b128 v[28:31], v85 offset:46080
  s_waitcnt lgkmcnt(3)
  s_waitcnt vmcnt(16)
  v_mfma_f32_16x16x32_bf16 v[68:71], v[56:59], v[176:179], v[68:71]
  ds_read_b128 v[32:35], v81 offset:48640
  v_mfma_f32_16x16x32_bf16 v[72:75], v[60:63], v[176:179], v[72:75]
  ds_read_b128 v[36:39], v81 offset:49664
  v_mfma_f32_16x16x32_bf16 v[76:79], v[64:67], v[176:179], v[76:79]
  ds_read_b128 v[40:43], v85 offset:48640
  s_waitcnt lgkmcnt(3)
  s_barrier
  s_waitcnt vmcnt(15)
  v_mfma_f32_16x16x32_bf16 v[68:71], v[20:23], v[180:183], v[68:71]
  ds_read_b128 v[44:47], v81 offset:51200
  v_mfma_f32_16x16x32_bf16 v[72:75], v[24:27], v[180:183], v[72:75]
  ds_read_b128 v[48:51], v81 offset:52224
  v_mfma_f32_16x16x32_bf16 v[76:79], v[28:31], v[180:183], v[76:79]
  ds_read_b128 v[52:55], v85 offset:51200
  s_waitcnt lgkmcnt(3)
  s_waitcnt vmcnt(14)
  v_mfma_f32_16x16x32_bf16 v[68:71], v[32:35], v[184:187], v[68:71]
  ds_read_b128 v[56:59], v81 offset:53760
  v_mfma_f32_16x16x32_bf16 v[72:75], v[36:39], v[184:187], v[72:75]
  ds_read_b128 v[60:63], v81 offset:54784
  v_mfma_f32_16x16x32_bf16 v[76:79], v[40:43], v[184:187], v[76:79]
  ds_read_b128 v[64:67], v85 offset:53760
  s_waitcnt lgkmcnt(3)
  s_barrier
  s_waitcnt vmcnt(13)
  v_mfma_f32_16x16x32_bf16 v[68:71], v[44:47], v[188:191], v[68:71]
  ds_read_b128 v[20:23], v81 offset:56320
  v_mfma_f32_16x16x32_bf16 v[72:75], v[48:51], v[188:191], v[72:75]
  ds_read_b128 v[24:27], v81 offset:57344
  v_mfma_f32_16x16x32_bf16 v[76:79], v[52:55], v[188:191], v[76:79]
  ds_read_b128 v[28:31], v85 offset:56320
  s_waitcnt lgkmcnt(3)
  s_waitcnt vmcnt(12)
  v_mfma_f32_16x16x32_bf16 v[68:71], v[56:59], v[192:195], v[68:71]
  ds_read_b128 v[32:35], v81 offset:58880
  v_mfma_f32_16x16x32_bf16 v[72:75], v[60:63], v[192:195], v[72:75]
  ds_read_b128 v[36:39], v81 offset:59904
  v_mfma_f32_16x16x32_bf16 v[76:79], v[64:67], v[192:195], v[76:79]
  ds_read_b128 v[40:43], v85 offset:58880
  s_waitcnt lgkmcnt(3)
  s_barrier
  s_waitcnt vmcnt(0)
  s_cmp_lg_u32 s52, 0
  s_cbranch_scc1 L_xrb_114
  s_barrier
  s_lshl_b32 s58, s32, 2
  s_add_u32 s58, s58, s3
  s_add_u32 s58, s58, 64
  s_mul_i32 s58, s58, 49152
  s_add_u32 s58, s58, 13107200
  buffer_load_dwordx2 v[96:97], v104, s[24:27], 0 offen sc1
  buffer_load_dwordx2 v[98:99], v105, s[24:27], 0 offen sc1
  buffer_load_dwordx2 v[100:101], v106, s[24:27], 0 offen sc1
L_xrb_114:
  v_mfma_f32_16x16x32_bf16 v[68:71], v[20:23], v[196:199], v[68:71]
  ds_read_b128 v[44:47], v82 offset:0
  v_mfma_f32_16x16x32_bf16 v[72:75], v[24:27], v[196:199], v[72:75]
  ds_read_b128 v[48:51], v82 offset:1024
  v_mfma_f32_16x16x32_bf16 v[76:79], v[28:31], v[196:199], v[76:79]
  ds_read_b128 v[52:55], v86 offset:0
  s_cmp_lg_u32 s52, 0
  s_cbranch_scc1 L_xbs_115
  buffer_load_dwordx4 v[148:151], v2, s[24:27], s58 offen offset:0 sc1
  buffer_load_dwordx4 v[152:155], v2, s[24:27], s58 offen offset:1024 sc1
L_xbs_115:
  s_waitcnt lgkmcnt(3)
  v_mfma_f32_16x16x32_bf16 v[68:71], v[32:35], v[200:203], v[68:71]
  ds_read_b128 v[56:59], v82 offset:2560
  v_mfma_f32_16x16x32_bf16 v[72:75], v[36:39], v[200:203], v[72:75]
  ds_read_b128 v[60:63], v82 offset:3584
  v_mfma_f32_16x16x32_bf16 v[76:79], v[40:43], v[200:203], v[76:79]
  ds_read_b128 v[64:67], v86 offset:2560
  s_cmp_lg_u32 s52, 0
  s_cbranch_scc1 L_xbs_116
  buffer_load_dwordx4 v[156:159], v2, s[24:27], s58 offen offset:2048 sc1
  buffer_load_dwordx4 v[160:163], v2, s[24:27], s58 offen offset:3072 sc1
L_xbs_116:
  s_waitcnt lgkmcnt(3)
  s_barrier
  v_mfma_f32_16x16x32_bf16 v[68:71], v[44:47], v[204:207], v[68:71]
  ds_read_b128 v[20:23], v82 offset:5120
  v_mfma_f32_16x16x32_bf16 v[72:75], v[48:51], v[204:207], v[72:75]
  ds_read_b128 v[24:27], v82 offset:6144
  v_mfma_f32_16x16x32_bf16 v[76:79], v[52:55], v[204:207], v[76:79]
  ds_read_b128 v[28:31], v86 offset:5120
  s_cmp_lg_u32 s52, 0
  s_cbranch_scc1 L_xbs_117
  s_add_u32 s58, s58, 4096
  buffer_load_dwordx4 v[164:167], v2, s[24:27], s58 offen offset:0 sc1
  buffer_load_dwordx4 v[168:171], v2, s[24:27], s58 offen offset:1024 sc1
L_xbs_117:
  s_waitcnt lgkmcnt(3)
  v_mfma_f32_16x16x32_bf16 v[68:71], v[56:59], v[208:211], v[68:71]
  ds_read_b128 v[32:35], v82 offset:7680
  v_mfma_f32_16x16x32_bf16 v[72:75], v[60:63], v[208:211], v[72:75]
  ds_read_b128 v[36:39], v82 offset:8704
  v_mfma_f32_16x16x32_bf16 v[76:79], v[64:67], v[208:211], v[76:79]
  ds_read_b128 v[40:43], v86 offset:7680
  s_cmp_lg_u32 s52, 0
  s_cbranch_scc1 L_xbs_118
  buffer_load_dwordx4 v[172:175], v2, s[24:27], s58 offen offset:2048 sc1
  buffer_load_dwordx4 v[176:179], v2, s[24:27], s58 offen offset:3072 sc1
L_xbs_118:
  s_waitcnt lgkmcnt(3)
  s_barrier
  v_mfma_f32_16x16x32_bf16 v[68:71], v[20:23], v[212:215], v[68:71]
  ds_read_b128 v[44:47], v82 offset:10240
  v_mfma_f32_16x16x32_bf16 v[72:75], v[24:27], v[212:215], v[72:75]
  ds_read_b128 v[48:51], v82 offset:11264
  v_mfma_f32_16x16x32_bf16 v[76:79], v[28:31], v[212:215], v[76:79]
  ds_read_b128 v[52:55], v86 offset:10240
  s_cmp_lg_u32 s52, 0
  s_cbranch_scc1 L_xbs_119
  s_add_u32 s58, s58, 4096
  buffer_load_dwordx4 v[180:183], v2, s[24:27], s58 offen offset:0 sc1
  buffer_load_dwordx4 v[184:187], v2, s[24:27], s58 offen offset:1024 sc1
L_xbs_119:
  s_waitcnt lgkmcnt(3)
  v_mfma_f32_16x16x32_bf16 v[68:71], v[32:35], v[216:219], v[68:71]
  ds_read_b128 v[56:59], v82 offset:12800
  v_mfma_f32_16x16x32_bf16 v[72:75], v[36:39], v[216:219], v[72:75]
  ds_read_b128 v[60:63], v82 offset:13824
  v_mfma_f32_16x16x32_bf16 v[76:79], v[40:43], v[216:219], v[76:79]
  ds_read_b128 v[64:67], v86 offset:12800
  s_cmp_lg_u32 s52, 0
  s_cbranch_scc1 L_xbs_120
  buffer_load_dwordx4 v[188:191], v2, s[24:27], s58 offen offset:2048 sc1
  buffer_load_dwordx4 v[192:195], v2, s[24:27], s58 offen offset:3072 sc1
L_xbs_120:
  s_waitcnt lgkmcnt(3)
  s_barrier
  v_mfma_f32_16x16x32_bf16 v[68:71], v[44:47], v[220:223], v[68:71]
  ds_read_b128 v[20:23], v82 offset:15360
  v_mfma_f32_16x16x32_bf16 v[72:75], v[48:51], v[220:223], v[72:75]
  ds_read_b128 v[24:27], v82 offset:16384
  v_mfma_f32_16x16x32_bf16 v[76:79], v[52:55], v[220:223], v[76:79]
  ds_read_b128 v[28:31], v86 offset:15360
  s_cmp_lg_u32 s52, 0
  s_cbranch_scc1 L_xbs_121
  s_add_u32 s58, s58, 4096
  buffer_load_dwordx4 v[196:199], v2, s[24:27], s58 offen offset:0 sc1
  buffer_load_dwordx4 v[200:203], v2, s[24:27], s58 offen offset:1024 sc1
L_xbs_121:
  s_waitcnt lgkmcnt(3)
  v_mfma_f32_16x16x32_bf16 v[68:71], v[56:59], v[224:227], v[68:71]
  ds_read_b128 v[32:35], v82 offset:17920
  v_mfma_f32_16x16x32_bf16 v[72:75], v[60:63], v[224:227], v[72:75]
  ds_read_b128 v[36:39], v82 offset:18944
  v_mfma_f32_16x16x32_bf16 v[76:79], v[64:67], v[224:227], v[76:79]
  ds_read_b128 v[40:43], v86 offset:17920
  s_cmp_lg_u32 s52, 0
  s_cbranch_scc1 L_xbs_122
  buffer_load_dwordx4 v[204:207], v2, s[24:27], s58 offen offset:2048 sc1
  buffer_load_dwordx4 v[208:211], v2, s[24:27], s58 offen offset:3072 sc1
L_xbs_122:
  s_waitcnt lgkmcnt(3)
  s_barrier
  v_mfma_f32_16x16x32_bf16 v[68:71], v[20:23], v[228:231], v[68:71]
  ds_read_b128 v[44:47], v82 offset:20480
  v_mfma_f32_16x16x32_bf16 v[72:75], v[24:27], v[228:231], v[72:75]
  ds_read_b128 v[48:51], v82 offset:21504
  v_mfma_f32_16x16x32_bf16 v[76:79], v[28:31], v[228:231], v[76:79]
  ds_read_b128 v[52:55], v86 offset:20480
  s_cmp_lg_u32 s52, 0
  s_cbranch_scc1 L_xbs_123
  s_add_u32 s58, s58, 4096
  buffer_load_dwordx4 v[212:215], v2, s[24:27], s58 offen offset:0 sc1
  buffer_load_dwordx4 v[216:219], v2, s[24:27], s58 offen offset:1024 sc1
L_xbs_123:
  s_waitcnt lgkmcnt(3)
  v_mfma_f32_16x16x32_bf16 v[68:71], v[32:35], v[232:235], v[68:71]
  ds_read_b128 v[56:59], v82 offset:23040
  v_mfma_f32_16x16x32_bf16 v[72:75], v[36:39], v[232:235], v[72:75]
  ds_read_b128 v[60:63], v82 offset:24064
  v_mfma_f32_16x16x32_bf16 v[76:79], v[40:43], v[232:235], v[76:79]
  ds_read_b128 v[64:67], v86 offset:23040
  s_cmp_lg_u32 s52, 0
  s_cbranch_scc1 L_xbs_124
  buffer_load_dwordx4 v[220:223], v2, s[24:27], s58 offen offset:2048 sc1
  buffer_load_dwordx4 v[224:227], v2, s[24:27], s58 offen offset:3072 sc1
L_xbs_124:
  s_waitcnt lgkmcnt(3)
  v_mfma_f32_16x16x32_bf16 v[68:71], v[44:47], v[236:239], v[68:71]
  v_mfma_f32_16x16x32_bf16 v[72:75], v[48:51], v[236:239], v[72:75]
  v_mfma_f32_16x16x32_bf16 v[76:79], v[52:55], v[236:239], v[76:79]
  s_cmp_lg_u32 s52, 0
  s_cbranch_scc1 L_xbs_125
  s_add_u32 s58, s58, 4096
  buffer_load_dwordx4 v[228:231], v2, s[24:27], s58 offen offset:0 sc1
  buffer_load_dwordx4 v[232:235], v2, s[24:27], s58 offen offset:1024 sc1
L_xbs_125:
  s_waitcnt lgkmcnt(0)
  v_mfma_f32_16x16x32_bf16 v[68:71], v[56:59], v[240:243], v[68:71]
  v_mfma_f32_16x16x32_bf16 v[72:75], v[60:63], v[240:243], v[72:75]
  v_mfma_f32_16x16x32_bf16 v[76:79], v[64:67], v[240:243], v[76:79]
  s_cmp_lg_u32 s52, 0
  s_cbranch_scc1 L_xbs_126
  buffer_load_dwordx4 v[236:239], v2, s[24:27], s58 offen offset:2048 sc1
  buffer_load_dwordx4 v[240:243], v2, s[24:27], s58 offen offset:3072 sc1
L_xbs_126:
  v_lshlrev_b32 v20, 16, v8
  v_and_b32 v21, 0xffff0000, v8
  v_lshlrev_b32 v22, 16, v9
  v_and_b32 v23, 0xffff0000, v9
  v_add_f32 v20, v20, v68
  v_add_f32 v21, v21, v69
  v_add_f32 v22, v22, v70
  v_add_f32 v23, v23, v71
  v_cvt_pk_bf16_f32 v24, v20, v21
  v_cvt_pk_bf16_f32 v25, v22, v23
  buffer_store_dwordx2 v[24:25], v4, s[60:63], 0 offen offset:0
  v_lshlrev_b32 v28, 16, v10
  v_and_b32 v29, 0xffff0000, v10
  v_lshlrev_b32 v30, 16, v11
  v_and_b32 v31, 0xffff0000, v11
  v_add_f32 v28, v28, v72
  v_add_f32 v29, v29, v73
  v_add_f32 v30, v30, v74
  v_add_f32 v31, v31, v75
  v_cvt_pk_bf16_f32 v32, v28, v29
  v_cvt_pk_bf16_f32 v33, v30, v31
  buffer_store_dwordx2 v[32:33], v4, s[60:63], 0 offen offset:32
  v_lshlrev_b32 v36, 16, v12
  v_and_b32 v37, 0xffff0000, v12
  v_lshlrev_b32 v38, 16, v13
  v_and_b32 v39, 0xffff0000, v13
  v_add_f32 v36, v36, v76
  v_add_f32 v37, v37, v77
  v_add_f32 v38, v38, v78
  v_add_f32 v39, v39, v79
  v_cvt_pk_bf16_f32 v40, v36, v37
  v_cvt_pk_bf16_f32 v41, v38, v39
  s_mov_b32 exec_lo, -1
  s_mov_b32 exec_hi, 0
  buffer_store_dwordx2 v[40:41], v4, s[60:63], 0 offen offset:64
  s_mov_b64 exec, -1
  s_add_u32 s52, s52, 1
  s_cmp_ge_u32 s52, 2
  s_cbranch_scc1 L_p5_done
  s_waitcnt vmcnt(27)
  v_mov_b32 v8, v96
  v_mov_b32 v9, v97
  v_mov_b32 v10, v98
  v_mov_b32 v11, v99
  v_mov_b32 v12, v100
  v_mov_b32 v13, v101
  v_mov_b32 v4, v102
  v_mov_b32 v88, v104
  v_mov_b32 v89, v105
  v_mov_b32 v90, v106
  v_mov_b32 v91, v107
  s_branch L_xh_113
L_p5_done:
L_mega_end:
  s_endpgm
.section .rodata,"a"
.p2align 6
.amdhsa_kernel sequential_preLN__mha_block__geglu_ffn__prompt_kernel
  .amdhsa_next_free_vgpr 256
  .amdhsa_next_free_sgpr 102
  .amdhsa_accum_offset 256
  .amdhsa_group_segment_fixed_size 0
  .amdhsa_kernarg_size 80
  .amdhsa_user_sgpr_count 2
  .amdhsa_user_sgpr_kernarg_segment_ptr 1
  .amdhsa_system_sgpr_workgroup_id_x 1
  .amdhsa_float_denorm_mode_32 3
.end_amdhsa_kernel
```
